```python
import torch

def _softmax(x, axis=-1):
    return torch.softmax(x, dim=axis)

def _gelu(x):
    return torch.nn.functional.gelu(x, approximate='tanh')

def _silu(x):
    return torch.nn.functional.silu(x)

def _sigmoid(x):
    return torch.sigmoid(x)

def _layernorm(x, axis=-1, eps=1e-05):
    m = x.mean(dim=axis, keepdim=True)
    v = x.var(dim=axis, keepdim=True, unbiased=False)
    return (x - m) / torch.sqrt(v + eps)

def _scatter_add(tgt, idx, src, axis=0):
    return tgt.clone().index_add_(axis, idx, src)

def _segment_sum(src, seg, n):
    out = torch.zeros((n,) + src.shape[1:], dtype=src.dtype)
    return out.index_add_(0, seg, src)

def _pad(x, pw):
    flat = tuple((v for pair in reversed(pw) for v in pair))
    return torch.nn.functional.pad(x, flat)
kernel_name = 'adaLN_cond__linear_kernel_hedgehog__mixer_gmlp__prompt'

def setup_inputs():

    _w = lambda a: (lambda t: t.to(torch.bfloat16) if t.is_floating_point() else t)(torch.as_tensor(a))

    def _A_setup():
        B, S, D, H = (1, 2048, 640, 32)
        Dh = D // H
        return {'x': _w((lambda *s: torch.randn(*s, dtype=torch.bfloat16) * 0.05)(B, S, D)), 'wqkv': _w((lambda *s: torch.randn(*s, dtype=torch.bfloat16) * 0.4)(D, 3 * D)), 'w_phi': _w((lambda *s: torch.randn(*s, dtype=torch.bfloat16) * 0.4)(H, Dh, Dh) * Dh ** (-0.5)), 'wo': _w((lambda *s: torch.randn(*s, dtype=torch.bfloat16) * 0.05)(D, D))}
    _A_in = _A_setup()

    def _B_setup():
        B, S, D, F = (1, 2048, 640, 1536)
        Fh = F // 2
        return {'x': _w((lambda *s: torch.randn(*s, dtype=torch.bfloat16) * 0.05)(B, S, D)), 'w_in': _w((lambda *s: torch.randn(*s, dtype=torch.bfloat16) * 0.2)(D, 2 * Fh)), 'w_sp': _w(0.01 * (lambda *s: torch.randn(*s, dtype=torch.bfloat16) * 0.2)(S, S)), 'b_sp': _w(1.0 + 0.01 * (lambda *s: torch.randn(*s, dtype=torch.bfloat16) * 0.05)(S)), 'w_out': _w((lambda *s: torch.randn(*s, dtype=torch.bfloat16) * 0.05)(Fh, D))}
    _B_in = _B_setup()
    return {'A_x': _A_in['x'], 'A_wqkv': _A_in['wqkv'], 'A_w_phi': _A_in['w_phi'], 'A_wo': _A_in['wo'], 'B_x': _B_in['x'], 'B_w_in': _B_in['w_in'], 'B_w_sp': _B_in['w_sp'], 'B_b_sp': _B_in['b_sp'], 'B_w_out': _B_in['w_out'], 'c': _w((lambda *s: torch.randn(*s, dtype=torch.bfloat16) * 0.1)(1, 640) * 8.0), 'w_mod': _w((lambda *s: torch.randn(*s, dtype=torch.bfloat16) * 0.1)(640, 6 * 640) * 640 ** (-0.5) * 8.0)}

def reference(A_x, A_wqkv, A_w_phi, A_wo, B_x, B_w_in, B_w_sp, B_b_sp, B_w_out, c, w_mod):

    def _A_ref(x, wqkv, w_phi, wo):
        B, S, D = x.shape
        H = 32
        Dh = D // H
        qkv = (lambda x, *d: x.permute(*d))((x @ wqkv).reshape(B, S, 3, H, Dh), 2, 0, 3, 1, 4)
        q, k, v = (qkv[0], qkv[1], qkv[2])
        pq = torch.einsum('bhsd,hdf->bhsf', q, w_phi)
        pk = torch.einsum('bhsd,hdf->bhsf', k, w_phi)
        phi_q = torch.concatenate([_softmax(pq, axis=-1), _softmax(-pq, axis=-1)], axis=-1)
        phi_k = torch.concatenate([_softmax(pk, axis=-1), _softmax(-pk, axis=-1)], axis=-1)
        kv = torch.einsum('bhsf,bhsd->bhfd', phi_k, v)
        z = torch.einsum('bhsf->bhf', phi_k)
        num = torch.einsum('bhqf,bhfd->bhqd', phi_q, kv)
        den = torch.einsum('bhqf,bhf->bhq', phi_q, z)[..., None] + 1e-06
        o = num / den
        return (lambda x, *d: x.permute(*d))(o, 0, 2, 1, 3).reshape(B, S, D) @ wo

    def _B_ref(x, w_in, w_sp, b_sp, w_out):
        B, S, D = x.shape
        F = w_in.shape[-1]
        Fh = F // 2
        z = _gelu(torch.einsum('bsd,df->bsf', x, w_in))
        z1 = z[..., :Fh].clone()
        z2 = _layernorm(z[..., Fh:], axis=-1)
        g = torch.einsum('ts,bsf->btf', w_sp, z2) + b_sp[None, :, None]
        return torch.einsum('bsf,fd->bsd', z1 * g, w_out)
    x = A_x
    mod = (_silu(c) @ w_mod).reshape(c.shape[0], 6, 1, -1)
    sa, ca, ga, sb, cb, gb = (mod[:, 0].clone(), mod[:, 1].clone(), mod[:, 2].clone(), mod[:, 3].clone(), mod[:, 4].clone(), mod[:, 5].clone())
    h = _layernorm(x, axis=-1) * (1 + ca) + sa
    x = x + ga * _A_ref(h, A_wqkv, A_w_phi, A_wo)
    h = _layernorm(x, axis=-1) * (1 + cb) + sb
    x = x + gb * _B_ref(h, B_w_in, B_w_sp, B_b_sp, B_w_out)
    return x
```

```asm
; @launch grid=(256,1,1) block=(256,1,1) lds=163840
.amdgcn_target "amdgcn-amd-amdhsa--gfx950"
.text
.globl adaLN_cond__linear_kernel_hedgehog__mixer_gmlp__prompt_kernel
.p2align 8
.type adaLN_cond__linear_kernel_hedgehog__mixer_gmlp__prompt_kernel,@function
adaLN_cond__linear_kernel_hedgehog__mixer_gmlp__prompt_kernel:
    s_cmp_ge_u32 s2, 256
    s_cbranch_scc1 L_end
    s_load_dwordx16 s[52:67], s[0:1], 0
    s_load_dwordx8 s[68:75], s[0:1], 64
    s_load_dwordx4 s[76:79], s[0:1], 96
    s_lshr_b32 s90, s2, 3
    s_lshl_b32 s90, s90, 12
    v_and_b32 v10, 0xc7, v0
    v_lshrrev_b32 v11, 3, v10
    v_and_b32 v10, 7, v10
    v_add_u32 v10, v10, v11
    v_lshl_add_u32 v10, v10, 7, s90
    v_min_u32 v10, 0x1aca8, v10
    s_getpc_b64 s[98:99]
L_pfbase:
    global_load_dword v32, v10, s[98:99]
    v_and_b32 v1, 63, v0
    v_lshrrev_b32 v3, 6, v0
    v_and_b32 v2, 15, v0
    v_readfirstlane_b32 s82, v3
    v_bfe_u32 v3, v0, 4, 2
    s_and_b32 s88, s2, 7
    s_lshr_b32 s89, s2, 3
    s_lshl_b32 s80, s88, 2
    s_lshr_b32 s81, s89, 3
    s_add_u32 s80, s80, s81
    s_and_b32 s81, s89, 7
    s_mov_b32 s86, 0x3fb8aa3b
    s_mov_b32 s87, 0x3fb8aa3b
    s_mov_b32 s84, 0
    s_sub_u32 s90, s2, 40
    s_mul_i32 s91, s90, 1639
    s_lshr_b32 s91, s91, 16
    s_mul_i32 s92, s91, 40
    s_sub_u32 s92, s90, s92
    s_add_u32 s92, s92, 20
    s_cmp_ge_u32 s2, 20
    s_cselect_b32 s93, 1, 0
    s_cselect_b32 s94, 20, 0
    s_sub_u32 s94, s2, s94
    s_cmp_lt_u32 s2, 40
    s_cselect_b32 s90, s93, s91
    s_cselect_b32 s91, s94, s92
    s_cselect_b32 s94, 10, 4
    s_lshl_b32 s92, s90, 2
    s_add_u32 s92, s92, s82
    s_mul_i32 s92, s92, s94
    s_lshl_b32 s92, s92, 3
    v_lshrrev_b32 v6, 3, v1
    v_mul_u32_u24 v6, s94, v6
    v_and_b32 v7, 7, v1
    v_mul_u32_u24 v35, 7680, v6
    v_lshl_add_u32 v35, v7, 4, v35
    v_lshlrev_b32 v9, 1, v6
    s_mul_i32 s93, s92, 7680
    s_lshl_b32 s94, s91, 7
    s_add_u32 s93, s93, s94
    s_lshl_b32 s92, s92, 1
    v_lshlrev_b32 v5, 4, v1
    v_add_u32 v12, 0x10000, v5
    s_getreg_b32 s3, hwreg(HW_REG_XCC_ID, 0, 4)
    s_lshl_b32 s88, s80, 2
    s_add_u32 s88, s88, s82
    s_lshl_b32 s88, s88, 3
    s_add_u32 s88, s88, s81
    s_mul_i32 s88, s88, 2560
    v_min_u32 v10, 19, v1
    v_lshlrev_b32 v10, 7, v10
    s_waitcnt lgkmcnt(0)
    s_mov_b32 s4, s52
    s_and_b32 s5, s53, 0xffff
    s_mov_b32 s6, 2621440
    s_mov_b32 s7, 0x20000
    s_mov_b32 s40, s70
    s_and_b32 s41, s71, 0xffff
    s_mov_b32 s42, 1280
    s_mov_b32 s43, 0x20000
    s_mov_b32 s36, s72
    s_and_b32 s37, s73, 0xffff
    s_mov_b32 s38, 4915200
    s_mov_b32 s39, 0x20000
    buffer_load_dword v32, v10, s[4:7], s88 offen
    s_mov_b32 s70, s93
    buffer_load_dwordx4 v[208:211], v9, s[40:43], s92 offen
    buffer_load_dword v212, v9, s[40:43], s92 offen offset:16
    s_cmp_lt_u32 s2, 40
    s_cbranch_scc1 L_wm_1
L_wmb_2:
    s_mov_b32 s28, s78
    s_and_b32 s29, s79, 0xffff
    s_mov_b32 s30, 268435456
    s_mov_b32 s31, 0x20000
    s_mov_b32 s8, s54
    s_and_b32 s9, s55, 0xffff
    s_mov_b32 s10, 2457600
    s_mov_b32 s11, 0x20000
    s_mov_b32 s60, s90
    s_mov_b32 s61, s91
    buffer_load_dword v207, off, s[28:31], 0 sc1
    v_mov_b32 v200, -1
    v_mov_b32 v201, -1
    v_mov_b32 v202, -1
    v_mov_b32 v203, -1
    s_lshl_b32 s88, s80, 2
    s_add_u32 s88, s88, s82
    s_lshl_b32 s88, s88, 3
    s_add_u32 s88, s88, s81
    s_lshl_b32 s88, s88, 7
    s_add_u32 s89, s88, 294784
    s_add_u32 s88, s88, 163840
    s_lshl_b32 s90, s81, 13
    s_lshl_b32 s91, s80, 8
    s_add_u32 s90, s90, s91
    s_add_u32 s90, s90, 458496
    s_cmp_lt_u32 s80, 28
    s_cselect_b32 s90, s90, 1073741824
    s_cmp_eq_u32 s82, 0
    s_cselect_b32 s90, s90, 1073741824
    v_mov_b32 v10, 1073741824
    v_mov_b32 v11, s90
    v_cmp_gt_u32 vcc, 32, v1
    s_nop 1
    v_cndmask_b32 v10, v10, v11, vcc
    v_mov_b32 v11, s89
    v_cmp_gt_u32 vcc, 16, v1
    s_nop 1
    v_cndmask_b32 v10, v10, v11, vcc
    v_mov_b32 v11, s88
    v_cmp_gt_u32 vcc, 8, v1
    s_nop 1
    v_cndmask_b32 v10, v10, v11, vcc
    v_add_u32 v10, v10, v5
    buffer_store_dwordx4 v[200:203], v10, s[28:31], 0 offen sc1
    s_mov_b32 s44, s56
    s_and_b32 s45, s57, 0xffff
    s_mov_b32 s46, 25600
    s_mov_b32 s47, 0x20000
    s_mov_b32 s12, s58
    s_and_b32 s13, s59, 0xffff
    s_mov_b32 s14, 819200
    s_mov_b32 s15, 0x20000
    s_mov_b32 s16, s62
    s_and_b32 s17, s63, 0xffff
    s_mov_b32 s18, 1966080
    s_mov_b32 s19, 0x20000
    s_mov_b32 s20, s64
    s_and_b32 s21, s65, 0xffff
    s_mov_b32 s22, 8388608
    s_mov_b32 s23, 0x20000
    s_mov_b32 s48, s66
    s_and_b32 s49, s67, 0xffff
    s_mov_b32 s50, 4096
    s_mov_b32 s51, 0x20000
    s_mov_b32 s24, s68
    s_and_b32 s25, s69, 0xffff
    s_mov_b32 s26, 983040
    s_mov_b32 s27, 0x20000
    s_mov_b32 s32, s74
    s_and_b32 s33, s75, 0xffff
    s_mov_b32 s34, 2621440
    s_mov_b32 s35, 0x20000
    s_mov_b64 s[74:75], s[98:99]
    s_lshl_b32 s88, s82, 10
    s_add_u32 s88, s88, 0xbcac
    s_add_u32 s74, s74, s88
    s_addc_u32 s75, s75, 0
    s_lshl_b32 s95, s2, 2
    s_add_u32 s95, s95, s82
    s_mul_i32 s95, s95, 50
    s_lshr_b32 s95, s95, 2
    v_min_u32 v10, 12, v1
    v_add3_u32 v10, v10, s95, 0
    v_add_u32 v10, 0, v10
    v_mul_u32_u24 v11, 52429, v10
    v_lshrrev_b32 v11, 20, v11
    v_mul_u32_u24 v11, 1280, v11
    v_lshl_add_u32 v10, v10, 7, v11
    buffer_load_dword v32, v10, s[8:11], 0 offen offset:1280
    v_mov_b32 v200, 0
    v_mov_b32 v201, 0
    v_mov_b32 v202, 0
    v_mov_b32 v203, 0
    v_lshlrev_b32 v6, 4, v0
    v_add_u32 v6, 155648, v6
    ds_write_b128 v6, v[200:203]
    v_min_u32 v6, 156784, v6
    ds_write_b128 v6, v[200:203] offset:4096
    s_mul_i32 s52, s82, 20480
    s_add_u32 s52, s52, 61440
    s_mul_i32 s54, s82, 15360
    v_lshrrev_b32 v6, 3, v1
    v_add_u32 v6, 0, v6
    v_lshrrev_b32 v7, 1, v6
    v_xor_b32 v7, v7, v1
    v_and_b32 v7, 7, v7
    v_mul_u32_u24 v6, 1280, v6
    v_lshl_add_u32 v205, v7, 4, v6
    v_lshrrev_b32 v6, 3, v1
    v_add_u32 v6, 8, v6
    v_lshrrev_b32 v7, 1, v6
    v_xor_b32 v7, v7, v1
    v_and_b32 v7, 7, v7
    v_mul_u32_u24 v6, 1280, v6
    v_lshl_add_u32 v206, v7, 4, v6
    v_subrev_u32 v206, 1024, v206
    s_lshl_b32 s55, s80, 2
    s_add_u32 s55, s55, s82
    s_lshl_b32 s56, s55, 5
    s_mul_i32 s55, s55, 20480
    s_mul_i32 s59, s81, 3200
    v_lshlrev_b32 v56, 2, v0
    v_min_u32 v57, 124, v56
    v_lshlrev_b32 v58, 1, v2
    s_cmp_lt_u32 s2, 40
    s_cbranch_scc1 L_roleA_3
    s_mov_b32 s95, 3840
    v_add_u32 v6, 0, v1
    v_mul_u32_u24 v7, 6554, v6
    v_lshrrev_b32 v7, 16, v7
    v_mul_u32_u24 v8, 160, v7
    v_lshlrev_b32 v6, 4, v6
    v_sub_u32 v6, v6, v8
    v_and_b32 v8, 12, v7
    v_add_u32 v8, v8, v7
    v_lshrrev_b32 v7, 4, v7
    v_mul_u32_u24 v7, 12, v7
    v_sub_u32 v7, v8, v7
    v_mad_u32_u24 v24, v7, s95, v6
    v_add_u32 v6, 64, v1
    v_mul_u32_u24 v7, 6554, v6
    v_lshrrev_b32 v7, 16, v7
    v_mul_u32_u24 v8, 160, v7
    v_lshlrev_b32 v6, 4, v6
    v_sub_u32 v6, v6, v8
    v_and_b32 v8, 12, v7
    v_add_u32 v8, v8, v7
    v_lshrrev_b32 v7, 4, v7
    v_mul_u32_u24 v7, 12, v7
    v_sub_u32 v7, v8, v7
    v_mad_u32_u24 v25, v7, s95, v6
    v_subrev_u32 v25, 1024, v25
    v_add_u32 v6, 128, v1
    v_mul_u32_u24 v7, 6554, v6
    v_lshrrev_b32 v7, 16, v7
    v_mul_u32_u24 v8, 160, v7
    v_lshlrev_b32 v6, 4, v6
    v_sub_u32 v6, v6, v8
    v_and_b32 v8, 12, v7
    v_add_u32 v8, v8, v7
    v_lshrrev_b32 v7, 4, v7
    v_mul_u32_u24 v7, 12, v7
    v_sub_u32 v7, v8, v7
    v_mad_u32_u24 v26, v7, s95, v6
    v_subrev_u32 v26, 2048, v26
    v_add_u32 v6, 192, v1
    v_mul_u32_u24 v7, 6554, v6
    v_lshrrev_b32 v7, 16, v7
    v_mul_u32_u24 v8, 160, v7
    v_lshlrev_b32 v6, 4, v6
    v_sub_u32 v6, v6, v8
    v_and_b32 v8, 12, v7
    v_add_u32 v8, v8, v7
    v_lshrrev_b32 v7, 4, v7
    v_mul_u32_u24 v7, 12, v7
    v_sub_u32 v7, v8, v7
    v_mad_u32_u24 v27, v7, s95, v6
    v_subrev_u32 v27, 3072, v27
    v_add_u32 v6, 256, v1
    v_mul_u32_u24 v7, 6554, v6
    v_lshrrev_b32 v7, 16, v7
    v_mul_u32_u24 v8, 160, v7
    v_lshlrev_b32 v6, 4, v6
    v_sub_u32 v6, v6, v8
    v_and_b32 v8, 12, v7
    v_add_u32 v8, v8, v7
    v_lshrrev_b32 v7, 4, v7
    v_mul_u32_u24 v7, 12, v7
    v_sub_u32 v7, v8, v7
    v_mad_u32_u24 v28, v7, s95, v6
    s_lshr_b32 s88, s82, 1
    s_mul_i32 s88, s88, 122880
    s_and_b32 s89, s82, 1
    s_add_u32 s89, s89, 1
    s_mul_i32 s89, s89, 1280
    s_add_u32 s88, s88, s89
    s_mul_i32 s89, s81, 160
    s_add_u32 s53, s88, s89
    s_add_u32 s57, s53, 737280
    v_add_u32 v6, 0, v0
    v_mul_u32_u24 v7, 6554, v6
    v_lshrrev_b32 v7, 16, v7
    v_mul_u32_u24 v8, 10, v7
    v_sub_u32 v8, v6, v8
    v_mul_u32_u24 v9, 205, v7
    v_lshrrev_b32 v9, 12, v9
    v_mul_u32_u24 v10, 20, v9
    v_sub_u32 v7, v7, v10
    v_lshl_add_u32 v10, v8, 1, v10
    v_mul_u32_u24 v10, 48, v10
    v_lshl_add_u32 v10, v7, 1, v10
    v_add_u32 v84, 155648, v10
    v_add_u32 v6, 256, v0
    v_mul_u32_u24 v7, 6554, v6
    v_lshrrev_b32 v7, 16, v7
    v_mul_u32_u24 v8, 10, v7
    v_sub_u32 v8, v6, v8
    v_mul_u32_u24 v9, 205, v7
    v_lshrrev_b32 v9, 12, v9
    v_mul_u32_u24 v10, 20, v9
    v_sub_u32 v7, v7, v10
    v_lshl_add_u32 v10, v8, 1, v10
    v_mul_u32_u24 v10, 48, v10
    v_lshl_add_u32 v10, v7, 1, v10
    v_add_u32 v85, 155648, v10
    v_add_u32 v6, 512, v0
    v_mul_u32_u24 v7, 6554, v6
    v_lshrrev_b32 v7, 16, v7
    v_mul_u32_u24 v8, 10, v7
    v_sub_u32 v8, v6, v8
    v_mul_u32_u24 v9, 205, v7
    v_lshrrev_b32 v9, 12, v9
    v_mul_u32_u24 v10, 20, v9
    v_sub_u32 v7, v7, v10
    v_lshl_add_u32 v10, v8, 1, v10
    v_mul_u32_u24 v10, 48, v10
    v_lshl_add_u32 v10, v7, 1, v10
    v_add_u32 v86, 155648, v10
    v_min_u32 v6, 31, v0
    v_add_u32 v6, 768, v6
    v_mul_u32_u24 v7, 6554, v6
    v_lshrrev_b32 v7, 16, v7
    v_mul_u32_u24 v8, 10, v7
    v_sub_u32 v8, v6, v8
    v_mul_u32_u24 v9, 205, v7
    v_lshrrev_b32 v9, 12, v9
    v_mul_u32_u24 v10, 20, v9
    v_sub_u32 v7, v7, v10
    v_lshl_add_u32 v10, v8, 1, v10
    v_mul_u32_u24 v10, 48, v10
    v_lshl_add_u32 v10, v7, 1, v10
    v_add_u32 v87, 155648, v10
    v_lshrrev_b32 v6, 1, v2
    v_and_b32 v7, 7, v2
    v_lshl_add_u32 v6, v7, 3, v6
    v_lshlrev_b32 v6, 4, v6
    v_lshrrev_b32 v7, 3, v2
    v_lshl_add_u32 v6, v7, 10, v6
    v_add_u32 v6, s52, v6
    v_lshlrev_b32 v7, 4, v3
    v_xor_b32 v93, v6, v7
    v_xor_b32 v94, 64, v93
    v_lshrrev_b32 v7, 1, v3
    v_lshlrev_b32 v7, 4, v7
    v_xor_b32 v6, v6, v7
    v_and_b32 v7, 1, v3
    v_lshl_add_u32 v92, v7, 3, v6
    s_mul_i32 s88, s81, 160
    s_and_b32 s89, s88, 0x60
    s_lshr_b32 s90, s88, 7
    s_lshl_b32 s90, s90, 11
    v_xor_b32 v72, s89, v92
    s_add_u32 s88, s88, 32
    v_add_u32 v72, s90, v72
    s_and_b32 s89, s88, 0x60
    s_lshr_b32 s90, s88, 7
    s_lshl_b32 s90, s90, 11
    v_xor_b32 v73, s89, v92
    s_add_u32 s88, s88, 32
    v_add_u32 v73, s90, v73
    s_and_b32 s89, s88, 0x60
    s_lshr_b32 s90, s88, 7
    s_lshl_b32 s90, s90, 11
    v_xor_b32 v74, s89, v92
    s_add_u32 s88, s88, 32
    v_add_u32 v74, s90, v74
    s_and_b32 s89, s88, 0x60
    s_lshr_b32 s90, s88, 7
    s_lshl_b32 s90, s90, 11
    v_xor_b32 v75, s89, v92
    s_add_u32 s88, s88, 32
    v_add_u32 v75, s90, v75
    s_and_b32 s89, s88, 0x60
    s_lshr_b32 s90, s88, 7
    s_lshl_b32 s90, s90, 11
    v_xor_b32 v76, s89, v92
    s_add_u32 s88, s88, 32
    v_add_u32 v76, s90, v76
    v_bfe_u32 v6, v1, 2, 2
    v_lshl_add_u32 v6, v3, 2, v6
    v_mul_u32_u24 v6, 160, v6
    v_and_b32 v7, 3, v1
    v_mul_u32_u24 v7, 40, v7
    v_add_u32 v29, v6, v7
    v_add_u32 v30, 0x10000, v29
    v_add_u32 v31, 0x20000, v29
    v_lshlrev_b32 v34, 5, v3
    v_add_u32 v34, 143360, v34
    s_lshl_b32 s89, s82, 3
    s_add_u32 s89, s89, s81
    s_lshl_b32 s89, s89, 7
    v_lshl_add_u32 v6, v2, 12, s89
    v_cmp_gt_u32 vcc, 16, v1
    v_mov_b32 v7, 1073741824
    s_nop 0
    v_cndmask_b32 v33, v7, v6, vcc
    v_lshlrev_b32 v88, 4, v0
    v_and_b32 v89, 127, v0
    v_lshlrev_b32 v89, 4, v89
    v_and_b32 v6, 7, v1
    s_and_b32 s88, s80, 3
    s_lshl_b32 s88, s88, 6
    s_lshr_b32 s89, s80, 2
    s_add_u32 s88, s88, s89
    v_lshl_add_u32 v6, v6, 3, s88
    v_lshlrev_b32 v90, 3, v6
    v_lshlrev_b32 v91, 2, v0
    v_add_u32 v91, 143360, v91
    s_add_u32 m0, s52, 0
    s_nop 0
    buffer_load_dwordx4 v205, s[4:7], s55 offen lds
    buffer_load_dwordx4 v206, s[4:7], s55 offen offset:1024 lds
    s_add_u32 m0, s52, 2048
    s_add_u32 s55, s55, 128
    buffer_load_dwordx4 v205, s[4:7], s55 offen lds
    buffer_load_dwordx4 v206, s[4:7], s55 offen offset:1024 lds
    s_add_u32 m0, s52, 4096
    s_add_u32 s55, s55, 128
    buffer_load_dwordx4 v205, s[4:7], s55 offen lds
    buffer_load_dwordx4 v206, s[4:7], s55 offen offset:1024 lds
    s_add_u32 m0, s52, 6144
    s_add_u32 s55, s55, 128
    buffer_load_dwordx4 v205, s[4:7], s55 offen lds
    buffer_load_dwordx4 v206, s[4:7], s55 offen offset:1024 lds
    s_add_u32 m0, s52, 8192
    s_add_u32 s55, s55, 128
    buffer_load_dwordx4 v205, s[4:7], s55 offen lds
    buffer_load_dwordx4 v206, s[4:7], s55 offen offset:1024 lds
    s_add_u32 m0, s52, 10240
    s_add_u32 s55, s55, 128
    buffer_load_dwordx4 v205, s[4:7], s55 offen lds
    buffer_load_dwordx4 v206, s[4:7], s55 offen offset:1024 lds
    s_add_u32 m0, s52, 12288
    s_add_u32 s55, s55, 128
    buffer_load_dwordx4 v205, s[4:7], s55 offen lds
    buffer_load_dwordx4 v206, s[4:7], s55 offen offset:1024 lds
    s_add_u32 m0, s52, 14336
    s_add_u32 s55, s55, 128
    buffer_load_dwordx4 v205, s[4:7], s55 offen lds
    buffer_load_dwordx4 v206, s[4:7], s55 offen offset:1024 lds
    s_add_u32 m0, s52, 16384
    s_add_u32 s55, s55, 128
    buffer_load_dwordx4 v205, s[4:7], s55 offen lds
    buffer_load_dwordx4 v206, s[4:7], s55 offen offset:1024 lds
    s_add_u32 m0, s52, 18432
    s_add_u32 s55, s55, 128
    buffer_load_dwordx4 v205, s[4:7], s55 offen lds
    buffer_load_dwordx4 v206, s[4:7], s55 offen offset:1024 lds
    buffer_load_dword v80, v56, s[44:47], s59 offen offset:0
    buffer_load_dword v81, v56, s[44:47], s59 offen offset:1024
    buffer_load_dword v82, v56, s[44:47], s59 offen offset:2048
    buffer_load_dword v83, v57, s[44:47], s59 offen offset:3072
    buffer_load_ushort v13, v58, s[48:51], s56 offen
    s_waitcnt vmcnt(28)
    v_lshlrev_b32 v190, 16, v208
    v_and_b32 v191, 0xffff0000, v208
    v_lshlrev_b32 v192, 16, v209
    v_and_b32 v193, 0xffff0000, v209
    v_mul_f32 v180, 0xbfb8aa3b, v190
    v_mul_f32 v181, 0xbfb8aa3b, v191
    v_mul_f32 v182, 0xbfb8aa3b, v192
    v_mul_f32 v183, 0xbfb8aa3b, v193
    v_exp_f32 v180, v180
    v_exp_f32 v181, v181
    v_exp_f32 v182, v182
    v_exp_f32 v183, v183
    v_add_f32 v180, 1.0, v180
    v_add_f32 v181, 1.0, v181
    v_add_f32 v182, 1.0, v182
    v_add_f32 v183, 1.0, v183
    v_rcp_f32 v180, v180
    v_rcp_f32 v181, v181
    v_rcp_f32 v182, v182
    v_rcp_f32 v183, v183
    v_mul_f32 v190, v190, v180
    v_mul_f32 v191, v191, v181
    v_mul_f32 v192, v192, v182
    v_mul_f32 v193, v193, v183
    v_cvt_pk_bf16_f32 v180, v190, v191
    v_cvt_pk_bf16_f32 v181, v192, v193
    v_accvgpr_write_b32 a48, v180
    v_accvgpr_write_b32 a49, v181
    s_waitcnt vmcnt(26)
    v_readfirstlane_b32 s88, v207
    s_nop 0
    s_mul_i32 s83, s88, 0x9E3779B1
    s_add_u32 s83, s83, 0x7F4A7C15
    s_waitcnt lgkmcnt(0)
    s_barrier
    s_cmp_lg_u32 s82, 0
    s_cbranch_scc1 L_nb0_4
    v_mov_b32 v8, s3
    v_mov_b32 v9, s83
    s_lshl_b32 s88, s2, 3
    s_add_u32 s88, s88, 4096
    s_mov_b64 exec, 1
    buffer_store_dwordx2 v[8:9], off, s[28:31], s88 sc1
    s_mov_b64 exec, -1
L_nb0_4:
    s_mov_b32 s71, 0
    s_mov_b32 s67, 0
    s_mov_b32 s68, 0
    v_mov_b32 v36, 1073741824
    v_mov_b32 v37, 1073741824
    v_mov_b32 v78, 0
    v_mov_b32 v79, 0
    v_mov_b32 v64, 1073741824
    v_mov_b32 v65, 1073741824
    v_mov_b32 v66, 1073741824
    v_mov_b32 v67, 1073741824
    v_mov_b32 v68, 1073741824
    v_mov_b32 v69, 1073741824
    s_lshl_b32 s62, s2, 2
    s_add_u32 s62, s62, s82
    s_mov_b32 s58, 0
    s_sub_u32 s88, s62, 160
    s_cmp_ge_u32 s88, 832
    s_cbranch_scc1 L_nounit_6
    s_cmp_ge_u32 s88, 672
    s_cbranch_scc1 L_uq_10
    s_cmp_ge_u32 s88, 192
    s_cbranch_scc1 L_uw2_7
    s_mul_i32 s89, s88, 2731
    s_lshr_b32 s89, s89, 16
    s_mul_i32 s91, s89, 24
    s_sub_u32 s91, s88, s91
    s_mul_i32 s67, s88, 5120
    s_add_u32 s67, s67, 18644992
    s_mul_i32 s68, s91, 40960
    s_mul_i32 s89, s89, 160
    s_add_u32 s68, s68, s89
    s_mov_b32 s64, 10
    s_mov_b32 s65, 6554
    s_mov_b32 s66, 0
    s_mov_b32 s63, 3
    s_mov_b32 s69, 1280
    s_mov_b64 s[40:41], s[24:25]
    s_mov_b32 s42, 983040
    s_branch L_udec_9
L_uw2_7:
    s_sub_u32 s88, s88, 192
    s_mul_i32 s89, s88, 3277
    s_lshr_b32 s89, s89, 16
    s_mul_i32 s91, s89, 20
    s_sub_u32 s91, s88, s91
    s_mul_i32 s92, s91, 52
    s_lshr_b32 s92, s92, 8
    s_mul_i32 s93, s92, 5
    s_sub_u32 s93, s91, s93
    s_mul_i32 s90, s92, 160
    s_bfe_u32 s92, s93, 0x10001
    s_mul_i32 s92, s92, 80
    s_add_u32 s90, s90, s92
    s_and_b32 s92, s93, 1
    s_lshr_b32 s93, s93, 2
    s_lshl_b32 s94, s93, 1
    s_add_u32 s92, s92, s94
    s_cmp_lt_u32 s88, 160
    s_cbranch_scc1 L_uwo_8
    s_lshl_b32 s92, s92, 5
    s_add_u32 s90, s90, s92
    s_sub_u32 s89, s89, 8
    s_sub_u32 s67, s88, 160
    s_mul_i32 s67, s67, 6144
    s_add_u32 s67, s67, 19628032
    s_mul_i32 s68, s90, 3072
    s_and_b32 s92, s89, 1
    s_mul_i32 s92, s92, 1536
    s_add_u32 s68, s68, s92
    s_lshr_b32 s92, s89, 1
    s_mul_i32 s92, s92, 192
    s_add_u32 s68, s68, s92
    s_mov_b32 s64, 12
    s_mov_b32 s65, 5462
    s_lshl_b32 s66, s93, 6
    s_mov_b32 s63, 4
    s_mov_b32 s69, 3072
    s_mov_b64 s[40:41], s[16:17]
    s_mov_b32 s42, 1966080
    s_branch L_udec_9
L_uwo_8:
    s_lshl_b32 s92, s92, 3
    s_add_u32 s90, s90, s92
    s_mul_i32 s67, s88, 5120
    s_add_u32 s67, s67, 17825792
    s_mul_i32 s68, s90, 1280
    s_mul_i32 s92, s89, 160
    s_add_u32 s68, s68, s92
    s_mov_b32 s64, 10
    s_mov_b32 s65, 6554
    s_mov_b32 s69, 1280
    s_sub_u32 s63, 3, s93
    s_cmp_eq_u32 s93, 0
    s_cselect_b32 s66, 12, 16
    s_mov_b64 s[40:41], s[12:13]
    s_mov_b32 s42, 819200
L_udec_9:
    s_mov_b32 s71, 1
    s_add_u32 s91, s54, 9216
    v_mov_b32 v11, 1073741824
    v_add_u32 v6, 0, v1
    v_mul_u32_u24 v7, s65, v6
    v_lshrrev_b32 v7, 16, v7
    v_cmp_gt_u32 vcc, 32, v7
    v_mul_u32_u24 v8, s64, v7
    v_sub_u32 v6, v6, v8
    v_lshrrev_b32 v8, s63, v7
    v_mad_u32_u24 v8, v8, s66, v7
    v_mul_u32_u24 v8, s69, v8
    v_lshl_add_u32 v6, v6, 4, v8
    v_cndmask_b32 v64, v11, v6, vcc
    v_add_u32 v6, 64, v1
    v_mul_u32_u24 v7, s65, v6
    v_lshrrev_b32 v7, 16, v7
    v_cmp_gt_u32 vcc, 32, v7
    v_mul_u32_u24 v8, s64, v7
    v_sub_u32 v6, v6, v8
    v_lshrrev_b32 v8, s63, v7
    v_mad_u32_u24 v8, v8, s66, v7
    v_mul_u32_u24 v8, s69, v8
    v_lshl_add_u32 v6, v6, 4, v8
    v_cndmask_b32 v65, v11, v6, vcc
    v_add_u32 v6, 128, v1
    v_mul_u32_u24 v7, s65, v6
    v_lshrrev_b32 v7, 16, v7
    v_cmp_gt_u32 vcc, 32, v7
    v_mul_u32_u24 v8, s64, v7
    v_sub_u32 v6, v6, v8
    v_lshrrev_b32 v8, s63, v7
    v_mad_u32_u24 v8, v8, s66, v7
    v_mul_u32_u24 v8, s69, v8
    v_lshl_add_u32 v6, v6, 4, v8
    v_cndmask_b32 v66, v11, v6, vcc
    v_add_u32 v6, 192, v1
    v_mul_u32_u24 v7, s65, v6
    v_lshrrev_b32 v7, 16, v7
    v_cmp_gt_u32 vcc, 32, v7
    v_mul_u32_u24 v8, s64, v7
    v_sub_u32 v6, v6, v8
    v_lshrrev_b32 v8, s63, v7
    v_mad_u32_u24 v8, v8, s66, v7
    v_mul_u32_u24 v8, s69, v8
    v_lshl_add_u32 v6, v6, 4, v8
    v_cndmask_b32 v67, v11, v6, vcc
    v_add_u32 v6, 256, v1
    v_mul_u32_u24 v7, s65, v6
    v_lshrrev_b32 v7, 16, v7
    v_cmp_gt_u32 vcc, 32, v7
    v_mul_u32_u24 v8, s64, v7
    v_sub_u32 v6, v6, v8
    v_lshrrev_b32 v8, s63, v7
    v_mad_u32_u24 v8, v8, s66, v7
    v_mul_u32_u24 v8, s69, v8
    v_lshl_add_u32 v6, v6, 4, v8
    v_cndmask_b32 v68, v11, v6, vcc
    v_add_u32 v6, 320, v1
    v_mul_u32_u24 v7, s65, v6
    v_lshrrev_b32 v7, 16, v7
    v_cmp_gt_u32 vcc, 32, v7
    v_mul_u32_u24 v8, s64, v7
    v_sub_u32 v6, v6, v8
    v_lshrrev_b32 v8, s63, v7
    v_mad_u32_u24 v8, v8, s66, v7
    v_mul_u32_u24 v8, s69, v8
    v_lshl_add_u32 v6, v6, 4, v8
    v_cndmask_b32 v69, v11, v6, vcc
    s_lshl_b32 s88, s64, 4
    s_mul_i32 s93, s58, 12
    s_add_u32 s93, s93, s66
    s_lshl_b32 s94, s58, 5
    s_add_u32 s94, s94, 8
    s_cmp_eq_u32 s93, 12
    s_cselect_b32 s89, 8, 4
    s_cselect_b32 s90, 4, 16
    s_mul_i32 s90, s90, s88
    v_bfe_u32 v78, v1, 2, 2
    v_mad_u32_u24 v78, v3, s89, v78
    v_mul_u32_u24 v78, s88, v78
    v_and_b32 v79, 3, v1
    v_mad_u32_u24 v78, v79, s94, v78
    v_add_u32 v78, s91, v78
    v_add_u32 v79, s90, v78
    v_mov_b32 v36, v5
    s_cmp_eq_u32 s64, 10
    s_cselect_b32 s92, 1073741824, 0
    v_add_u32 v37, s92, v5
L_nounit_6:
    s_cmp_eq_u32 s71, 0
    s_cbranch_scc1 L_u0_11
    s_add_u32 s91, s54, 9216
    s_add_u32 m0, s91, 0
    s_nop 0
    buffer_load_dwordx4 v64, s[40:43], s68 offen lds
    s_add_u32 m0, s91, 1024
    s_nop 0
    buffer_load_dwordx4 v65, s[40:43], s68 offen lds
    s_add_u32 m0, s91, 2048
    s_nop 0
    buffer_load_dwordx4 v66, s[40:43], s68 offen lds
    s_add_u32 m0, s91, 3072
    s_nop 0
    buffer_load_dwordx4 v67, s[40:43], s68 offen lds
    s_add_u32 m0, s91, 4096
    s_nop 0
    buffer_load_dwordx4 v68, s[40:43], s68 offen lds
    s_add_u32 m0, s91, 5120
    s_nop 0
    buffer_load_dwordx4 v69, s[40:43], s68 offen lds
    s_add_u32 s68, s67, 4096
    s_waitcnt vmcnt(6)
L_u1_12:
    ds_read_b64 v[14:15], v72
    ds_read_b64 v[16:17], v73
    ds_read_b64 v[18:19], v74
    ds_read_b64 v[20:21], v75
    ds_read_b64 v[22:23], v76
    ds_write_b16 v84, v80
    ds_write_b16_d16_hi v84, v80 offset:48
    ds_write_b16 v85, v81
    ds_write_b16_d16_hi v85, v81 offset:48
    ds_write_b16 v86, v82
    ds_write_b16_d16_hi v86, v82 offset:48
    ds_write_b16 v87, v83
    ds_write_b16_d16_hi v87, v83 offset:48
    v_lshlrev_b32 v13, 16, v13
    global_load_dwordx4 v[72:75], v5, s[74:75]
    s_add_u32 s74, s74, 4096
    s_addc_u32 s75, s75, 0
    v_mov_b32 v68, 0x3f803f80
    v_mov_b32 v69, 0x3f803f80
    v_mov_b32 v70, 0x3f803f80
    v_mov_b32 v71, 0x3f803f80
    s_waitcnt lgkmcnt(0)
    ds_read_b128 v[100:103], v93 offset:0
    ds_read_b128 v[108:111], v94 offset:0
    ds_read_b128 v[116:119], v93 offset:2048
    ds_read_b128 v[124:127], v94 offset:2048
    ds_read_b128 v[132:135], v93 offset:4096
    ds_read_b128 v[140:143], v94 offset:4096
    s_waitcnt lgkmcnt(5)
    v_mfma_f32_16x16x32_bf16 v[60:63], v[68:71], v[100:103], 0
    ds_read_b128 v[148:151], v93 offset:6144
    v_mfma_f32_16x16x32_bf16 v[64:67], v[100:103], v[100:103], 0
    v_lshlrev_b32 v96, 16, v100
    v_and_b32 v97, 0xffff0000, v100
    v_lshlrev_b32 v98, 16, v101
    v_and_b32 v99, 0xffff0000, v101
    v_lshlrev_b32 v100, 16, v102
    v_and_b32 v101, 0xffff0000, v102
    v_lshlrev_b32 v102, 16, v103
    v_and_b32 v103, 0xffff0000, v103
    s_waitcnt lgkmcnt(5)
    v_mfma_f32_16x16x32_bf16 v[60:63], v[68:71], v[108:111], v[60:63]
    ds_read_b128 v[156:159], v94 offset:6144
    v_mfma_f32_16x16x32_bf16 v[64:67], v[108:111], v[108:111], v[64:67]
    v_lshlrev_b32 v104, 16, v108
    v_and_b32 v105, 0xffff0000, v108
    v_lshlrev_b32 v106, 16, v109
    v_and_b32 v107, 0xffff0000, v109
    v_lshlrev_b32 v108, 16, v110
    v_and_b32 v109, 0xffff0000, v110
    v_lshlrev_b32 v110, 16, v111
    v_and_b32 v111, 0xffff0000, v111
    s_add_u32 m0, s54, 0
    s_nop 0
    buffer_load_dwordx4 v24, s[8:11], s53 offen offset:0 lds
    s_waitcnt lgkmcnt(5)
    v_mfma_f32_16x16x32_bf16 v[60:63], v[68:71], v[116:119], v[60:63]
    ds_read_b128 v[164:167], v93 offset:8192
    v_mfma_f32_16x16x32_bf16 v[64:67], v[116:119], v[116:119], v[64:67]
    v_lshlrev_b32 v112, 16, v116
    v_and_b32 v113, 0xffff0000, v116
    v_lshlrev_b32 v114, 16, v117
    v_and_b32 v115, 0xffff0000, v117
    v_lshlrev_b32 v116, 16, v118
    v_and_b32 v117, 0xffff0000, v118
    v_lshlrev_b32 v118, 16, v119
    v_and_b32 v119, 0xffff0000, v119
    s_waitcnt lgkmcnt(5)
    v_mfma_f32_16x16x32_bf16 v[60:63], v[68:71], v[124:127], v[60:63]
    ds_read_b128 v[172:175], v94 offset:8192
    v_mfma_f32_16x16x32_bf16 v[64:67], v[124:127], v[124:127], v[64:67]
    v_lshlrev_b32 v120, 16, v124
    v_and_b32 v121, 0xffff0000, v124
    v_lshlrev_b32 v122, 16, v125
    v_and_b32 v123, 0xffff0000, v125
    v_lshlrev_b32 v124, 16, v126
    v_and_b32 v125, 0xffff0000, v126
    v_lshlrev_b32 v126, 16, v127
    v_and_b32 v127, 0xffff0000, v127
    buffer_load_dwordx4 v25, s[8:11], s53 offen offset:1024 lds
    s_waitcnt lgkmcnt(5)
    v_mfma_f32_16x16x32_bf16 v[60:63], v[68:71], v[132:135], v[60:63]
    ds_read_b128 v[180:183], v93 offset:10240
    v_mfma_f32_16x16x32_bf16 v[64:67], v[132:135], v[132:135], v[64:67]
    v_lshlrev_b32 v128, 16, v132
    v_and_b32 v129, 0xffff0000, v132
    v_lshlrev_b32 v130, 16, v133
    v_and_b32 v131, 0xffff0000, v133
    v_lshlrev_b32 v132, 16, v134
    v_and_b32 v133, 0xffff0000, v134
    v_lshlrev_b32 v134, 16, v135
    v_and_b32 v135, 0xffff0000, v135
    s_waitcnt lgkmcnt(5)
    v_mfma_f32_16x16x32_bf16 v[60:63], v[68:71], v[140:143], v[60:63]
    ds_read_b128 v[188:191], v94 offset:10240
    v_mfma_f32_16x16x32_bf16 v[64:67], v[140:143], v[140:143], v[64:67]
    v_lshlrev_b32 v136, 16, v140
    v_and_b32 v137, 0xffff0000, v140
    v_lshlrev_b32 v138, 16, v141
    v_and_b32 v139, 0xffff0000, v141
    v_lshlrev_b32 v140, 16, v142
    v_and_b32 v141, 0xffff0000, v142
    v_lshlrev_b32 v142, 16, v143
    v_and_b32 v143, 0xffff0000, v143
    buffer_load_dwordx4 v26, s[8:11], s53 offen offset:2048 lds
    s_waitcnt lgkmcnt(5)
    v_mfma_f32_16x16x32_bf16 v[60:63], v[68:71], v[148:151], v[60:63]
    ds_read_b128 v[196:199], v93 offset:12288
    v_mfma_f32_16x16x32_bf16 v[64:67], v[148:151], v[148:151], v[64:67]
    v_lshlrev_b32 v144, 16, v148
    v_and_b32 v145, 0xffff0000, v148
    v_lshlrev_b32 v146, 16, v149
    v_and_b32 v147, 0xffff0000, v149
    v_lshlrev_b32 v148, 16, v150
    v_and_b32 v149, 0xffff0000, v150
    v_lshlrev_b32 v150, 16, v151
    v_and_b32 v151, 0xffff0000, v151
    s_waitcnt lgkmcnt(5)
    v_mfma_f32_16x16x32_bf16 v[60:63], v[68:71], v[156:159], v[60:63]
    ds_read_b128 v[204:207], v94 offset:12288
    v_mfma_f32_16x16x32_bf16 v[64:67], v[156:159], v[156:159], v[64:67]
    v_lshlrev_b32 v152, 16, v156
    v_and_b32 v153, 0xffff0000, v156
    v_lshlrev_b32 v154, 16, v157
    v_and_b32 v155, 0xffff0000, v157
    v_lshlrev_b32 v156, 16, v158
    v_and_b32 v157, 0xffff0000, v158
    v_lshlrev_b32 v158, 16, v159
    v_and_b32 v159, 0xffff0000, v159
    buffer_load_dwordx4 v27, s[8:11], s53 offen offset:3072 lds
    s_add_u32 m0, s54, 4096
    s_waitcnt lgkmcnt(5)
    v_mfma_f32_16x16x32_bf16 v[60:63], v[68:71], v[164:167], v[60:63]
    ds_read_b128 v[212:215], v93 offset:14336
    v_mfma_f32_16x16x32_bf16 v[64:67], v[164:167], v[164:167], v[64:67]
    v_lshlrev_b32 v160, 16, v164
    v_and_b32 v161, 0xffff0000, v164
    v_lshlrev_b32 v162, 16, v165
    v_and_b32 v163, 0xffff0000, v165
    v_lshlrev_b32 v164, 16, v166
    v_and_b32 v165, 0xffff0000, v166
    v_lshlrev_b32 v166, 16, v167
    v_and_b32 v167, 0xffff0000, v167
    s_waitcnt lgkmcnt(5)
    v_mfma_f32_16x16x32_bf16 v[60:63], v[68:71], v[172:175], v[60:63]
    ds_read_b128 v[220:223], v94 offset:14336
    v_mfma_f32_16x16x32_bf16 v[64:67], v[172:175], v[172:175], v[64:67]
    v_lshlrev_b32 v168, 16, v172
    v_and_b32 v169, 0xffff0000, v172
    v_lshlrev_b32 v170, 16, v173
    v_and_b32 v171, 0xffff0000, v173
    v_lshlrev_b32 v172, 16, v174
    v_and_b32 v173, 0xffff0000, v174
    v_lshlrev_b32 v174, 16, v175
    v_and_b32 v175, 0xffff0000, v175
    buffer_load_dwordx4 v28, s[8:11], s53 offen offset:0 lds
    s_add_u32 s53, s53, 245760
    s_add_u32 m0, s52, 0
    s_waitcnt lgkmcnt(5)
    v_mfma_f32_16x16x32_bf16 v[60:63], v[68:71], v[180:183], v[60:63]
    ds_read_b128 v[228:231], v93 offset:16384
    v_mfma_f32_16x16x32_bf16 v[64:67], v[180:183], v[180:183], v[64:67]
    v_lshlrev_b32 v176, 16, v180
    v_and_b32 v177, 0xffff0000, v180
    v_lshlrev_b32 v178, 16, v181
    v_and_b32 v179, 0xffff0000, v181
    v_lshlrev_b32 v180, 16, v182
    v_and_b32 v181, 0xffff0000, v182
    v_lshlrev_b32 v182, 16, v183
    v_and_b32 v183, 0xffff0000, v183
    s_waitcnt lgkmcnt(5)
    v_mfma_f32_16x16x32_bf16 v[60:63], v[68:71], v[188:191], v[60:63]
    ds_read_b128 v[236:239], v94 offset:16384
    v_mfma_f32_16x16x32_bf16 v[64:67], v[188:191], v[188:191], v[64:67]
    v_lshlrev_b32 v184, 16, v188
    v_and_b32 v185, 0xffff0000, v188
    v_lshlrev_b32 v186, 16, v189
    v_and_b32 v187, 0xffff0000, v189
    v_lshlrev_b32 v188, 16, v190
    v_and_b32 v189, 0xffff0000, v190
    v_lshlrev_b32 v190, 16, v191
    v_and_b32 v191, 0xffff0000, v191
    buffer_load_dwordx4 v24, s[8:11], s57 offen offset:0 lds
    s_waitcnt lgkmcnt(5)
    v_mfma_f32_16x16x32_bf16 v[60:63], v[68:71], v[196:199], v[60:63]
    ds_read_b128 v[244:247], v93 offset:18432
    v_mfma_f32_16x16x32_bf16 v[64:67], v[196:199], v[196:199], v[64:67]
    v_lshlrev_b32 v192, 16, v196
    v_and_b32 v193, 0xffff0000, v196
    v_lshlrev_b32 v194, 16, v197
    v_and_b32 v195, 0xffff0000, v197
    v_lshlrev_b32 v196, 16, v198
    v_and_b32 v197, 0xffff0000, v198
    v_lshlrev_b32 v198, 16, v199
    v_and_b32 v199, 0xffff0000, v199
    s_waitcnt lgkmcnt(5)
    v_mfma_f32_16x16x32_bf16 v[60:63], v[68:71], v[204:207], v[60:63]
    ds_read_b128 v[252:255], v94 offset:18432
    v_mfma_f32_16x16x32_bf16 v[64:67], v[204:207], v[204:207], v[64:67]
    v_lshlrev_b32 v200, 16, v204
    v_and_b32 v201, 0xffff0000, v204
    v_lshlrev_b32 v202, 16, v205
    v_and_b32 v203, 0xffff0000, v205
    v_lshlrev_b32 v204, 16, v206
    v_and_b32 v205, 0xffff0000, v206
    v_lshlrev_b32 v206, 16, v207
    v_and_b32 v207, 0xffff0000, v207
    buffer_load_dwordx4 v25, s[8:11], s57 offen offset:1024 lds
    s_waitcnt lgkmcnt(5)
    v_mfma_f32_16x16x32_bf16 v[60:63], v[68:71], v[212:215], v[60:63]
    v_mfma_f32_16x16x32_bf16 v[64:67], v[212:215], v[212:215], v[64:67]
    v_lshlrev_b32 v208, 16, v212
    v_and_b32 v209, 0xffff0000, v212
    v_lshlrev_b32 v210, 16, v213
    v_and_b32 v211, 0xffff0000, v213
    v_lshlrev_b32 v212, 16, v214
    v_and_b32 v213, 0xffff0000, v214
    v_lshlrev_b32 v214, 16, v215
    v_and_b32 v215, 0xffff0000, v215
    s_waitcnt lgkmcnt(4)
    v_mfma_f32_16x16x32_bf16 v[60:63], v[68:71], v[220:223], v[60:63]
    v_mfma_f32_16x16x32_bf16 v[64:67], v[220:223], v[220:223], v[64:67]
    v_lshlrev_b32 v216, 16, v220
    v_and_b32 v217, 0xffff0000, v220
    v_lshlrev_b32 v218, 16, v221
    v_and_b32 v219, 0xffff0000, v221
    v_lshlrev_b32 v220, 16, v222
    v_and_b32 v221, 0xffff0000, v222
    v_lshlrev_b32 v222, 16, v223
    v_and_b32 v223, 0xffff0000, v223
    buffer_load_dwordx4 v26, s[8:11], s57 offen offset:2048 lds
    s_waitcnt lgkmcnt(3)
    v_mfma_f32_16x16x32_bf16 v[60:63], v[68:71], v[228:231], v[60:63]
    v_mfma_f32_16x16x32_bf16 v[64:67], v[228:231], v[228:231], v[64:67]
    v_lshlrev_b32 v224, 16, v228
    v_and_b32 v225, 0xffff0000, v228
    v_lshlrev_b32 v226, 16, v229
    v_and_b32 v227, 0xffff0000, v229
    v_lshlrev_b32 v228, 16, v230
    v_and_b32 v229, 0xffff0000, v230
    v_lshlrev_b32 v230, 16, v231
    v_and_b32 v231, 0xffff0000, v231
    s_waitcnt lgkmcnt(2)
    v_mfma_f32_16x16x32_bf16 v[60:63], v[68:71], v[236:239], v[60:63]
    v_mfma_f32_16x16x32_bf16 v[64:67], v[236:239], v[236:239], v[64:67]
    v_lshlrev_b32 v232, 16, v236
    v_and_b32 v233, 0xffff0000, v236
    v_lshlrev_b32 v234, 16, v237
    v_and_b32 v235, 0xffff0000, v237
    v_lshlrev_b32 v236, 16, v238
    v_and_b32 v237, 0xffff0000, v238
    v_lshlrev_b32 v238, 16, v239
    v_and_b32 v239, 0xffff0000, v239
    buffer_load_dwordx4 v27, s[8:11], s57 offen offset:3072 lds
    s_add_u32 m0, s52, 4096
    s_waitcnt lgkmcnt(1)
    v_mfma_f32_16x16x32_bf16 v[60:63], v[68:71], v[244:247], v[60:63]
    v_mfma_f32_16x16x32_bf16 v[64:67], v[244:247], v[244:247], v[64:67]
    v_lshlrev_b32 v240, 16, v244
    v_and_b32 v241, 0xffff0000, v244
    v_lshlrev_b32 v242, 16, v245
    v_and_b32 v243, 0xffff0000, v245
    v_lshlrev_b32 v244, 16, v246
    v_and_b32 v245, 0xffff0000, v246
    v_lshlrev_b32 v246, 16, v247
    v_and_b32 v247, 0xffff0000, v247
    s_waitcnt lgkmcnt(0)
    v_mfma_f32_16x16x32_bf16 v[60:63], v[68:71], v[252:255], v[60:63]
    v_mfma_f32_16x16x32_bf16 v[64:67], v[252:255], v[252:255], v[64:67]
    v_lshlrev_b32 v248, 16, v252
    v_and_b32 v249, 0xffff0000, v252
    v_lshlrev_b32 v250, 16, v253
    v_and_b32 v251, 0xffff0000, v253
    v_lshlrev_b32 v252, 16, v254
    v_and_b32 v253, 0xffff0000, v254
    v_lshlrev_b32 v254, 16, v255
    v_and_b32 v255, 0xffff0000, v255
    buffer_load_dwordx4 v28, s[8:11], s57 offen offset:0 lds
    s_add_u32 s57, s57, 245760
    v_and_b32 v6, 1, v2
    v_cmp_eq_u32 vcc, 1, v6
    v_and_b32 v6, 2, v2
    v_cmp_eq_u32 s[88:89], 2, v6
    v_lshrrev_b32 v6, 2, v2
    v_cndmask_b32 v64, v64, v65, vcc
    v_cndmask_b32 v66, v66, v67, vcc
    v_cmp_eq_u32 vcc, v6, v3
    v_cndmask_b32 v64, v64, v66, s[88:89]
    s_nop 0
    v_cndmask_b32 v64, 0, v64, vcc
    v_mov_b32 v6, v64
    s_nop 1
    v_permlane32_swap_b32 v64, v6
    v_add_f32 v64, v64, v6
    v_mov_b32 v6, v64
    s_nop 1
    v_permlane16_swap_b32 v64, v6
    v_add_f32 v64, v64, v6
    v_mul_f32 v60, 0x3acccccd, v60
    v_mul_f32 v64, 0x3acccccd, v64
    v_fma_f32 v64, -v60, v60, v64
    v_max_f32 v64, 0, v64
    v_add_f32 v64, 0x3727c5ac, v64
    v_rsq_f32 v6, v64
    s_nop 0
    v_mul_f32 v7, -v60, v6
    s_waitcnt lgkmcnt(0)
    s_mov_b32 s90, 8192
    s_mov_b32 s91, 12288
    s_mov_b32 s92, 16384
    s_mov_b32 s93, 20480
    s_mov_b32 s94, 24576
    s_mov_b32 s95, 4096
    v_pk_fma_f32 v[96:97], v[96:97], v[6:7], v[6:7] op_sel:[0,0,1] op_sel_hi:[1,0,1]
    v_pk_fma_f32 v[98:99], v[98:99], v[6:7], v[6:7] op_sel:[0,0,1] op_sel_hi:[1,0,1]
    v_pk_fma_f32 v[100:101], v[100:101], v[6:7], v[6:7] op_sel:[0,0,1] op_sel_hi:[1,0,1]
    v_pk_fma_f32 v[102:103], v[102:103], v[6:7], v[6:7] op_sel:[0,0,1] op_sel_hi:[1,0,1]
    v_pk_fma_f32 v[104:105], v[104:105], v[6:7], v[6:7] op_sel:[0,0,1] op_sel_hi:[1,0,1]
    v_pk_fma_f32 v[106:107], v[106:107], v[6:7], v[6:7] op_sel:[0,0,1] op_sel_hi:[1,0,1]
    s_add_u32 m0, s52, 5120
    s_nop 0
    buffer_load_dwordx4 v24, s[8:11], s57 offen offset:0 lds
    v_pk_fma_f32 v[108:109], v[108:109], v[6:7], v[6:7] op_sel:[0,0,1] op_sel_hi:[1,0,1]
    v_pk_fma_f32 v[110:111], v[110:111], v[6:7], v[6:7] op_sel:[0,0,1] op_sel_hi:[1,0,1]
    v_pk_fma_f32 v[112:113], v[112:113], v[6:7], v[6:7] op_sel:[0,0,1] op_sel_hi:[1,0,1]
    v_pk_fma_f32 v[114:115], v[114:115], v[6:7], v[6:7] op_sel:[0,0,1] op_sel_hi:[1,0,1]
    v_pk_fma_f32 v[116:117], v[116:117], v[6:7], v[6:7] op_sel:[0,0,1] op_sel_hi:[1,0,1]
    v_pk_fma_f32 v[118:119], v[118:119], v[6:7], v[6:7] op_sel:[0,0,1] op_sel_hi:[1,0,1]
    buffer_load_dwordx4 v25, s[8:11], s57 offen offset:1024 lds
    v_pk_fma_f32 v[120:121], v[120:121], v[6:7], v[6:7] op_sel:[0,0,1] op_sel_hi:[1,0,1]
    v_pk_fma_f32 v[122:123], v[122:123], v[6:7], v[6:7] op_sel:[0,0,1] op_sel_hi:[1,0,1]
    v_pk_fma_f32 v[124:125], v[124:125], v[6:7], v[6:7] op_sel:[0,0,1] op_sel_hi:[1,0,1]
    v_pk_fma_f32 v[126:127], v[126:127], v[6:7], v[6:7] op_sel:[0,0,1] op_sel_hi:[1,0,1]
    v_pk_fma_f32 v[128:129], v[128:129], v[6:7], v[6:7] op_sel:[0,0,1] op_sel_hi:[1,0,1]
    v_pk_fma_f32 v[130:131], v[130:131], v[6:7], v[6:7] op_sel:[0,0,1] op_sel_hi:[1,0,1]
    buffer_load_dwordx4 v26, s[8:11], s57 offen offset:2048 lds
    v_pk_fma_f32 v[132:133], v[132:133], v[6:7], v[6:7] op_sel:[0,0,1] op_sel_hi:[1,0,1]
    v_pk_fma_f32 v[134:135], v[134:135], v[6:7], v[6:7] op_sel:[0,0,1] op_sel_hi:[1,0,1]
    v_pk_fma_f32 v[136:137], v[136:137], v[6:7], v[6:7] op_sel:[0,0,1] op_sel_hi:[1,0,1]
    v_pk_fma_f32 v[138:139], v[138:139], v[6:7], v[6:7] op_sel:[0,0,1] op_sel_hi:[1,0,1]
    v_pk_fma_f32 v[140:141], v[140:141], v[6:7], v[6:7] op_sel:[0,0,1] op_sel_hi:[1,0,1]
    v_pk_fma_f32 v[142:143], v[142:143], v[6:7], v[6:7] op_sel:[0,0,1] op_sel_hi:[1,0,1]
    buffer_load_dwordx4 v27, s[8:11], s57 offen offset:3072 lds
    s_add_u32 m0, s52, 9216
    v_pk_fma_f32 v[144:145], v[144:145], v[6:7], v[6:7] op_sel:[0,0,1] op_sel_hi:[1,0,1]
    v_pk_fma_f32 v[146:147], v[146:147], v[6:7], v[6:7] op_sel:[0,0,1] op_sel_hi:[1,0,1]
    v_pk_fma_f32 v[148:149], v[148:149], v[6:7], v[6:7] op_sel:[0,0,1] op_sel_hi:[1,0,1]
    v_pk_fma_f32 v[150:151], v[150:151], v[6:7], v[6:7] op_sel:[0,0,1] op_sel_hi:[1,0,1]
    v_pk_fma_f32 v[152:153], v[152:153], v[6:7], v[6:7] op_sel:[0,0,1] op_sel_hi:[1,0,1]
    v_pk_fma_f32 v[154:155], v[154:155], v[6:7], v[6:7] op_sel:[0,0,1] op_sel_hi:[1,0,1]
    buffer_load_dwordx4 v28, s[8:11], s57 offen offset:0 lds
    s_add_u32 s57, s57, 245760
    v_pk_fma_f32 v[156:157], v[156:157], v[6:7], v[6:7] op_sel:[0,0,1] op_sel_hi:[1,0,1]
    v_pk_fma_f32 v[158:159], v[158:159], v[6:7], v[6:7] op_sel:[0,0,1] op_sel_hi:[1,0,1]
    v_pk_fma_f32 v[160:161], v[160:161], v[6:7], v[6:7] op_sel:[0,0,1] op_sel_hi:[1,0,1]
    v_pk_fma_f32 v[162:163], v[162:163], v[6:7], v[6:7] op_sel:[0,0,1] op_sel_hi:[1,0,1]
    v_pk_fma_f32 v[164:165], v[164:165], v[6:7], v[6:7] op_sel:[0,0,1] op_sel_hi:[1,0,1]
    v_pk_fma_f32 v[166:167], v[166:167], v[6:7], v[6:7] op_sel:[0,0,1] op_sel_hi:[1,0,1]
    buffer_load_dwordx4 v[40:43], v88, s[28:31], s90 offen sc1
    v_pk_fma_f32 v[168:169], v[168:169], v[6:7], v[6:7] op_sel:[0,0,1] op_sel_hi:[1,0,1]
    v_pk_fma_f32 v[170:171], v[170:171], v[6:7], v[6:7] op_sel:[0,0,1] op_sel_hi:[1,0,1]
    v_pk_fma_f32 v[172:173], v[172:173], v[6:7], v[6:7] op_sel:[0,0,1] op_sel_hi:[1,0,1]
    v_pk_fma_f32 v[174:175], v[174:175], v[6:7], v[6:7] op_sel:[0,0,1] op_sel_hi:[1,0,1]
    v_pk_fma_f32 v[176:177], v[176:177], v[6:7], v[6:7] op_sel:[0,0,1] op_sel_hi:[1,0,1]
    v_pk_fma_f32 v[178:179], v[178:179], v[6:7], v[6:7] op_sel:[0,0,1] op_sel_hi:[1,0,1]
    buffer_load_dwordx4 v[44:47], v88, s[28:31], s91 offen sc1
    v_pk_fma_f32 v[180:181], v[180:181], v[6:7], v[6:7] op_sel:[0,0,1] op_sel_hi:[1,0,1]
    v_pk_fma_f32 v[182:183], v[182:183], v[6:7], v[6:7] op_sel:[0,0,1] op_sel_hi:[1,0,1]
    v_pk_fma_f32 v[184:185], v[184:185], v[6:7], v[6:7] op_sel:[0,0,1] op_sel_hi:[1,0,1]
    v_pk_fma_f32 v[186:187], v[186:187], v[6:7], v[6:7] op_sel:[0,0,1] op_sel_hi:[1,0,1]
    v_pk_fma_f32 v[188:189], v[188:189], v[6:7], v[6:7] op_sel:[0,0,1] op_sel_hi:[1,0,1]
    v_pk_fma_f32 v[190:191], v[190:191], v[6:7], v[6:7] op_sel:[0,0,1] op_sel_hi:[1,0,1]
    buffer_load_dwordx4 v[48:51], v88, s[28:31], s92 offen sc1
    v_pk_fma_f32 v[192:193], v[192:193], v[6:7], v[6:7] op_sel:[0,0,1] op_sel_hi:[1,0,1]
    v_pk_fma_f32 v[194:195], v[194:195], v[6:7], v[6:7] op_sel:[0,0,1] op_sel_hi:[1,0,1]
    v_pk_fma_f32 v[196:197], v[196:197], v[6:7], v[6:7] op_sel:[0,0,1] op_sel_hi:[1,0,1]
    v_pk_fma_f32 v[198:199], v[198:199], v[6:7], v[6:7] op_sel:[0,0,1] op_sel_hi:[1,0,1]
    v_pk_fma_f32 v[200:201], v[200:201], v[6:7], v[6:7] op_sel:[0,0,1] op_sel_hi:[1,0,1]
    v_pk_fma_f32 v[202:203], v[202:203], v[6:7], v[6:7] op_sel:[0,0,1] op_sel_hi:[1,0,1]
    buffer_load_dwordx4 v[52:55], v88, s[28:31], s93 offen sc1
    v_pk_fma_f32 v[204:205], v[204:205], v[6:7], v[6:7] op_sel:[0,0,1] op_sel_hi:[1,0,1]
    v_pk_fma_f32 v[206:207], v[206:207], v[6:7], v[6:7] op_sel:[0,0,1] op_sel_hi:[1,0,1]
    v_pk_fma_f32 v[208:209], v[208:209], v[6:7], v[6:7] op_sel:[0,0,1] op_sel_hi:[1,0,1]
    v_pk_fma_f32 v[210:211], v[210:211], v[6:7], v[6:7] op_sel:[0,0,1] op_sel_hi:[1,0,1]
    v_pk_fma_f32 v[212:213], v[212:213], v[6:7], v[6:7] op_sel:[0,0,1] op_sel_hi:[1,0,1]
    v_pk_fma_f32 v[214:215], v[214:215], v[6:7], v[6:7] op_sel:[0,0,1] op_sel_hi:[1,0,1]
    buffer_load_dwordx4 v[56:59], v88, s[28:31], s94 offen sc1
    v_pk_fma_f32 v[216:217], v[216:217], v[6:7], v[6:7] op_sel:[0,0,1] op_sel_hi:[1,0,1]
    v_pk_fma_f32 v[218:219], v[218:219], v[6:7], v[6:7] op_sel:[0,0,1] op_sel_hi:[1,0,1]
    v_pk_fma_f32 v[220:221], v[220:221], v[6:7], v[6:7] op_sel:[0,0,1] op_sel_hi:[1,0,1]
    v_pk_fma_f32 v[222:223], v[222:223], v[6:7], v[6:7] op_sel:[0,0,1] op_sel_hi:[1,0,1]
    v_pk_fma_f32 v[224:225], v[224:225], v[6:7], v[6:7] op_sel:[0,0,1] op_sel_hi:[1,0,1]
    v_pk_fma_f32 v[226:227], v[226:227], v[6:7], v[6:7] op_sel:[0,0,1] op_sel_hi:[1,0,1]
    buffer_load_dwordx4 v[60:63], v89, s[28:31], s95 offen sc1
    v_pk_fma_f32 v[228:229], v[228:229], v[6:7], v[6:7] op_sel:[0,0,1] op_sel_hi:[1,0,1]
    v_pk_fma_f32 v[230:231], v[230:231], v[6:7], v[6:7] op_sel:[0,0,1] op_sel_hi:[1,0,1]
    v_pk_fma_f32 v[232:233], v[232:233], v[6:7], v[6:7] op_sel:[0,0,1] op_sel_hi:[1,0,1]
    v_pk_fma_f32 v[234:235], v[234:235], v[6:7], v[6:7] op_sel:[0,0,1] op_sel_hi:[1,0,1]
    v_pk_fma_f32 v[236:237], v[236:237], v[6:7], v[6:7] op_sel:[0,0,1] op_sel_hi:[1,0,1]
    v_pk_fma_f32 v[238:239], v[238:239], v[6:7], v[6:7] op_sel:[0,0,1] op_sel_hi:[1,0,1]
    buffer_load_dwordx2 v[64:65], v90, s[28:31], s95 offen sc1
    v_pk_fma_f32 v[240:241], v[240:241], v[6:7], v[6:7] op_sel:[0,0,1] op_sel_hi:[1,0,1]
    v_pk_fma_f32 v[242:243], v[242:243], v[6:7], v[6:7] op_sel:[0,0,1] op_sel_hi:[1,0,1]
    v_pk_fma_f32 v[244:245], v[244:245], v[6:7], v[6:7] op_sel:[0,0,1] op_sel_hi:[1,0,1]
    v_pk_fma_f32 v[246:247], v[246:247], v[6:7], v[6:7] op_sel:[0,0,1] op_sel_hi:[1,0,1]
    v_pk_fma_f32 v[248:249], v[248:249], v[6:7], v[6:7] op_sel:[0,0,1] op_sel_hi:[1,0,1]
    v_pk_fma_f32 v[250:251], v[250:251], v[6:7], v[6:7] op_sel:[0,0,1] op_sel_hi:[1,0,1]
    v_pk_fma_f32 v[252:253], v[252:253], v[6:7], v[6:7] op_sel:[0,0,1] op_sel_hi:[1,0,1]
    v_pk_fma_f32 v[254:255], v[254:255], v[6:7], v[6:7] op_sel:[0,0,1] op_sel_hi:[1,0,1]
    s_waitcnt vmcnt(22)
    s_cmp_lg_u32 s58, 0
    s_cbranch_scc1 L_qrd_13
    ds_read_b64_tr_b16 a[120:121], v78 offset:0
    ds_read_b64_tr_b16 a[122:123], v79 offset:0
    ds_read_b64_tr_b16 a[124:125], v78 offset:32
    ds_read_b64_tr_b16 a[126:127], v79 offset:32
    ds_read_b64_tr_b16 a[128:129], v78 offset:64
    ds_read_b64_tr_b16 a[130:131], v79 offset:64
    ds_read_b64_tr_b16 a[132:133], v78 offset:96
    ds_read_b64_tr_b16 a[134:135], v79 offset:96
    ds_read_b64_tr_b16 a[136:137], v78 offset:128
    ds_read_b64_tr_b16 a[138:139], v79 offset:128
    ds_read_b64_tr_b16 a[140:141], v78 offset:160
    ds_read_b64_tr_b16 a[142:143], v79 offset:160
L_qrdb_14:
    s_lshr_b32 s88, s81, 1
    s_and_b32 s89, s81, 1
    v_mad_u32_u24 v72, v73, s80, v72
    v_mad_u32_u24 v72, v74, s88, v72
    v_mad_u32_u24 v72, v75, s89, v72
    s_min_u32 s89, s80, 27
    s_mul_i32 s69, s81, 28
    s_add_u32 s69, s69, s89
    s_lshl_b32 s69, s69, 14
    s_add_u32 s69, s69, 1048576
    s_mul_i32 s88, s89, 37
    s_lshr_b32 s88, s88, 8
    s_mul_i32 s88, s88, 7
    s_sub_u32 s88, s89, s88
    s_cmp_eq_u32 s88, 6
    s_cselect_b32 s76, 17, 31
    s_lshl_b32 s76, s76, 4
    s_cmp_lt_u32 s80, 28
    s_cselect_b32 s77, 0, 1073741824
    v_readlane_b32 s4, v72, 0
    v_readlane_b32 s5, v72, 1
    v_readlane_b32 s6, v72, 2
    v_readlane_b32 s7, v72, 3
    v_readlane_b32 s12, v72, 4
    v_readlane_b32 s13, v72, 5
    v_readlane_b32 s14, v72, 6
    v_readlane_b32 s15, v72, 7
    v_readlane_b32 s16, v72, 8
    v_readlane_b32 s17, v72, 9
    v_readlane_b32 s18, v72, 10
    v_readlane_b32 s19, v72, 11
    v_readlane_b32 s24, v72, 12
    v_readlane_b32 s25, v72, 13
    v_readlane_b32 s26, v72, 14
    v_readlane_b32 s27, v72, 15
    v_readlane_b32 s40, v72, 16
    v_readlane_b32 s41, v72, 17
    v_readlane_b32 s42, v72, 18
    v_readlane_b32 s43, v72, 19
    v_readlane_b32 s44, v72, 20
    v_readlane_b32 s45, v72, 21
    v_readlane_b32 s46, v72, 22
    v_readlane_b32 s47, v72, 23
    v_readlane_b32 s48, v72, 24
    v_readlane_b32 s49, v72, 25
    v_readlane_b32 s50, v72, 26
    v_readlane_b32 s51, v72, 27
    v_readlane_b32 s55, v72, 28
    v_readlane_b32 s56, v72, 29
    v_readlane_b32 s62, v72, 30
    v_readlane_b32 s63, v72, 31
    v_readlane_b32 s64, v72, 32
    v_readlane_b32 s65, v72, 33
    v_readlane_b32 s66, v72, 34
    s_waitcnt vmcnt(0)
    v_min3_u32 v6, v41, v43, v45
    v_min3_u32 v6, v6, v47, v49
    v_min3_u32 v6, v6, v51, v53
    v_min3_u32 v6, v6, v55, v57
    v_min3_u32 v6, v6, v59, v61
    v_min3_u32 v6, v6, v63, v65
    v_max3_u32 v7, v41, v43, v45
    v_max3_u32 v7, v7, v47, v49
    v_max3_u32 v7, v7, v51, v53
    v_max3_u32 v7, v7, v55, v57
    v_max3_u32 v7, v7, v59, v61
    v_max3_u32 v7, v7, v63, v65
    v_cmp_ne_u32 vcc, s83, v6
    v_cmp_ne_u32 s[88:89], s83, v7
    s_nop 0
    s_or_b64 vcc, vcc, s[88:89]
    s_cmp_lg_u64 vcc, 0
    s_cbranch_scc1 L_retry_15
L_ok_16:
    v_add_f32 v40, v40, v42
    v_add_f32 v44, v44, v46
    v_add_f32 v48, v48, v50
    v_add_f32 v52, v52, v54
    v_add_f32 v56, v56, v58
    v_add_f32 v6, 1.0, v48
    v_cmp_le_u32 vcc, 128, v0
    v_add_f32 v52, 1.0, v52
    v_add_f32 v56, 1.0, v56
    v_cndmask_b32 v48, v48, v6, vcc
    v_cmp_ne_u32 vcc, s3, v64
    ds_write_b32 v91, v40 offset:0
    ds_write_b32 v91, v44 offset:1024
    ds_write_b32 v91, v48 offset:2048
    ds_write_b32 v91, v52 offset:3072
    ds_write_b32 v91, v56 offset:4096
    s_cmp_eq_u64 vcc, 0
    s_cselect_b32 s3, 1, 0
    s_or_b32 s88, s2, s82
    s_cbranch_scc0 L_ep_17
L_epb_18:
    s_waitcnt lgkmcnt(0)
    s_add_u32 m0, s54, 5120
    s_nop 0
    buffer_load_dwordx4 v24, s[8:11], s53 offen offset:0 lds
    buffer_load_dwordx4 v25, s[8:11], s53 offen offset:1024 lds
    s_waitcnt lgkmcnt(0)
    s_barrier
    ds_read_b128 v[40:43], v34 offset:2560
    ds_read_b128 v[44:47], v34 offset:2576
    ds_read_b128 v[48:51], v34 offset:0
    ds_read_b128 v[52:55], v34 offset:16
    ds_read_b128 v[56:59], v34 offset:2688
    ds_read_b128 v[60:63], v34 offset:2704
    ds_read_b128 v[64:67], v34 offset:128
    ds_read_b128 v[68:71], v34 offset:144
    ds_read_b128 v[72:75], v34 offset:2816
    ds_read_b128 v[76:79], v34 offset:2832
    ds_read_b128 v[80:83], v34 offset:256
    ds_read_b128 v[84:87], v34 offset:272
    s_waitcnt lgkmcnt(8)
    v_pk_fma_f32 v[96:97], v[96:97], v[40:41], v[48:49]
    v_pk_fma_f32 v[98:99], v[98:99], v[42:43], v[50:51]
    v_pk_fma_f32 v[100:101], v[100:101], v[44:45], v[52:53]
    v_pk_fma_f32 v[102:103], v[102:103], v[46:47], v[54:55]
    ds_read_b128 v[40:43], v34 offset:2944
    ds_read_b128 v[44:47], v34 offset:2960
    ds_read_b128 v[48:51], v34 offset:384
    ds_read_b128 v[52:55], v34 offset:400
    v_cvt_pk_bf16_f32 v96, v96, v97
    v_cvt_pk_bf16_f32 v97, v98, v99
    v_cvt_pk_bf16_f32 v98, v100, v101
    v_cvt_pk_bf16_f32 v99, v102, v103
    buffer_load_dwordx4 v26, s[8:11], s53 offen offset:2048 lds
    s_waitcnt lgkmcnt(8)
    v_pk_fma_f32 v[104:105], v[104:105], v[56:57], v[64:65]
    v_pk_fma_f32 v[106:107], v[106:107], v[58:59], v[66:67]
    v_pk_fma_f32 v[108:109], v[108:109], v[60:61], v[68:69]
    v_pk_fma_f32 v[110:111], v[110:111], v[62:63], v[70:71]
    ds_read_b128 v[56:59], v34 offset:3072
    ds_read_b128 v[60:63], v34 offset:3088
    ds_read_b128 v[64:67], v34 offset:512
    ds_read_b128 v[68:71], v34 offset:528
    v_cvt_pk_bf16_f32 v100, v104, v105
    v_cvt_pk_bf16_f32 v101, v106, v107
    v_cvt_pk_bf16_f32 v102, v108, v109
    v_cvt_pk_bf16_f32 v103, v110, v111
    buffer_load_dwordx4 v27, s[8:11], s53 offen offset:3072 lds
    s_add_u32 m0, s54, 9216
    s_waitcnt lgkmcnt(8)
    v_pk_fma_f32 v[112:113], v[112:113], v[72:73], v[80:81]
    v_pk_fma_f32 v[114:115], v[114:115], v[74:75], v[82:83]
    v_pk_fma_f32 v[116:117], v[116:117], v[76:77], v[84:85]
    v_pk_fma_f32 v[118:119], v[118:119], v[78:79], v[86:87]
    ds_read_b128 v[72:75], v34 offset:3200
    ds_read_b128 v[76:79], v34 offset:3216
    ds_read_b128 v[80:83], v34 offset:640
    ds_read_b128 v[84:87], v34 offset:656
    v_cvt_pk_bf16_f32 v104, v112, v113
    v_cvt_pk_bf16_f32 v105, v114, v115
    v_cvt_pk_bf16_f32 v106, v116, v117
    v_cvt_pk_bf16_f32 v107, v118, v119
    buffer_load_dwordx4 v28, s[8:11], s53 offen offset:0 lds
    s_add_u32 s53, s53, 245760
    s_add_u32 m0, s54, 10240
    s_waitcnt lgkmcnt(8)
    v_pk_fma_f32 v[120:121], v[120:121], v[40:41], v[48:49]
    v_pk_fma_f32 v[122:123], v[122:123], v[42:43], v[50:51]
    v_pk_fma_f32 v[124:125], v[124:125], v[44:45], v[52:53]
    v_pk_fma_f32 v[126:127], v[126:127], v[46:47], v[54:55]
    ds_read_b128 v[40:43], v34 offset:3328
    ds_read_b128 v[44:47], v34 offset:3344
    ds_read_b128 v[48:51], v34 offset:768
    ds_read_b128 v[52:55], v34 offset:784
    v_cvt_pk_bf16_f32 v108, v120, v121
    v_cvt_pk_bf16_f32 v109, v122, v123
    v_cvt_pk_bf16_f32 v110, v124, v125
    v_cvt_pk_bf16_f32 v111, v126, v127
    buffer_load_dwordx4 v24, s[8:11], s53 offen offset:0 lds
    s_waitcnt lgkmcnt(8)
    v_pk_fma_f32 v[128:129], v[128:129], v[56:57], v[64:65]
    v_pk_fma_f32 v[130:131], v[130:131], v[58:59], v[66:67]
    v_pk_fma_f32 v[132:133], v[132:133], v[60:61], v[68:69]
    v_pk_fma_f32 v[134:135], v[134:135], v[62:63], v[70:71]
    ds_read_b128 v[56:59], v34 offset:3456
    ds_read_b128 v[60:63], v34 offset:3472
    ds_read_b128 v[64:67], v34 offset:896
    ds_read_b128 v[68:71], v34 offset:912
    v_cvt_pk_bf16_f32 v112, v128, v129
    v_cvt_pk_bf16_f32 v113, v130, v131
    v_cvt_pk_bf16_f32 v114, v132, v133
    v_cvt_pk_bf16_f32 v115, v134, v135
    buffer_load_dwordx4 v25, s[8:11], s53 offen offset:1024 lds
    s_waitcnt lgkmcnt(8)
    v_pk_fma_f32 v[136:137], v[136:137], v[72:73], v[80:81]
    v_pk_fma_f32 v[138:139], v[138:139], v[74:75], v[82:83]
    v_pk_fma_f32 v[140:141], v[140:141], v[76:77], v[84:85]
    v_pk_fma_f32 v[142:143], v[142:143], v[78:79], v[86:87]
    ds_read_b128 v[72:75], v34 offset:3584
    ds_read_b128 v[76:79], v34 offset:3600
    ds_read_b128 v[80:83], v34 offset:1024
    ds_read_b128 v[84:87], v34 offset:1040
    v_cvt_pk_bf16_f32 v116, v136, v137
    v_cvt_pk_bf16_f32 v117, v138, v139
    v_cvt_pk_bf16_f32 v118, v140, v141
    v_cvt_pk_bf16_f32 v119, v142, v143
    buffer_load_dwordx4 v26, s[8:11], s53 offen offset:2048 lds
    s_waitcnt lgkmcnt(8)
    v_pk_fma_f32 v[144:145], v[144:145], v[40:41], v[48:49]
    v_pk_fma_f32 v[146:147], v[146:147], v[42:43], v[50:51]
    v_pk_fma_f32 v[148:149], v[148:149], v[44:45], v[52:53]
    v_pk_fma_f32 v[150:151], v[150:151], v[46:47], v[54:55]
    ds_read_b128 v[40:43], v34 offset:3712
    ds_read_b128 v[44:47], v34 offset:3728
    ds_read_b128 v[48:51], v34 offset:1152
    ds_read_b128 v[52:55], v34 offset:1168
    v_cvt_pk_bf16_f32 v120, v144, v145
    v_cvt_pk_bf16_f32 v121, v146, v147
    v_cvt_pk_bf16_f32 v122, v148, v149
    v_cvt_pk_bf16_f32 v123, v150, v151
    buffer_load_dwordx4 v27, s[8:11], s53 offen offset:3072 lds
    s_add_u32 m0, s54, 14336
    s_waitcnt lgkmcnt(8)
    v_pk_fma_f32 v[152:153], v[152:153], v[56:57], v[64:65]
    v_pk_fma_f32 v[154:155], v[154:155], v[58:59], v[66:67]
    v_pk_fma_f32 v[156:157], v[156:157], v[60:61], v[68:69]
    v_pk_fma_f32 v[158:159], v[158:159], v[62:63], v[70:71]
    ds_read_b128 v[56:59], v34 offset:3840
    ds_read_b128 v[60:63], v34 offset:3856
    ds_read_b128 v[64:67], v34 offset:1280
    ds_read_b128 v[68:71], v34 offset:1296
    v_cvt_pk_bf16_f32 v124, v152, v153
    v_cvt_pk_bf16_f32 v125, v154, v155
    v_cvt_pk_bf16_f32 v126, v156, v157
    v_cvt_pk_bf16_f32 v127, v158, v159
    buffer_load_dwordx4 v28, s[8:11], s53 offen offset:0 lds
    s_add_u32 s53, s53, 245760
    s_waitcnt lgkmcnt(8)
    v_pk_fma_f32 v[160:161], v[160:161], v[72:73], v[80:81]
    v_pk_fma_f32 v[162:163], v[162:163], v[74:75], v[82:83]
    v_pk_fma_f32 v[164:165], v[164:165], v[76:77], v[84:85]
    v_pk_fma_f32 v[166:167], v[166:167], v[78:79], v[86:87]
    ds_read_b128 v[72:75], v34 offset:3968
    ds_read_b128 v[76:79], v34 offset:3984
    ds_read_b128 v[80:83], v34 offset:1408
    ds_read_b128 v[84:87], v34 offset:1424
    v_cvt_pk_bf16_f32 v128, v160, v161
    v_cvt_pk_bf16_f32 v129, v162, v163
    v_cvt_pk_bf16_f32 v130, v164, v165
    v_cvt_pk_bf16_f32 v131, v166, v167
    buffer_store_dwordx4 a[120:123], v36, s[28:31], s67 offen offset:0 sc1
    s_waitcnt lgkmcnt(8)
    v_pk_fma_f32 v[168:169], v[168:169], v[40:41], v[48:49]
    v_pk_fma_f32 v[170:171], v[170:171], v[42:43], v[50:51]
    v_pk_fma_f32 v[172:173], v[172:173], v[44:45], v[52:53]
    v_pk_fma_f32 v[174:175], v[174:175], v[46:47], v[54:55]
    ds_read_b128 v[40:43], v34 offset:4096
    ds_read_b128 v[44:47], v34 offset:4112
    ds_read_b128 v[48:51], v34 offset:1536
    ds_read_b128 v[52:55], v34 offset:1552
    v_cvt_pk_bf16_f32 v132, v168, v169
    v_cvt_pk_bf16_f32 v133, v170, v171
    v_cvt_pk_bf16_f32 v134, v172, v173
    v_cvt_pk_bf16_f32 v135, v174, v175
    buffer_store_dwordx4 a[124:127], v36, s[28:31], s67 offen offset:1024 sc1
    s_waitcnt lgkmcnt(8)
    v_pk_fma_f32 v[176:177], v[176:177], v[56:57], v[64:65]
    v_pk_fma_f32 v[178:179], v[178:179], v[58:59], v[66:67]
    v_pk_fma_f32 v[180:181], v[180:181], v[60:61], v[68:69]
    v_pk_fma_f32 v[182:183], v[182:183], v[62:63], v[70:71]
    ds_read_b128 v[56:59], v34 offset:4224
    ds_read_b128 v[60:63], v34 offset:4240
    ds_read_b128 v[64:67], v34 offset:1664
    ds_read_b128 v[68:71], v34 offset:1680
    v_cvt_pk_bf16_f32 v136, v176, v177
    v_cvt_pk_bf16_f32 v137, v178, v179
    v_cvt_pk_bf16_f32 v138, v180, v181
    v_cvt_pk_bf16_f32 v139, v182, v183
    buffer_store_dwordx4 a[128:131], v36, s[28:31], s67 offen offset:2048 sc1
    s_waitcnt lgkmcnt(8)
    v_pk_fma_f32 v[184:185], v[184:185], v[72:73], v[80:81]
    v_pk_fma_f32 v[186:187], v[186:187], v[74:75], v[82:83]
    v_pk_fma_f32 v[188:189], v[188:189], v[76:77], v[84:85]
    v_pk_fma_f32 v[190:191], v[190:191], v[78:79], v[86:87]
    ds_read_b128 v[72:75], v34 offset:4352
    ds_read_b128 v[76:79], v34 offset:4368
    ds_read_b128 v[80:83], v34 offset:1792
    ds_read_b128 v[84:87], v34 offset:1808
    v_cvt_pk_bf16_f32 v140, v184, v185
    v_cvt_pk_bf16_f32 v141, v186, v187
    v_cvt_pk_bf16_f32 v142, v188, v189
    v_cvt_pk_bf16_f32 v143, v190, v191
    buffer_store_dwordx4 a[132:135], v36, s[28:31], s67 offen offset:3072 sc1
    s_waitcnt lgkmcnt(8)
    v_pk_fma_f32 v[192:193], v[192:193], v[40:41], v[48:49]
    v_pk_fma_f32 v[194:195], v[194:195], v[42:43], v[50:51]
    v_pk_fma_f32 v[196:197], v[196:197], v[44:45], v[52:53]
    v_pk_fma_f32 v[198:199], v[198:199], v[46:47], v[54:55]
    ds_read_b128 v[40:43], v34 offset:4480
    ds_read_b128 v[44:47], v34 offset:4496
    ds_read_b128 v[48:51], v34 offset:1920
    ds_read_b128 v[52:55], v34 offset:1936
    v_cvt_pk_bf16_f32 v144, v192, v193
    v_cvt_pk_bf16_f32 v145, v194, v195
    v_cvt_pk_bf16_f32 v146, v196, v197
    v_cvt_pk_bf16_f32 v147, v198, v199
    buffer_store_dwordx4 a[136:139], v36, s[28:31], s68 offen offset:0 sc1
    s_waitcnt lgkmcnt(8)
    v_pk_fma_f32 v[200:201], v[200:201], v[56:57], v[64:65]
    v_pk_fma_f32 v[202:203], v[202:203], v[58:59], v[66:67]
    v_pk_fma_f32 v[204:205], v[204:205], v[60:61], v[68:69]
    v_pk_fma_f32 v[206:207], v[206:207], v[62:63], v[70:71]
    ds_read_b128 v[56:59], v34 offset:4608
    ds_read_b128 v[60:63], v34 offset:4624
    ds_read_b128 v[64:67], v34 offset:2048
    ds_read_b128 v[68:71], v34 offset:2064
    v_cvt_pk_bf16_f32 v148, v200, v201
    v_cvt_pk_bf16_f32 v149, v202, v203
    v_cvt_pk_bf16_f32 v150, v204, v205
    v_cvt_pk_bf16_f32 v151, v206, v207
    buffer_store_dwordx4 a[140:143], v37, s[28:31], s68 offen offset:1024 sc1
    s_waitcnt lgkmcnt(8)
    v_pk_fma_f32 v[208:209], v[208:209], v[72:73], v[80:81]
    v_pk_fma_f32 v[210:211], v[210:211], v[74:75], v[82:83]
    v_pk_fma_f32 v[212:213], v[212:213], v[76:77], v[84:85]
    v_pk_fma_f32 v[214:215], v[214:215], v[78:79], v[86:87]
    ds_read_b128 v[72:75], v34 offset:4736
    ds_read_b128 v[76:79], v34 offset:4752
    ds_read_b128 v[80:83], v34 offset:2176
    ds_read_b128 v[84:87], v34 offset:2192
    v_cvt_pk_bf16_f32 v152, v208, v209
    v_cvt_pk_bf16_f32 v153, v210, v211
    v_cvt_pk_bf16_f32 v154, v212, v213
    v_cvt_pk_bf16_f32 v155, v214, v215
    s_waitcnt lgkmcnt(8)
    v_pk_fma_f32 v[216:217], v[216:217], v[40:41], v[48:49]
    v_pk_fma_f32 v[218:219], v[218:219], v[42:43], v[50:51]
    v_pk_fma_f32 v[220:221], v[220:221], v[44:45], v[52:53]
    v_pk_fma_f32 v[222:223], v[222:223], v[46:47], v[54:55]
    ds_read_b128 v[40:43], v34 offset:4864
    ds_read_b128 v[44:47], v34 offset:4880
    ds_read_b128 v[48:51], v34 offset:2304
    ds_read_b128 v[52:55], v34 offset:2320
    v_cvt_pk_bf16_f32 v156, v216, v217
    v_cvt_pk_bf16_f32 v157, v218, v219
    v_cvt_pk_bf16_f32 v158, v220, v221
    v_cvt_pk_bf16_f32 v159, v222, v223
    s_waitcnt lgkmcnt(8)
    v_pk_fma_f32 v[224:225], v[224:225], v[56:57], v[64:65]
    v_pk_fma_f32 v[226:227], v[226:227], v[58:59], v[66:67]
    v_pk_fma_f32 v[228:229], v[228:229], v[60:61], v[68:69]
    v_pk_fma_f32 v[230:231], v[230:231], v[62:63], v[70:71]
    ds_read_b128 v[56:59], v34 offset:4992
    ds_read_b128 v[60:63], v34 offset:5008
    ds_read_b128 v[64:67], v34 offset:2432
    ds_read_b128 v[68:71], v34 offset:2448
    v_cvt_pk_bf16_f32 v160, v224, v225
    v_cvt_pk_bf16_f32 v161, v226, v227
    v_cvt_pk_bf16_f32 v162, v228, v229
    v_cvt_pk_bf16_f32 v163, v230, v231
    s_waitcnt lgkmcnt(8)
    v_pk_fma_f32 v[232:233], v[232:233], v[72:73], v[80:81]
    v_pk_fma_f32 v[234:235], v[234:235], v[74:75], v[82:83]
    v_pk_fma_f32 v[236:237], v[236:237], v[76:77], v[84:85]
    v_pk_fma_f32 v[238:239], v[238:239], v[78:79], v[86:87]
    v_cvt_pk_bf16_f32 v164, v232, v233
    v_cvt_pk_bf16_f32 v165, v234, v235
    v_cvt_pk_bf16_f32 v166, v236, v237
    v_cvt_pk_bf16_f32 v167, v238, v239
    s_waitcnt lgkmcnt(4)
    v_pk_fma_f32 v[240:241], v[240:241], v[40:41], v[48:49]
    v_pk_fma_f32 v[242:243], v[242:243], v[42:43], v[50:51]
    v_pk_fma_f32 v[244:245], v[244:245], v[44:45], v[52:53]
    v_pk_fma_f32 v[246:247], v[246:247], v[46:47], v[54:55]
    v_cvt_pk_bf16_f32 v168, v240, v241
    v_cvt_pk_bf16_f32 v169, v242, v243
    v_cvt_pk_bf16_f32 v170, v244, v245
    v_cvt_pk_bf16_f32 v171, v246, v247
    s_waitcnt lgkmcnt(0)
    v_pk_fma_f32 v[248:249], v[248:249], v[56:57], v[64:65]
    v_pk_fma_f32 v[250:251], v[250:251], v[58:59], v[66:67]
    v_pk_fma_f32 v[252:253], v[252:253], v[60:61], v[68:69]
    v_pk_fma_f32 v[254:255], v[254:255], v[62:63], v[70:71]
    v_cvt_pk_bf16_f32 v172, v248, v249
    v_cvt_pk_bf16_f32 v173, v250, v251
    v_cvt_pk_bf16_f32 v174, v252, v253
    v_cvt_pk_bf16_f32 v175, v254, v255
    s_waitcnt vmcnt(6)
    s_sub_u32 s88, s2, 40
    s_cmp_lt_u32 s88, 200
    s_cselect_b32 s59, 0, 1073741824
    v_or_b32 v35, s59, v35
    s_barrier
    s_mov_b32 s73, 6144
    ds_read_b64_tr_b16 a[0:1], v29 offset:0
    ds_read_b64_tr_b16 a[2:3], v29 offset:2560
    ds_read_b64_tr_b16 a[4:5], v29 offset:8
    ds_read_b64_tr_b16 a[6:7], v29 offset:2568
    ds_read_b64_tr_b16 a[8:9], v29 offset:16
    ds_read_b64_tr_b16 a[10:11], v29 offset:2576
    ds_read_b64_tr_b16 a[12:13], v29 offset:24
    ds_read_b64_tr_b16 a[14:15], v29 offset:2584
    ds_read_b64_tr_b16 a[16:17], v29 offset:32
    ds_read_b64_tr_b16 a[18:19], v29 offset:2592
    ds_read_b64_tr_b16 a[20:21], v29 offset:15360
    ds_read_b64_tr_b16 a[22:23], v29 offset:17920
    ds_read_b64_tr_b16 a[24:25], v29 offset:15368
    ds_read_b64_tr_b16 a[26:27], v29 offset:17928
    s_waitcnt lgkmcnt(8)
    v_mfma_f32_16x16x32_bf16 v[40:43], a[0:3], v[96:99], 0
    ds_read_b64_tr_b16 a[28:29], v29 offset:15376
    ds_read_b64_tr_b16 a[30:31], v29 offset:17936
    v_mfma_f32_16x16x32_bf16 v[44:47], a[4:7], v[96:99], 0
    ds_read_b64_tr_b16 a[32:33], v29 offset:15384
    ds_read_b64_tr_b16 a[34:35], v29 offset:17944
    s_add_u32 m0, s52, 10240
    s_nop 0
    buffer_load_dwordx4 v24, s[8:11], s57 offen offset:0 lds
    v_mfma_f32_16x16x32_bf16 v[48:51], a[8:11], v[96:99], 0
    ds_read_b64_tr_b16 a[36:37], v29 offset:15392
    ds_read_b64_tr_b16 a[38:39], v29 offset:17952
    s_waitcnt lgkmcnt(8)
    v_mfma_f32_16x16x32_bf16 v[52:55], a[12:15], v[96:99], 0
    ds_read_b64_tr_b16 a[0:1], v29 offset:30720
    ds_read_b64_tr_b16 a[2:3], v29 offset:33280
    v_mfma_f32_16x16x32_bf16 v[56:59], a[16:19], v[96:99], 0
    ds_read_b64_tr_b16 a[4:5], v29 offset:30728
    ds_read_b64_tr_b16 a[6:7], v29 offset:33288
    v_mfma_f32_16x16x32_bf16 v[60:63], a[20:23], v[96:99], 0
    ds_read_b64_tr_b16 a[8:9], v29 offset:30736
    ds_read_b64_tr_b16 a[10:11], v29 offset:33296
    s_waitcnt lgkmcnt(8)
    v_mfma_f32_16x16x32_bf16 v[64:67], a[24:27], v[96:99], 0
    ds_read_b64_tr_b16 a[12:13], v29 offset:30744
    ds_read_b64_tr_b16 a[14:15], v29 offset:33304
    buffer_load_dwordx4 v25, s[8:11], s57 offen offset:1024 lds
    v_mfma_f32_16x16x32_bf16 v[68:71], a[28:31], v[96:99], 0
    ds_read_b64_tr_b16 a[16:17], v29 offset:30752
    ds_read_b64_tr_b16 a[18:19], v29 offset:33312
    v_mfma_f32_16x16x32_bf16 v[72:75], a[32:35], v[96:99], 0
    ds_read_b64_tr_b16 a[20:21], v29 offset:46080
    ds_read_b64_tr_b16 a[22:23], v29 offset:48640
    s_waitcnt lgkmcnt(8)
    v_mfma_f32_16x16x32_bf16 v[76:79], a[36:39], v[96:99], 0
    ds_read_b64_tr_b16 a[24:25], v29 offset:46088
    ds_read_b64_tr_b16 a[26:27], v29 offset:48648
    v_mfma_f32_16x16x32_bf16 v[40:43], a[0:3], v[100:103], v[40:43]
    ds_read_b64_tr_b16 a[28:29], v29 offset:46096
    ds_read_b64_tr_b16 a[30:31], v29 offset:48656
    v_mfma_f32_16x16x32_bf16 v[44:47], a[4:7], v[100:103], v[44:47]
    ds_read_b64_tr_b16 a[32:33], v29 offset:46104
    ds_read_b64_tr_b16 a[34:35], v29 offset:48664
    buffer_load_dwordx4 v26, s[8:11], s57 offen offset:2048 lds
    s_waitcnt lgkmcnt(8)
    v_mfma_f32_16x16x32_bf16 v[48:51], a[8:11], v[100:103], v[48:51]
    ds_read_b64_tr_b16 a[36:37], v29 offset:46112
    ds_read_b64_tr_b16 a[38:39], v29 offset:48672
    v_mfma_f32_16x16x32_bf16 v[52:55], a[12:15], v[100:103], v[52:55]
    ds_read_b64_tr_b16 a[0:1], v29 offset:5120
    ds_read_b64_tr_b16 a[2:3], v29 offset:7680
    v_mfma_f32_16x16x32_bf16 v[56:59], a[16:19], v[100:103], v[56:59]
    ds_read_b64_tr_b16 a[4:5], v29 offset:5128
    ds_read_b64_tr_b16 a[6:7], v29 offset:7688
    s_waitcnt lgkmcnt(8)
    v_mfma_f32_16x16x32_bf16 v[60:63], a[20:23], v[100:103], v[60:63]
    ds_read_b64_tr_b16 a[8:9], v29 offset:5136
    ds_read_b64_tr_b16 a[10:11], v29 offset:7696
    v_mfma_f32_16x16x32_bf16 v[64:67], a[24:27], v[100:103], v[64:67]
    ds_read_b64_tr_b16 a[12:13], v29 offset:5144
    ds_read_b64_tr_b16 a[14:15], v29 offset:7704
    buffer_load_dwordx4 v27, s[8:11], s57 offen offset:3072 lds
    s_add_u32 m0, s52, 14336
    v_mfma_f32_16x16x32_bf16 v[68:71], a[28:31], v[100:103], v[68:71]
    ds_read_b64_tr_b16 a[16:17], v29 offset:5152
    ds_read_b64_tr_b16 a[18:19], v29 offset:7712
    s_waitcnt lgkmcnt(8)
    v_mfma_f32_16x16x32_bf16 v[72:75], a[32:35], v[100:103], v[72:75]
    ds_read_b64_tr_b16 a[20:21], v29 offset:20480
    ds_read_b64_tr_b16 a[22:23], v29 offset:23040
    v_mfma_f32_16x16x32_bf16 v[76:79], a[36:39], v[100:103], v[76:79]
    ds_read_b64_tr_b16 a[24:25], v29 offset:20488
    ds_read_b64_tr_b16 a[26:27], v29 offset:23048
    v_mfma_f32_16x16x32_bf16 v[40:43], a[0:3], v[104:107], v[40:43]
    ds_read_b64_tr_b16 a[28:29], v29 offset:20496
    ds_read_b64_tr_b16 a[30:31], v29 offset:23056
    s_waitcnt lgkmcnt(8)
    v_mfma_f32_16x16x32_bf16 v[44:47], a[4:7], v[104:107], v[44:47]
    ds_read_b64_tr_b16 a[32:33], v29 offset:20504
    ds_read_b64_tr_b16 a[34:35], v29 offset:23064
    buffer_load_dwordx4 v28, s[8:11], s57 offen offset:0 lds
    s_add_u32 s57, s57, 245760
    s_add_u32 m0, s52, 15360
    v_mfma_f32_16x16x32_bf16 v[48:51], a[8:11], v[104:107], v[48:51]
    ds_read_b64_tr_b16 a[36:37], v29 offset:20512
    ds_read_b64_tr_b16 a[38:39], v29 offset:23072
    v_mfma_f32_16x16x32_bf16 v[52:55], a[12:15], v[104:107], v[52:55]
    ds_read_b64_tr_b16 a[0:1], v29 offset:35840
    ds_read_b64_tr_b16 a[2:3], v29 offset:38400
    s_waitcnt lgkmcnt(8)
    v_mfma_f32_16x16x32_bf16 v[56:59], a[16:19], v[104:107], v[56:59]
    ds_read_b64_tr_b16 a[4:5], v29 offset:35848
    ds_read_b64_tr_b16 a[6:7], v29 offset:38408
    v_mfma_f32_16x16x32_bf16 v[60:63], a[20:23], v[104:107], v[60:63]
    ds_read_b64_tr_b16 a[8:9], v29 offset:35856
    ds_read_b64_tr_b16 a[10:11], v29 offset:38416
    v_mfma_f32_16x16x32_bf16 v[64:67], a[24:27], v[104:107], v[64:67]
    ds_read_b64_tr_b16 a[12:13], v29 offset:35864
    ds_read_b64_tr_b16 a[14:15], v29 offset:38424
    buffer_load_dwordx4 v24, s[8:11], s57 offen offset:0 lds
    s_waitcnt lgkmcnt(8)
    v_mfma_f32_16x16x32_bf16 v[68:71], a[28:31], v[104:107], v[68:71]
    ds_read_b64_tr_b16 a[16:17], v29 offset:35872
    ds_read_b64_tr_b16 a[18:19], v29 offset:38432
    v_mfma_f32_16x16x32_bf16 v[72:75], a[32:35], v[104:107], v[72:75]
    ds_read_b64_tr_b16 a[20:21], v29 offset:51200
    ds_read_b64_tr_b16 a[22:23], v29 offset:53760
    v_mfma_f32_16x16x32_bf16 v[76:79], a[36:39], v[104:107], v[76:79]
    ds_read_b64_tr_b16 a[24:25], v29 offset:51208
    ds_read_b64_tr_b16 a[26:27], v29 offset:53768
    s_waitcnt lgkmcnt(8)
    v_mfma_f32_16x16x32_bf16 v[40:43], a[0:3], v[108:111], v[40:43]
    ds_read_b64_tr_b16 a[28:29], v29 offset:51216
    ds_read_b64_tr_b16 a[30:31], v29 offset:53776
    v_mfma_f32_16x16x32_bf16 v[44:47], a[4:7], v[108:111], v[44:47]
    ds_read_b64_tr_b16 a[32:33], v29 offset:51224
    ds_read_b64_tr_b16 a[34:35], v29 offset:53784
    buffer_load_dwordx4 v25, s[8:11], s57 offen offset:1024 lds
    v_mfma_f32_16x16x32_bf16 v[48:51], a[8:11], v[108:111], v[48:51]
    ds_read_b64_tr_b16 a[36:37], v29 offset:51232
    ds_read_b64_tr_b16 a[38:39], v29 offset:53792
    s_waitcnt lgkmcnt(8)
    v_mfma_f32_16x16x32_bf16 v[52:55], a[12:15], v[108:111], v[52:55]
    ds_read_b64_tr_b16 a[0:1], v29 offset:10240
    ds_read_b64_tr_b16 a[2:3], v29 offset:12800
    v_mfma_f32_16x16x32_bf16 v[56:59], a[16:19], v[108:111], v[56:59]
    ds_read_b64_tr_b16 a[4:5], v29 offset:10248
    ds_read_b64_tr_b16 a[6:7], v29 offset:12808
    v_mfma_f32_16x16x32_bf16 v[60:63], a[20:23], v[108:111], v[60:63]
    ds_read_b64_tr_b16 a[8:9], v29 offset:10256
    ds_read_b64_tr_b16 a[10:11], v29 offset:12816
    s_waitcnt lgkmcnt(8)
    v_mfma_f32_16x16x32_bf16 v[64:67], a[24:27], v[108:111], v[64:67]
    ds_read_b64_tr_b16 a[12:13], v29 offset:10264
    ds_read_b64_tr_b16 a[14:15], v29 offset:12824
    buffer_load_dwordx4 v26, s[8:11], s57 offen offset:2048 lds
    v_mfma_f32_16x16x32_bf16 v[68:71], a[28:31], v[108:111], v[68:71]
    ds_read_b64_tr_b16 a[16:17], v29 offset:10272
    ds_read_b64_tr_b16 a[18:19], v29 offset:12832
    v_mfma_f32_16x16x32_bf16 v[72:75], a[32:35], v[108:111], v[72:75]
    ds_read_b64_tr_b16 a[20:21], v29 offset:25600
    ds_read_b64_tr_b16 a[22:23], v29 offset:28160
    s_waitcnt lgkmcnt(8)
    v_mfma_f32_16x16x32_bf16 v[76:79], a[36:39], v[108:111], v[76:79]
    ds_read_b64_tr_b16 a[24:25], v29 offset:25608
    ds_read_b64_tr_b16 a[26:27], v29 offset:28168
    v_mfma_f32_16x16x32_bf16 v[40:43], a[0:3], v[112:115], v[40:43]
    ds_read_b64_tr_b16 a[28:29], v29 offset:25616
    ds_read_b64_tr_b16 a[30:31], v29 offset:28176
    v_mfma_f32_16x16x32_bf16 v[44:47], a[4:7], v[112:115], v[44:47]
    ds_read_b64_tr_b16 a[32:33], v29 offset:25624
    ds_read_b64_tr_b16 a[34:35], v29 offset:28184
    buffer_load_dwordx4 v27, s[8:11], s57 offen offset:3072 lds
    s_add_u32 m0, s52, 19456
    s_waitcnt lgkmcnt(8)
    v_mfma_f32_16x16x32_bf16 v[48:51], a[8:11], v[112:115], v[48:51]
    ds_read_b64_tr_b16 a[36:37], v29 offset:25632
    ds_read_b64_tr_b16 a[38:39], v29 offset:28192
    v_mfma_f32_16x16x32_bf16 v[52:55], a[12:15], v[112:115], v[52:55]
    ds_read_b64_tr_b16 a[0:1], v29 offset:40960
    ds_read_b64_tr_b16 a[2:3], v29 offset:43520
    v_mfma_f32_16x16x32_bf16 v[56:59], a[16:19], v[112:115], v[56:59]
    ds_read_b64_tr_b16 a[4:5], v29 offset:40968
    ds_read_b64_tr_b16 a[6:7], v29 offset:43528
    s_waitcnt lgkmcnt(8)
    v_mfma_f32_16x16x32_bf16 v[60:63], a[20:23], v[112:115], v[60:63]
    ds_read_b64_tr_b16 a[8:9], v29 offset:40976
    ds_read_b64_tr_b16 a[10:11], v29 offset:43536
    v_mfma_f32_16x16x32_bf16 v[64:67], a[24:27], v[112:115], v[64:67]
    ds_read_b64_tr_b16 a[12:13], v29 offset:40984
    ds_read_b64_tr_b16 a[14:15], v29 offset:43544
    buffer_load_dwordx4 v28, s[8:11], s57 offen offset:0 lds
    s_add_u32 s57, s57, 245760
    v_mfma_f32_16x16x32_bf16 v[68:71], a[28:31], v[112:115], v[68:71]
    ds_read_b64_tr_b16 a[16:17], v29 offset:40992
    ds_read_b64_tr_b16 a[18:19], v29 offset:43552
    s_waitcnt lgkmcnt(8)
    v_mfma_f32_16x16x32_bf16 v[72:75], a[32:35], v[112:115], v[72:75]
    ds_read_b64_tr_b16 a[20:21], v29 offset:56320
    ds_read_b64_tr_b16 a[22:23], v29 offset:58880
    v_mfma_f32_16x16x32_bf16 v[76:79], a[36:39], v[112:115], v[76:79]
    ds_read_b64_tr_b16 a[24:25], v29 offset:56328
    ds_read_b64_tr_b16 a[26:27], v29 offset:58888
    v_mfma_f32_16x16x32_bf16 v[40:43], a[0:3], v[116:119], v[40:43]
    ds_read_b64_tr_b16 a[28:29], v29 offset:56336
    ds_read_b64_tr_b16 a[30:31], v29 offset:58896
    s_waitcnt lgkmcnt(8)
    v_mfma_f32_16x16x32_bf16 v[44:47], a[4:7], v[116:119], v[44:47]
    ds_read_b64_tr_b16 a[32:33], v29 offset:56344
    ds_read_b64_tr_b16 a[34:35], v29 offset:58904
    v_mfma_f32_16x16x32_bf16 v[48:51], a[8:11], v[116:119], v[48:51]
    ds_read_b64_tr_b16 a[36:37], v29 offset:56352
    ds_read_b64_tr_b16 a[38:39], v29 offset:58912
    v_mfma_f32_16x16x32_bf16 v[52:55], a[12:15], v[116:119], v[52:55]
    ds_read_b64_tr_b16 a[0:1], v29 offset:61440
    ds_read_b64_tr_b16 a[2:3], v29 offset:64000
    s_waitcnt lgkmcnt(8)
    v_mfma_f32_16x16x32_bf16 v[56:59], a[16:19], v[116:119], v[56:59]
    ds_read_b64_tr_b16 a[4:5], v29 offset:61448
    ds_read_b64_tr_b16 a[6:7], v29 offset:64008
    v_mfma_f32_16x16x32_bf16 v[60:63], a[20:23], v[116:119], v[60:63]
    ds_read_b64_tr_b16 a[8:9], v29 offset:61456
    ds_read_b64_tr_b16 a[10:11], v29 offset:64016
    v_mfma_f32_16x16x32_bf16 v[64:67], a[24:27], v[116:119], v[64:67]
    ds_read_b64_tr_b16 a[12:13], v29 offset:61464
    ds_read_b64_tr_b16 a[14:15], v29 offset:64024
    global_load_dwordx4 v[84:87], v5, s[74:75]
    s_add_u32 s74, s74, 4096
    s_addc_u32 s75, s75, 0
    s_waitcnt lgkmcnt(8)
    v_mfma_f32_16x16x32_bf16 v[68:71], a[28:31], v[116:119], v[68:71]
    ds_read_b64_tr_b16 a[16:17], v29 offset:61472
    ds_read_b64_tr_b16 a[18:19], v29 offset:64032
    v_mfma_f32_16x16x32_bf16 v[72:75], a[32:35], v[116:119], v[72:75]
    ds_read_b64_tr_b16 a[20:21], v30 offset:16384
    ds_read_b64_tr_b16 a[22:23], v30 offset:18944
    v_mfma_f32_16x16x32_bf16 v[76:79], a[36:39], v[116:119], v[76:79]
    ds_read_b64_tr_b16 a[24:25], v30 offset:16392
    ds_read_b64_tr_b16 a[26:27], v30 offset:18952
    s_waitcnt lgkmcnt(8)
    v_mfma_f32_16x16x32_bf16 v[40:43], a[0:3], v[120:123], v[40:43]
    ds_read_b64_tr_b16 a[28:29], v30 offset:16400
    ds_read_b64_tr_b16 a[30:31], v30 offset:18960
    v_mfma_f32_16x16x32_bf16 v[44:47], a[4:7], v[120:123], v[44:47]
    ds_read_b64_tr_b16 a[32:33], v30 offset:16408
    ds_read_b64_tr_b16 a[34:35], v30 offset:18968
    global_load_dwordx4 v[88:91], v5, s[74:75]
    s_add_u32 s74, s74, 4096
    s_addc_u32 s75, s75, 0
    global_load_dwordx4 v[92:95], v5, s[74:75]
    s_add_u32 s74, s74, 4096
    s_addc_u32 s75, s75, 0
    s_waitcnt vmcnt(13)
    s_barrier
    s_cmp_eq_u32 s82, 0
    s_cbranch_scc1 L_r2_19
L_r2b_20:
    s_add_u32 m0, s54, 0
    s_nop 0
    buffer_load_dwordx4 v24, s[8:11], s57 offen offset:0 lds
    v_mfma_f32_16x16x32_bf16 v[48:51], a[8:11], v[120:123], v[48:51]
    ds_read_b64_tr_b16 a[36:37], v30 offset:16416
    ds_read_b64_tr_b16 a[38:39], v30 offset:18976
    s_waitcnt lgkmcnt(8)
    v_mfma_f32_16x16x32_bf16 v[52:55], a[12:15], v[120:123], v[52:55]
    ds_read_b64_tr_b16 a[0:1], v30 offset:36864
    ds_read_b64_tr_b16 a[2:3], v30 offset:39424
    v_mfma_f32_16x16x32_bf16 v[56:59], a[16:19], v[120:123], v[56:59]
    ds_read_b64_tr_b16 a[4:5], v30 offset:36872
    ds_read_b64_tr_b16 a[6:7], v30 offset:39432
    buffer_load_dwordx4 v25, s[8:11], s57 offen offset:1024 lds
    v_mfma_f32_16x16x32_bf16 v[60:63], a[20:23], v[120:123], v[60:63]
    ds_read_b64_tr_b16 a[8:9], v30 offset:36880
    ds_read_b64_tr_b16 a[10:11], v30 offset:39440
    s_waitcnt lgkmcnt(8)
    v_mfma_f32_16x16x32_bf16 v[64:67], a[24:27], v[120:123], v[64:67]
    ds_read_b64_tr_b16 a[12:13], v30 offset:36888
    ds_read_b64_tr_b16 a[14:15], v30 offset:39448
    v_mfma_f32_16x16x32_bf16 v[68:71], a[28:31], v[120:123], v[68:71]
    ds_read_b64_tr_b16 a[16:17], v30 offset:36896
    ds_read_b64_tr_b16 a[18:19], v30 offset:39456
    buffer_load_dwordx4 v26, s[8:11], s57 offen offset:2048 lds
    v_mfma_f32_16x16x32_bf16 v[72:75], a[32:35], v[120:123], v[72:75]
    ds_read_b64_tr_b16 a[20:21], v30 offset:57344
    ds_read_b64_tr_b16 a[22:23], v30 offset:59904
    s_waitcnt lgkmcnt(8)
    v_mfma_f32_16x16x32_bf16 v[76:79], a[36:39], v[120:123], v[76:79]
    ds_read_b64_tr_b16 a[24:25], v30 offset:57352
    ds_read_b64_tr_b16 a[26:27], v30 offset:59912
    v_mfma_f32_16x16x32_bf16 v[40:43], a[0:3], v[124:127], v[40:43]
    ds_read_b64_tr_b16 a[28:29], v30 offset:57360
    ds_read_b64_tr_b16 a[30:31], v30 offset:59920
    buffer_load_dwordx4 v27, s[8:11], s57 offen offset:3072 lds
    s_add_u32 m0, s54, 4096
    v_mfma_f32_16x16x32_bf16 v[44:47], a[4:7], v[124:127], v[44:47]
    ds_read_b64_tr_b16 a[32:33], v30 offset:57368
    ds_read_b64_tr_b16 a[34:35], v30 offset:59928
    s_waitcnt lgkmcnt(8)
    v_mfma_f32_16x16x32_bf16 v[48:51], a[8:11], v[124:127], v[48:51]
    ds_read_b64_tr_b16 a[36:37], v30 offset:57376
    ds_read_b64_tr_b16 a[38:39], v30 offset:59936
    v_mfma_f32_16x16x32_bf16 v[52:55], a[12:15], v[124:127], v[52:55]
    ds_read_b64_tr_b16 a[0:1], v30 offset:1024
    ds_read_b64_tr_b16 a[2:3], v30 offset:3584
    buffer_load_dwordx4 v28, s[8:11], s57 offen offset:0 lds
    s_add_u32 s57, s57, 245760
    s_add_u32 m0, s54, 5120
    v_mfma_f32_16x16x32_bf16 v[56:59], a[16:19], v[124:127], v[56:59]
    ds_read_b64_tr_b16 a[4:5], v30 offset:1032
    ds_read_b64_tr_b16 a[6:7], v30 offset:3592
    s_waitcnt lgkmcnt(8)
    v_mfma_f32_16x16x32_bf16 v[60:63], a[20:23], v[124:127], v[60:63]
    ds_read_b64_tr_b16 a[8:9], v30 offset:1040
    ds_read_b64_tr_b16 a[10:11], v30 offset:3600
    v_mfma_f32_16x16x32_bf16 v[64:67], a[24:27], v[124:127], v[64:67]
    ds_read_b64_tr_b16 a[12:13], v30 offset:1048
    ds_read_b64_tr_b16 a[14:15], v30 offset:3608
    buffer_load_dwordx4 v24, s[8:11], s57 offen offset:0 lds
    v_mfma_f32_16x16x32_bf16 v[68:71], a[28:31], v[124:127], v[68:71]
    ds_read_b64_tr_b16 a[16:17], v30 offset:1056
    ds_read_b64_tr_b16 a[18:19], v30 offset:3616
    s_waitcnt lgkmcnt(8)
    v_mfma_f32_16x16x32_bf16 v[72:75], a[32:35], v[124:127], v[72:75]
    ds_read_b64_tr_b16 a[20:21], v30 offset:21504
    ds_read_b64_tr_b16 a[22:23], v30 offset:24064
    v_mfma_f32_16x16x32_bf16 v[76:79], a[36:39], v[124:127], v[76:79]
    ds_read_b64_tr_b16 a[24:25], v30 offset:21512
    ds_read_b64_tr_b16 a[26:27], v30 offset:24072
    buffer_load_dwordx4 v25, s[8:11], s57 offen offset:1024 lds
    v_mfma_f32_16x16x32_bf16 v[40:43], a[0:3], v[128:131], v[40:43]
    ds_read_b64_tr_b16 a[28:29], v30 offset:21520
    ds_read_b64_tr_b16 a[30:31], v30 offset:24080
    s_waitcnt lgkmcnt(8)
    v_mfma_f32_16x16x32_bf16 v[44:47], a[4:7], v[128:131], v[44:47]
    ds_read_b64_tr_b16 a[32:33], v30 offset:21528
    ds_read_b64_tr_b16 a[34:35], v30 offset:24088
    v_mfma_f32_16x16x32_bf16 v[48:51], a[8:11], v[128:131], v[48:51]
    ds_read_b64_tr_b16 a[36:37], v30 offset:21536
    ds_read_b64_tr_b16 a[38:39], v30 offset:24096
    buffer_load_dwordx4 v26, s[8:11], s57 offen offset:2048 lds
    v_mfma_f32_16x16x32_bf16 v[52:55], a[12:15], v[128:131], v[52:55]
    ds_read_b64_tr_b16 a[0:1], v30 offset:41984
    ds_read_b64_tr_b16 a[2:3], v30 offset:44544
    s_waitcnt lgkmcnt(8)
    v_mfma_f32_16x16x32_bf16 v[56:59], a[16:19], v[128:131], v[56:59]
    ds_read_b64_tr_b16 a[4:5], v30 offset:41992
    ds_read_b64_tr_b16 a[6:7], v30 offset:44552
    v_mfma_f32_16x16x32_bf16 v[60:63], a[20:23], v[128:131], v[60:63]
    ds_read_b64_tr_b16 a[8:9], v30 offset:42000
    ds_read_b64_tr_b16 a[10:11], v30 offset:44560
    buffer_load_dwordx4 v27, s[8:11], s57 offen offset:3072 lds
    s_add_u32 m0, s54, 9216
    v_mfma_f32_16x16x32_bf16 v[64:67], a[24:27], v[128:131], v[64:67]
    ds_read_b64_tr_b16 a[12:13], v30 offset:42008
    ds_read_b64_tr_b16 a[14:15], v30 offset:44568
    s_waitcnt lgkmcnt(8)
    v_mfma_f32_16x16x32_bf16 v[68:71], a[28:31], v[128:131], v[68:71]
    ds_read_b64_tr_b16 a[16:17], v30 offset:42016
    ds_read_b64_tr_b16 a[18:19], v30 offset:44576
    v_mfma_f32_16x16x32_bf16 v[72:75], a[32:35], v[128:131], v[72:75]
    ds_read_b64_tr_b16 a[20:21], v30 offset:62464
    ds_read_b64_tr_b16 a[22:23], v30 offset:65024
    buffer_load_dwordx4 v28, s[8:11], s57 offen offset:0 lds
    s_add_u32 s57, s57, 245760
    s_add_u32 m0, s54, 10240
    v_mfma_f32_16x16x32_bf16 v[76:79], a[36:39], v[128:131], v[76:79]
    ds_read_b64_tr_b16 a[24:25], v30 offset:62472
    ds_read_b64_tr_b16 a[26:27], v30 offset:65032
    s_waitcnt lgkmcnt(8)
    v_mfma_f32_16x16x32_bf16 v[40:43], a[0:3], v[132:135], v[40:43]
    ds_read_b64_tr_b16 a[28:29], v30 offset:62480
    ds_read_b64_tr_b16 a[30:31], v30 offset:65040
    v_mfma_f32_16x16x32_bf16 v[44:47], a[4:7], v[132:135], v[44:47]
    ds_read_b64_tr_b16 a[32:33], v30 offset:62488
    ds_read_b64_tr_b16 a[34:35], v30 offset:65048
    s_waitcnt vmcnt(13)
    s_barrier
    buffer_load_dwordx4 v24, s[8:11], s57 offen offset:0 lds
    v_mfma_f32_16x16x32_bf16 v[48:51], a[8:11], v[132:135], v[48:51]
    ds_read_b64_tr_b16 a[36:37], v30 offset:62496
    ds_read_b64_tr_b16 a[38:39], v30 offset:65056
    s_waitcnt lgkmcnt(8)
    v_mfma_f32_16x16x32_bf16 v[52:55], a[12:15], v[132:135], v[52:55]
    ds_read_b64_tr_b16 a[0:1], v30 offset:6144
    ds_read_b64_tr_b16 a[2:3], v30 offset:8704
    v_mfma_f32_16x16x32_bf16 v[56:59], a[16:19], v[132:135], v[56:59]
    ds_read_b64_tr_b16 a[4:5], v30 offset:6152
    ds_read_b64_tr_b16 a[6:7], v30 offset:8712
    buffer_load_dwordx4 v25, s[8:11], s57 offen offset:1024 lds
    v_mfma_f32_16x16x32_bf16 v[60:63], a[20:23], v[132:135], v[60:63]
    ds_read_b64_tr_b16 a[8:9], v30 offset:6160
    ds_read_b64_tr_b16 a[10:11], v30 offset:8720
    s_waitcnt lgkmcnt(8)
    v_mfma_f32_16x16x32_bf16 v[64:67], a[24:27], v[132:135], v[64:67]
    ds_read_b64_tr_b16 a[12:13], v30 offset:6168
    ds_read_b64_tr_b16 a[14:15], v30 offset:8728
    v_mfma_f32_16x16x32_bf16 v[68:71], a[28:31], v[132:135], v[68:71]
    ds_read_b64_tr_b16 a[16:17], v30 offset:6176
    ds_read_b64_tr_b16 a[18:19], v30 offset:8736
    buffer_load_dwordx4 v26, s[8:11], s57 offen offset:2048 lds
    v_mfma_f32_16x16x32_bf16 v[72:75], a[32:35], v[132:135], v[72:75]
    ds_read_b64_tr_b16 a[20:21], v30 offset:26624
    ds_read_b64_tr_b16 a[22:23], v30 offset:29184
    s_waitcnt lgkmcnt(8)
    v_mfma_f32_16x16x32_bf16 v[76:79], a[36:39], v[132:135], v[76:79]
    ds_read_b64_tr_b16 a[24:25], v30 offset:26632
    ds_read_b64_tr_b16 a[26:27], v30 offset:29192
    v_mfma_f32_16x16x32_bf16 v[40:43], a[0:3], v[136:139], v[40:43]
    ds_read_b64_tr_b16 a[28:29], v30 offset:26640
    ds_read_b64_tr_b16 a[30:31], v30 offset:29200
    buffer_load_dwordx4 v27, s[8:11], s57 offen offset:3072 lds
    s_add_u32 m0, s54, 14336
    v_mfma_f32_16x16x32_bf16 v[44:47], a[4:7], v[136:139], v[44:47]
    ds_read_b64_tr_b16 a[32:33], v30 offset:26648
    ds_read_b64_tr_b16 a[34:35], v30 offset:29208
    s_waitcnt lgkmcnt(8)
    v_mfma_f32_16x16x32_bf16 v[48:51], a[8:11], v[136:139], v[48:51]
    ds_read_b64_tr_b16 a[36:37], v30 offset:26656
    ds_read_b64_tr_b16 a[38:39], v30 offset:29216
    v_mfma_f32_16x16x32_bf16 v[52:55], a[12:15], v[136:139], v[52:55]
    ds_read_b64_tr_b16 a[0:1], v30 offset:47104
    ds_read_b64_tr_b16 a[2:3], v30 offset:49664
    buffer_load_dwordx4 v28, s[8:11], s57 offen offset:0 lds
    s_add_u32 s57, s57, 245760
    v_mfma_f32_16x16x32_bf16 v[56:59], a[16:19], v[136:139], v[56:59]
    ds_read_b64_tr_b16 a[4:5], v30 offset:47112
    ds_read_b64_tr_b16 a[6:7], v30 offset:49672
    s_waitcnt lgkmcnt(8)
    v_mfma_f32_16x16x32_bf16 v[60:63], a[20:23], v[136:139], v[60:63]
    ds_read_b64_tr_b16 a[8:9], v30 offset:47120
    ds_read_b64_tr_b16 a[10:11], v30 offset:49680
    v_mfma_f32_16x16x32_bf16 v[64:67], a[24:27], v[136:139], v[64:67]
    ds_read_b64_tr_b16 a[12:13], v30 offset:47128
    ds_read_b64_tr_b16 a[14:15], v30 offset:49688
    v_mfma_f32_16x16x32_bf16 v[68:71], a[28:31], v[136:139], v[68:71]
    ds_read_b64_tr_b16 a[16:17], v30 offset:47136
    ds_read_b64_tr_b16 a[18:19], v30 offset:49696
    s_waitcnt lgkmcnt(8)
    v_mfma_f32_16x16x32_bf16 v[72:75], a[32:35], v[136:139], v[72:75]
    ds_read_b64_tr_b16 a[20:21], v31 offset:2048
    ds_read_b64_tr_b16 a[22:23], v31 offset:4608
    v_mfma_f32_16x16x32_bf16 v[76:79], a[36:39], v[136:139], v[76:79]
    ds_read_b64_tr_b16 a[24:25], v31 offset:2056
    ds_read_b64_tr_b16 a[26:27], v31 offset:4616
    v_mfma_f32_16x16x32_bf16 v[40:43], a[0:3], v[140:143], v[40:43]
    ds_read_b64_tr_b16 a[28:29], v31 offset:2064
    ds_read_b64_tr_b16 a[30:31], v31 offset:4624
    s_waitcnt lgkmcnt(8)
    v_mfma_f32_16x16x32_bf16 v[44:47], a[4:7], v[140:143], v[44:47]
    ds_read_b64_tr_b16 a[32:33], v31 offset:2072
    ds_read_b64_tr_b16 a[34:35], v31 offset:4632
    v_mfma_f32_16x16x32_bf16 v[48:51], a[8:11], v[140:143], v[48:51]
    ds_read_b64_tr_b16 a[36:37], v31 offset:2080
    ds_read_b64_tr_b16 a[38:39], v31 offset:4640
    v_mfma_f32_16x16x32_bf16 v[52:55], a[12:15], v[140:143], v[52:55]
    ds_read_b64_tr_b16 a[0:1], v30 offset:11264
    ds_read_b64_tr_b16 a[2:3], v30 offset:13824
    s_waitcnt lgkmcnt(8)
    v_mfma_f32_16x16x32_bf16 v[56:59], a[16:19], v[140:143], v[56:59]
    ds_read_b64_tr_b16 a[4:5], v30 offset:11272
    ds_read_b64_tr_b16 a[6:7], v30 offset:13832
    v_mfma_f32_16x16x32_bf16 v[60:63], a[20:23], v[140:143], v[60:63]
    ds_read_b64_tr_b16 a[8:9], v30 offset:11280
    ds_read_b64_tr_b16 a[10:11], v30 offset:13840
    v_mfma_f32_16x16x32_bf16 v[64:67], a[24:27], v[140:143], v[64:67]
    ds_read_b64_tr_b16 a[12:13], v30 offset:11288
    ds_read_b64_tr_b16 a[14:15], v30 offset:13848
    s_waitcnt lgkmcnt(8)
    v_mfma_f32_16x16x32_bf16 v[68:71], a[28:31], v[140:143], v[68:71]
    ds_read_b64_tr_b16 a[16:17], v30 offset:11296
    ds_read_b64_tr_b16 a[18:19], v30 offset:13856
    v_mfma_f32_16x16x32_bf16 v[72:75], a[32:35], v[140:143], v[72:75]
    ds_read_b64_tr_b16 a[20:21], v30 offset:31744
    ds_read_b64_tr_b16 a[22:23], v30 offset:34304
    v_mfma_f32_16x16x32_bf16 v[76:79], a[36:39], v[140:143], v[76:79]
    ds_read_b64_tr_b16 a[24:25], v30 offset:31752
    ds_read_b64_tr_b16 a[26:27], v30 offset:34312
    s_waitcnt lgkmcnt(8)
    v_mfma_f32_16x16x32_bf16 v[40:43], a[0:3], v[144:147], v[40:43]
    ds_read_b64_tr_b16 a[28:29], v30 offset:31760
    ds_read_b64_tr_b16 a[30:31], v30 offset:34320
    v_mfma_f32_16x16x32_bf16 v[44:47], a[4:7], v[144:147], v[44:47]
    ds_read_b64_tr_b16 a[32:33], v30 offset:31768
    ds_read_b64_tr_b16 a[34:35], v30 offset:34328
    v_mfma_f32_16x16x32_bf16 v[48:51], a[8:11], v[144:147], v[48:51]
    ds_read_b64_tr_b16 a[36:37], v30 offset:31776
    ds_read_b64_tr_b16 a[38:39], v30 offset:34336
    buffer_load_dwordx4 v[176:179], v5, s[28:31], s73 offen offset:0 sc1
    buffer_load_dwordx4 v[180:183], v5, s[28:31], s73 offen offset:1024 sc1
    s_waitcnt lgkmcnt(8)
    v_mfma_f32_16x16x32_bf16 v[52:55], a[12:15], v[144:147], v[52:55]
    ds_read_b64_tr_b16 a[0:1], v30 offset:52224
    ds_read_b64_tr_b16 a[2:3], v30 offset:54784
    v_mfma_f32_16x16x32_bf16 v[56:59], a[16:19], v[144:147], v[56:59]
    ds_read_b64_tr_b16 a[4:5], v30 offset:52232
    ds_read_b64_tr_b16 a[6:7], v30 offset:54792
    v_mfma_f32_16x16x32_bf16 v[60:63], a[20:23], v[144:147], v[60:63]
    ds_read_b64_tr_b16 a[8:9], v30 offset:52240
    ds_read_b64_tr_b16 a[10:11], v30 offset:54800
    s_waitcnt lgkmcnt(8)
    v_mfma_f32_16x16x32_bf16 v[64:67], a[24:27], v[144:147], v[64:67]
    ds_read_b64_tr_b16 a[12:13], v30 offset:52248
    ds_read_b64_tr_b16 a[14:15], v30 offset:54808
    v_mfma_f32_16x16x32_bf16 v[68:71], a[28:31], v[144:147], v[68:71]
    ds_read_b64_tr_b16 a[16:17], v30 offset:52256
    ds_read_b64_tr_b16 a[18:19], v30 offset:54816
    v_mfma_f32_16x16x32_bf16 v[72:75], a[32:35], v[144:147], v[72:75]
    ds_read_b64_tr_b16 a[20:21], v31 offset:7168
    ds_read_b64_tr_b16 a[22:23], v31 offset:9728
    s_waitcnt lgkmcnt(8)
    v_mfma_f32_16x16x32_bf16 v[76:79], a[36:39], v[144:147], v[76:79]
    ds_read_b64_tr_b16 a[24:25], v31 offset:7176
    ds_read_b64_tr_b16 a[26:27], v31 offset:9736
    v_mfma_f32_16x16x32_bf16 v[40:43], a[0:3], v[148:151], v[40:43]
    ds_read_b64_tr_b16 a[28:29], v31 offset:7184
    ds_read_b64_tr_b16 a[30:31], v31 offset:9744
    v_mfma_f32_16x16x32_bf16 v[44:47], a[4:7], v[148:151], v[44:47]
    ds_read_b64_tr_b16 a[32:33], v31 offset:7192
    ds_read_b64_tr_b16 a[34:35], v31 offset:9752
    s_waitcnt vmcnt(0)
    s_barrier
    v_min3_u32 v6, v176, v178, v180
    v_min_u32 v6, v6, v182
    v_max3_u32 v7, v176, v178, v180
    v_max_u32 v7, v7, v182
    v_cmp_ne_u32 vcc, s83, v6
    v_cmp_ne_u32 s[92:93], s83, v7
    s_nop 0
    s_or_b64 vcc, vcc, s[92:93]
    s_cmp_lg_u64 vcc, 0
    s_cbranch_scc1 L_retry_21
L_ok_22:
    s_waitcnt lgkmcnt(8)
    v_mfma_f32_16x16x32_bf16 v[48:51], a[8:11], v[148:151], v[48:51]
    ds_read_b64_tr_b16 a[36:37], v31 offset:7200
    ds_read_b64_tr_b16 a[38:39], v31 offset:9760
    v_mfma_f32_16x16x32_bf16 v[52:55], a[12:15], v[148:151], v[52:55]
    ds_read_b64_tr_b16 a[0:1], v29 offset:0
    ds_read_b64_tr_b16 a[2:3], v29 offset:2560
    s_add_u32 s98, s51, 0
    s_add_u32 m0, s52, 0
    s_nop 0
    buffer_load_dwordx4 v5, s[28:31], s98 offen offset:0 sc1 lds
    v_mfma_f32_16x16x32_bf16 v[56:59], a[16:19], v[148:151], v[56:59]
    ds_read_b64_tr_b16 a[4:5], v29 offset:8
    ds_read_b64_tr_b16 a[6:7], v29 offset:2568
    s_waitcnt lgkmcnt(8)
    v_mfma_f32_16x16x32_bf16 v[60:63], a[20:23], v[148:151], v[60:63]
    ds_read_b64_tr_b16 a[8:9], v29 offset:16
    ds_read_b64_tr_b16 a[10:11], v29 offset:2576
    v_mfma_f32_16x16x32_bf16 v[64:67], a[24:27], v[148:151], v[64:67]
    ds_read_b64_tr_b16 a[12:13], v29 offset:24
    ds_read_b64_tr_b16 a[14:15], v29 offset:2584
    v_mfma_f32_16x16x32_bf16 v[68:71], a[28:31], v[148:151], v[68:71]
    ds_read_b64_tr_b16 a[16:17], v29 offset:32
    ds_read_b64_tr_b16 a[18:19], v29 offset:2592
    buffer_load_dwordx4 v5, s[28:31], s98 offen offset:1024 sc1 lds
    s_waitcnt lgkmcnt(8)
    v_mfma_f32_16x16x32_bf16 v[72:75], a[32:35], v[148:151], v[72:75]
    ds_read_b64_tr_b16 a[20:21], v29 offset:15360
    ds_read_b64_tr_b16 a[22:23], v29 offset:17920
    v_mfma_f32_16x16x32_bf16 v[76:79], a[36:39], v[148:151], v[76:79]
    ds_read_b64_tr_b16 a[24:25], v29 offset:15368
    ds_read_b64_tr_b16 a[26:27], v29 offset:17928
    v_mfma_f32_16x16x32_bf16 v[40:43], a[0:3], v[152:155], v[40:43]
    ds_read_b64_tr_b16 a[28:29], v29 offset:15376
    ds_read_b64_tr_b16 a[30:31], v29 offset:17936
    s_waitcnt lgkmcnt(8)
    v_mfma_f32_16x16x32_bf16 v[44:47], a[4:7], v[152:155], v[44:47]
    ds_read_b64_tr_b16 a[32:33], v29 offset:15384
    ds_read_b64_tr_b16 a[34:35], v29 offset:17944
    buffer_load_dwordx4 v5, s[28:31], s98 offen offset:2048 sc1 lds
    v_mfma_f32_16x16x32_bf16 v[48:51], a[8:11], v[152:155], v[48:51]
    ds_read_b64_tr_b16 a[36:37], v29 offset:15392
    ds_read_b64_tr_b16 a[38:39], v29 offset:17952
    v_mfma_f32_16x16x32_bf16 v[52:55], a[12:15], v[152:155], v[52:55]
    ds_read_b64_tr_b16 a[0:1], v29 offset:30720
    ds_read_b64_tr_b16 a[2:3], v29 offset:33280
    s_waitcnt lgkmcnt(8)
    v_mfma_f32_16x16x32_bf16 v[56:59], a[16:19], v[152:155], v[56:59]
    ds_read_b64_tr_b16 a[4:5], v29 offset:30728
    ds_read_b64_tr_b16 a[6:7], v29 offset:33288
    v_mfma_f32_16x16x32_bf16 v[60:63], a[20:23], v[152:155], v[60:63]
    ds_read_b64_tr_b16 a[8:9], v29 offset:30736
    ds_read_b64_tr_b16 a[10:11], v29 offset:33296
    buffer_load_dwordx4 v5, s[28:31], s98 offen offset:3072 sc1 lds
    s_add_u32 s98, s98, 4096
    s_add_u32 m0, s52, 4096
    v_mfma_f32_16x16x32_bf16 v[64:67], a[24:27], v[152:155], v[64:67]
    ds_read_b64_tr_b16 a[12:13], v29 offset:30744
    ds_read_b64_tr_b16 a[14:15], v29 offset:33304
    s_waitcnt lgkmcnt(8)
    v_mfma_f32_16x16x32_bf16 v[68:71], a[28:31], v[152:155], v[68:71]
    ds_read_b64_tr_b16 a[16:17], v29 offset:30752
    ds_read_b64_tr_b16 a[18:19], v29 offset:33312
    v_mfma_f32_16x16x32_bf16 v[72:75], a[32:35], v[152:155], v[72:75]
    ds_read_b64_tr_b16 a[20:21], v29 offset:46080
    ds_read_b64_tr_b16 a[22:23], v29 offset:48640
    v_mfma_f32_16x16x32_bf16 v[76:79], a[36:39], v[152:155], v[76:79]
    ds_read_b64_tr_b16 a[24:25], v29 offset:46088
    ds_read_b64_tr_b16 a[26:27], v29 offset:48648
    buffer_load_dwordx4 v5, s[28:31], s98 offen offset:0 sc1 lds
    s_add_u32 m0, s52, 5120
    s_waitcnt lgkmcnt(8)
    v_mfma_f32_16x16x32_bf16 v[40:43], a[0:3], v[156:159], v[40:43]
    ds_read_b64_tr_b16 a[28:29], v29 offset:46096
    ds_read_b64_tr_b16 a[30:31], v29 offset:48656
    v_mfma_f32_16x16x32_bf16 v[44:47], a[4:7], v[156:159], v[44:47]
    ds_read_b64_tr_b16 a[32:33], v29 offset:46104
    ds_read_b64_tr_b16 a[34:35], v29 offset:48664
    v_mfma_f32_16x16x32_bf16 v[48:51], a[8:11], v[156:159], v[48:51]
    ds_read_b64_tr_b16 a[36:37], v29 offset:46112
    ds_read_b64_tr_b16 a[38:39], v29 offset:48672
    s_waitcnt lgkmcnt(8)
    v_mfma_f32_16x16x32_bf16 v[52:55], a[12:15], v[156:159], v[52:55]
    ds_read_b64_tr_b16 a[0:1], v29 offset:5120
    ds_read_b64_tr_b16 a[2:3], v29 offset:7680
    s_add_u32 s98, s51, 20480
    buffer_load_dwordx4 v5, s[28:31], s98 offen offset:0 sc1 lds
    v_mfma_f32_16x16x32_bf16 v[56:59], a[16:19], v[156:159], v[56:59]
    ds_read_b64_tr_b16 a[4:5], v29 offset:5128
    ds_read_b64_tr_b16 a[6:7], v29 offset:7688
    v_mfma_f32_16x16x32_bf16 v[60:63], a[20:23], v[156:159], v[60:63]
    ds_read_b64_tr_b16 a[8:9], v29 offset:5136
    ds_read_b64_tr_b16 a[10:11], v29 offset:7696
    s_waitcnt lgkmcnt(8)
    v_mfma_f32_16x16x32_bf16 v[64:67], a[24:27], v[156:159], v[64:67]
    ds_read_b64_tr_b16 a[12:13], v29 offset:5144
    ds_read_b64_tr_b16 a[14:15], v29 offset:7704
    v_mfma_f32_16x16x32_bf16 v[68:71], a[28:31], v[156:159], v[68:71]
    ds_read_b64_tr_b16 a[16:17], v29 offset:5152
    ds_read_b64_tr_b16 a[18:19], v29 offset:7712
    buffer_load_dwordx4 v5, s[28:31], s98 offen offset:1024 sc1 lds
    v_mfma_f32_16x16x32_bf16 v[72:75], a[32:35], v[156:159], v[72:75]
    ds_read_b64_tr_b16 a[20:21], v29 offset:20480
    ds_read_b64_tr_b16 a[22:23], v29 offset:23040
    s_waitcnt lgkmcnt(8)
    v_mfma_f32_16x16x32_bf16 v[76:79], a[36:39], v[156:159], v[76:79]
    ds_read_b64_tr_b16 a[24:25], v29 offset:20488
    ds_read_b64_tr_b16 a[26:27], v29 offset:23048
    v_mfma_f32_16x16x32_bf16 v[40:43], a[0:3], v[160:163], v[40:43]
    ds_read_b64_tr_b16 a[28:29], v29 offset:20496
    ds_read_b64_tr_b16 a[30:31], v29 offset:23056
    v_mfma_f32_16x16x32_bf16 v[44:47], a[4:7], v[160:163], v[44:47]
    ds_read_b64_tr_b16 a[32:33], v29 offset:20504
    ds_read_b64_tr_b16 a[34:35], v29 offset:23064
    buffer_load_dwordx4 v5, s[28:31], s98 offen offset:2048 sc1 lds
    s_waitcnt lgkmcnt(8)
    v_mfma_f32_16x16x32_bf16 v[48:51], a[8:11], v[160:163], v[48:51]
    ds_read_b64_tr_b16 a[36:37], v29 offset:20512
    ds_read_b64_tr_b16 a[38:39], v29 offset:23072
    v_mfma_f32_16x16x32_bf16 v[52:55], a[12:15], v[160:163], v[52:55]
    ds_read_b64_tr_b16 a[0:1], v29 offset:35840
    ds_read_b64_tr_b16 a[2:3], v29 offset:38400
    v_mfma_f32_16x16x32_bf16 v[56:59], a[16:19], v[160:163], v[56:59]
    ds_read_b64_tr_b16 a[4:5], v29 offset:35848
    ds_read_b64_tr_b16 a[6:7], v29 offset:38408
    s_waitcnt lgkmcnt(8)
    v_mfma_f32_16x16x32_bf16 v[60:63], a[20:23], v[160:163], v[60:63]
    ds_read_b64_tr_b16 a[8:9], v29 offset:35856
    ds_read_b64_tr_b16 a[10:11], v29 offset:38416
    buffer_load_dwordx4 v5, s[28:31], s98 offen offset:3072 sc1 lds
    s_add_u32 s98, s98, 4096
    s_add_u32 m0, s52, 9216
    v_mfma_f32_16x16x32_bf16 v[64:67], a[24:27], v[160:163], v[64:67]
    ds_read_b64_tr_b16 a[12:13], v29 offset:35864
    ds_read_b64_tr_b16 a[14:15], v29 offset:38424
    v_mfma_f32_16x16x32_bf16 v[68:71], a[28:31], v[160:163], v[68:71]
    ds_read_b64_tr_b16 a[16:17], v29 offset:35872
    ds_read_b64_tr_b16 a[18:19], v29 offset:38432
    s_waitcnt lgkmcnt(8)
    v_mfma_f32_16x16x32_bf16 v[72:75], a[32:35], v[160:163], v[72:75]
    ds_read_b64_tr_b16 a[20:21], v29 offset:51200
    ds_read_b64_tr_b16 a[22:23], v29 offset:53760
    v_mfma_f32_16x16x32_bf16 v[76:79], a[36:39], v[160:163], v[76:79]
    ds_read_b64_tr_b16 a[24:25], v29 offset:51208
    ds_read_b64_tr_b16 a[26:27], v29 offset:53768
    buffer_load_dwordx4 v5, s[28:31], s98 offen offset:0 sc1 lds
    s_add_u32 m0, s52, 10240
    v_mfma_f32_16x16x32_bf16 v[40:43], a[0:3], v[164:167], v[40:43]
    ds_read_b64_tr_b16 a[28:29], v29 offset:51216
    ds_read_b64_tr_b16 a[30:31], v29 offset:53776
    s_waitcnt lgkmcnt(8)
    v_mfma_f32_16x16x32_bf16 v[44:47], a[4:7], v[164:167], v[44:47]
    ds_read_b64_tr_b16 a[32:33], v29 offset:51224
    ds_read_b64_tr_b16 a[34:35], v29 offset:53784
    v_mfma_f32_16x16x32_bf16 v[48:51], a[8:11], v[164:167], v[48:51]
    ds_read_b64_tr_b16 a[36:37], v29 offset:51232
    ds_read_b64_tr_b16 a[38:39], v29 offset:53792
    v_mfma_f32_16x16x32_bf16 v[52:55], a[12:15], v[164:167], v[52:55]
    ds_read_b64_tr_b16 a[0:1], v29 offset:10240
    ds_read_b64_tr_b16 a[2:3], v29 offset:12800
    s_add_u32 s98, s51, 40960
    buffer_load_dwordx4 v5, s[28:31], s98 offen offset:0 sc1 lds
    s_waitcnt lgkmcnt(8)
    v_mfma_f32_16x16x32_bf16 v[56:59], a[16:19], v[164:167], v[56:59]
    ds_read_b64_tr_b16 a[4:5], v29 offset:10248
    ds_read_b64_tr_b16 a[6:7], v29 offset:12808
    v_mfma_f32_16x16x32_bf16 v[60:63], a[20:23], v[164:167], v[60:63]
    ds_read_b64_tr_b16 a[8:9], v29 offset:10256
    ds_read_b64_tr_b16 a[10:11], v29 offset:12816
    v_mfma_f32_16x16x32_bf16 v[64:67], a[24:27], v[164:167], v[64:67]
    ds_read_b64_tr_b16 a[12:13], v29 offset:10264
    ds_read_b64_tr_b16 a[14:15], v29 offset:12824
    s_waitcnt lgkmcnt(8)
    v_mfma_f32_16x16x32_bf16 v[68:71], a[28:31], v[164:167], v[68:71]
    ds_read_b64_tr_b16 a[16:17], v29 offset:10272
    ds_read_b64_tr_b16 a[18:19], v29 offset:12832
    buffer_load_dwordx4 v5, s[28:31], s98 offen offset:1024 sc1 lds
    v_mfma_f32_16x16x32_bf16 v[72:75], a[32:35], v[164:167], v[72:75]
    ds_read_b64_tr_b16 a[20:21], v29 offset:25600
    ds_read_b64_tr_b16 a[22:23], v29 offset:28160
    v_mfma_f32_16x16x32_bf16 v[76:79], a[36:39], v[164:167], v[76:79]
    ds_read_b64_tr_b16 a[24:25], v29 offset:25608
    ds_read_b64_tr_b16 a[26:27], v29 offset:28168
    s_waitcnt lgkmcnt(8)
    v_mfma_f32_16x16x32_bf16 v[40:43], a[0:3], v[168:171], v[40:43]
    ds_read_b64_tr_b16 a[28:29], v29 offset:25616
    ds_read_b64_tr_b16 a[30:31], v29 offset:28176
    v_mfma_f32_16x16x32_bf16 v[44:47], a[4:7], v[168:171], v[44:47]
    ds_read_b64_tr_b16 a[32:33], v29 offset:25624
    ds_read_b64_tr_b16 a[34:35], v29 offset:28184
    buffer_load_dwordx4 v5, s[28:31], s98 offen offset:2048 sc1 lds
    v_mfma_f32_16x16x32_bf16 v[48:51], a[8:11], v[168:171], v[48:51]
    ds_read_b64_tr_b16 a[36:37], v29 offset:25632
    ds_read_b64_tr_b16 a[38:39], v29 offset:28192
    s_waitcnt lgkmcnt(8)
    v_mfma_f32_16x16x32_bf16 v[52:55], a[12:15], v[168:171], v[52:55]
    ds_read_b64_tr_b16 a[0:1], v29 offset:40960
    ds_read_b64_tr_b16 a[2:3], v29 offset:43520
    v_mfma_f32_16x16x32_bf16 v[56:59], a[16:19], v[168:171], v[56:59]
    ds_read_b64_tr_b16 a[4:5], v29 offset:40968
    ds_read_b64_tr_b16 a[6:7], v29 offset:43528
    v_mfma_f32_16x16x32_bf16 v[60:63], a[20:23], v[168:171], v[60:63]
    ds_read_b64_tr_b16 a[8:9], v29 offset:40976
    ds_read_b64_tr_b16 a[10:11], v29 offset:43536
    buffer_load_dwordx4 v5, s[28:31], s98 offen offset:3072 sc1 lds
    s_add_u32 s98, s98, 4096
    s_add_u32 m0, s52, 14336
    s_waitcnt lgkmcnt(8)
    v_mfma_f32_16x16x32_bf16 v[64:67], a[24:27], v[168:171], v[64:67]
    ds_read_b64_tr_b16 a[12:13], v29 offset:40984
    ds_read_b64_tr_b16 a[14:15], v29 offset:43544
    v_mfma_f32_16x16x32_bf16 v[68:71], a[28:31], v[168:171], v[68:71]
    ds_read_b64_tr_b16 a[16:17], v29 offset:40992
    ds_read_b64_tr_b16 a[18:19], v29 offset:43552
    v_mfma_f32_16x16x32_bf16 v[72:75], a[32:35], v[168:171], v[72:75]
    ds_read_b64_tr_b16 a[20:21], v29 offset:56320
    ds_read_b64_tr_b16 a[22:23], v29 offset:58880
    s_waitcnt lgkmcnt(8)
    v_mfma_f32_16x16x32_bf16 v[76:79], a[36:39], v[168:171], v[76:79]
    ds_read_b64_tr_b16 a[24:25], v29 offset:56328
    ds_read_b64_tr_b16 a[26:27], v29 offset:58888
    buffer_load_dwordx4 v5, s[28:31], s98 offen offset:0 sc1 lds
    v_mfma_f32_16x16x32_bf16 v[40:43], a[0:3], v[172:175], v[40:43]
    ds_read_b64_tr_b16 a[28:29], v29 offset:56336
    ds_read_b64_tr_b16 a[30:31], v29 offset:58896
    v_mfma_f32_16x16x32_bf16 v[44:47], a[4:7], v[172:175], v[44:47]
    ds_read_b64_tr_b16 a[32:33], v29 offset:56344
    ds_read_b64_tr_b16 a[34:35], v29 offset:58904
    s_waitcnt lgkmcnt(8)
    v_mfma_f32_16x16x32_bf16 v[48:51], a[8:11], v[172:175], v[48:51]
    ds_read_b64_tr_b16 a[36:37], v29 offset:56352
    ds_read_b64_tr_b16 a[38:39], v29 offset:58912
    v_mfma_f32_16x16x32_bf16 v[52:55], a[12:15], v[172:175], v[52:55]
    v_mfma_f32_16x16x32_bf16 v[56:59], a[16:19], v[172:175], v[56:59]
    s_waitcnt lgkmcnt(4)
    v_mfma_f32_16x16x32_bf16 v[60:63], a[20:23], v[172:175], v[60:63]
    v_mfma_f32_16x16x32_bf16 v[64:67], a[24:27], v[172:175], v[64:67]
    v_mfma_f32_16x16x32_bf16 v[68:71], a[28:31], v[172:175], v[68:71]
    s_waitcnt lgkmcnt(0)
    v_mfma_f32_16x16x32_bf16 v[72:75], a[32:35], v[172:175], v[72:75]
    v_mfma_f32_16x16x32_bf16 v[76:79], a[36:39], v[172:175], v[76:79]
    ds_read_b128 a[148:151], v84 offset:0
    ds_read_b128 a[152:155], v84 offset:192
    ds_read_b128 a[156:159], v84 offset:384
    ds_read_b128 a[160:163], v84 offset:576
    ds_read_b128 a[164:167], v84 offset:768
    ds_read_b128 a[168:171], v84 offset:16
    ds_read_b128 a[172:175], v84 offset:208
    ds_read_b128 a[176:179], v84 offset:400
    ds_read_b128 a[180:183], v84 offset:592
    ds_read_b128 a[184:187], v84 offset:784
    ds_read_b128 a[188:191], v84 offset:32
    ds_read_b128 a[192:195], v84 offset:224
    ds_read_b128 a[196:199], v84 offset:416
    ds_read_b128 a[200:203], v84 offset:608
    ds_read_b128 a[204:207], v84 offset:800
    s_barrier
    v_add_u32 v29, 0x20000, v5
    v_mov_b32 v254, 0
    v_mov_b32 v255, 0
    v_cvt_pk_bf16_f32 v244, v40, v41
    v_cvt_pk_bf16_f32 v245, v42, v43
    v_cvt_pk_bf16_f32 v246, v44, v45
    v_cvt_pk_bf16_f32 v247, v46, v47
    v_cvt_pk_bf16_f32 v248, v48, v49
    v_cvt_pk_bf16_f32 v249, v50, v51
    v_cvt_pk_bf16_f32 v250, v52, v53
    v_cvt_pk_bf16_f32 v251, v54, v55
    v_cvt_pk_bf16_f32 v252, v56, v57
    v_cvt_pk_bf16_f32 v253, v58, v59
    s_add_u32 s98, s51, 61440
    s_add_u32 m0, s52, 15360
    s_nop 0
    buffer_load_dwordx4 v5, s[28:31], s98 offen offset:0 sc1 lds
    s_waitcnt lgkmcnt(10)
    v_mfma_f32_16x16x32_bf16 v[224:227], a[148:151], v[244:247], 0
    v_mfma_f32_16x16x32_bf16 v[228:231], a[152:155], v[244:247], 0
    v_mfma_f32_16x16x32_bf16 v[232:235], a[156:159], v[244:247], 0
    v_mfma_f32_16x16x32_bf16 v[236:239], a[160:163], v[244:247], 0
    v_mfma_f32_16x16x32_bf16 v[240:243], a[164:167], v[244:247], 0
    s_waitcnt lgkmcnt(5)
    v_mfma_f32_16x16x32_bf16 v[224:227], a[168:171], v[248:251], v[224:227]
    v_mfma_f32_16x16x32_bf16 v[228:231], a[172:175], v[248:251], v[228:231]
    v_mfma_f32_16x16x32_bf16 v[232:235], a[176:179], v[248:251], v[232:235]
    v_mfma_f32_16x16x32_bf16 v[236:239], a[180:183], v[248:251], v[236:239]
    v_mfma_f32_16x16x32_bf16 v[240:243], a[184:187], v[248:251], v[240:243]
    s_waitcnt lgkmcnt(0)
    v_mfma_f32_16x16x32_bf16 v[224:227], a[188:191], v[252:255], v[224:227]
    v_mfma_f32_16x16x32_bf16 v[228:231], a[192:195], v[252:255], v[228:231]
    v_mfma_f32_16x16x32_bf16 v[232:235], a[196:199], v[252:255], v[232:235]
    v_mfma_f32_16x16x32_bf16 v[236:239], a[200:203], v[252:255], v[236:239]
    v_mfma_f32_16x16x32_bf16 v[240:243], a[204:207], v[252:255], v[240:243]
    v_cvt_pk_bf16_f32 v204, v60, v61
    v_cvt_pk_bf16_f32 v205, v62, v63
    v_cvt_pk_bf16_f32 v206, v64, v65
    v_cvt_pk_bf16_f32 v207, v66, v67
    v_cvt_pk_bf16_f32 v208, v68, v69
    v_cvt_pk_bf16_f32 v209, v70, v71
    v_cvt_pk_bf16_f32 v210, v72, v73
    v_cvt_pk_bf16_f32 v211, v74, v75
    v_cvt_pk_bf16_f32 v212, v76, v77
    v_cvt_pk_bf16_f32 v213, v78, v79
    v_mov_b32 v214, 0x3f80
    v_mov_b32 v215, 0
    buffer_load_dwordx4 v5, s[28:31], s98 offen offset:1024 sc1 lds
    ds_write_b128 v86, v[204:207] offset:10240
    ds_write_b128 v86, v[208:211] offset:10256
    ds_write_b128 v86, v[212:215] offset:10272
    v_max3_f32 v6, v224, v225, v226
    v_min3_f32 v7, v224, v225, v226
    v_max3_f32 v6, v6, v227, v228
    v_min3_f32 v7, v7, v227, v228
    v_max3_f32 v6, v6, v229, v230
    v_min3_f32 v7, v7, v229, v230
    v_max3_f32 v6, v6, v231, v232
    v_min3_f32 v7, v7, v231, v232
    v_max3_f32 v6, v6, v233, v234
    v_min3_f32 v7, v7, v233, v234
    v_max3_f32 v6, v6, v235, v236
    v_min3_f32 v7, v7, v235, v236
    buffer_load_dwordx4 v5, s[28:31], s98 offen offset:2048 sc1 lds
    v_max3_f32 v6, v6, v237, v238
    v_min3_f32 v7, v7, v237, v238
    v_max3_f32 v6, v6, v239, v240
    v_min3_f32 v7, v7, v239, v240
    v_max3_f32 v6, v6, v241, v242
    v_min3_f32 v7, v7, v241, v242
    v_max_f32 v6, v6, v243
    v_min_f32 v7, v7, v243
    v_mul_f32 v6, 0xbfb8aa3b, v6
    v_mul_f32 v7, 0x3fb8aa3b, v7
    v_pk_fma_f32 v[204:205], v[224:225], s[86:87], v[6:7] op_sel:[0,0,0] op_sel_hi:[1,1,0]
    v_pk_fma_f32 v[184:185], v[224:225], s[86:87], v[6:7] op_sel:[0,0,1] op_sel_hi:[1,1,1] neg_lo:[1,0,0] neg_hi:[1,0,0]
    buffer_load_dwordx4 v5, s[28:31], s98 offen offset:3072 sc1 lds
    s_add_u32 s98, s98, 4096
    s_add_u32 m0, s52, 19456
    v_pk_fma_f32 v[206:207], v[226:227], s[86:87], v[6:7] op_sel:[0,0,0] op_sel_hi:[1,1,0]
    v_pk_fma_f32 v[186:187], v[226:227], s[86:87], v[6:7] op_sel:[0,0,1] op_sel_hi:[1,1,1] neg_lo:[1,0,0] neg_hi:[1,0,0]
    v_pk_fma_f32 v[208:209], v[228:229], s[86:87], v[6:7] op_sel:[0,0,0] op_sel_hi:[1,1,0]
    v_pk_fma_f32 v[188:189], v[228:229], s[86:87], v[6:7] op_sel:[0,0,1] op_sel_hi:[1,1,1] neg_lo:[1,0,0] neg_hi:[1,0,0]
    v_pk_fma_f32 v[210:211], v[230:231], s[86:87], v[6:7] op_sel:[0,0,0] op_sel_hi:[1,1,0]
    v_pk_fma_f32 v[190:191], v[230:231], s[86:87], v[6:7] op_sel:[0,0,1] op_sel_hi:[1,1,1] neg_lo:[1,0,0] neg_hi:[1,0,0]
    v_pk_fma_f32 v[212:213], v[232:233], s[86:87], v[6:7] op_sel:[0,0,0] op_sel_hi:[1,1,0]
    v_pk_fma_f32 v[192:193], v[232:233], s[86:87], v[6:7] op_sel:[0,0,1] op_sel_hi:[1,1,1] neg_lo:[1,0,0] neg_hi:[1,0,0]
    v_pk_fma_f32 v[214:215], v[234:235], s[86:87], v[6:7] op_sel:[0,0,0] op_sel_hi:[1,1,0]
    v_pk_fma_f32 v[194:195], v[234:235], s[86:87], v[6:7] op_sel:[0,0,1] op_sel_hi:[1,1,1] neg_lo:[1,0,0] neg_hi:[1,0,0]
    v_pk_fma_f32 v[216:217], v[236:237], s[86:87], v[6:7] op_sel:[0,0,0] op_sel_hi:[1,1,0]
    v_pk_fma_f32 v[196:197], v[236:237], s[86:87], v[6:7] op_sel:[0,0,1] op_sel_hi:[1,1,1] neg_lo:[1,0,0] neg_hi:[1,0,0]
    buffer_load_dwordx4 v5, s[28:31], s98 offen offset:0 sc1 lds
    s_add_u32 m0, s54, 0
    v_pk_fma_f32 v[218:219], v[238:239], s[86:87], v[6:7] op_sel:[0,0,0] op_sel_hi:[1,1,0]
    v_pk_fma_f32 v[198:199], v[238:239], s[86:87], v[6:7] op_sel:[0,0,1] op_sel_hi:[1,1,1] neg_lo:[1,0,0] neg_hi:[1,0,0]
    v_pk_fma_f32 v[220:221], v[240:241], s[86:87], v[6:7] op_sel:[0,0,0] op_sel_hi:[1,1,0]
    v_pk_fma_f32 v[200:201], v[240:241], s[86:87], v[6:7] op_sel:[0,0,1] op_sel_hi:[1,1,1] neg_lo:[1,0,0] neg_hi:[1,0,0]
    v_pk_fma_f32 v[222:223], v[242:243], s[86:87], v[6:7] op_sel:[0,0,0] op_sel_hi:[1,1,0]
    v_pk_fma_f32 v[202:203], v[242:243], s[86:87], v[6:7] op_sel:[0,0,1] op_sel_hi:[1,1,1] neg_lo:[1,0,0] neg_hi:[1,0,0]
    v_exp_f32 v204, v204
    v_exp_f32 v205, v205
    v_exp_f32 v206, v206
    v_exp_f32 v207, v207
    v_exp_f32 v208, v208
    v_exp_f32 v209, v209
    s_add_u32 s98, s51, 81920
    buffer_load_dwordx4 v5, s[28:31], s98 offen offset:0 sc1 lds
    v_exp_f32 v210, v210
    v_exp_f32 v211, v211
    v_exp_f32 v212, v212
    v_exp_f32 v213, v213
    v_exp_f32 v214, v214
    v_exp_f32 v215, v215
    v_exp_f32 v216, v216
    v_exp_f32 v217, v217
    v_exp_f32 v218, v218
    v_exp_f32 v219, v219
    v_exp_f32 v220, v220
    v_exp_f32 v221, v221
    buffer_load_dwordx4 v5, s[28:31], s98 offen offset:1024 sc1 lds
    v_exp_f32 v222, v222
    v_exp_f32 v223, v223
    v_exp_f32 v184, v184
    v_exp_f32 v185, v185
    v_exp_f32 v186, v186
    v_exp_f32 v187, v187
    v_exp_f32 v188, v188
    v_exp_f32 v189, v189
    v_exp_f32 v190, v190
    v_exp_f32 v191, v191
    v_exp_f32 v192, v192
    v_exp_f32 v193, v193
    buffer_load_dwordx4 v5, s[28:31], s98 offen offset:2048 sc1 lds
    v_exp_f32 v194, v194
    v_exp_f32 v195, v195
    v_exp_f32 v196, v196
    v_exp_f32 v197, v197
    v_exp_f32 v198, v198
    v_exp_f32 v199, v199
    v_exp_f32 v200, v200
    v_exp_f32 v201, v201
    v_exp_f32 v202, v202
    v_exp_f32 v203, v203
    v_pk_add_f32 v[8:9], v[204:205], v[206:207]
    v_pk_add_f32 v[10:11], v[184:185], v[186:187]
    buffer_load_dwordx4 v5, s[28:31], s98 offen offset:3072 sc1 lds
    s_add_u32 s98, s98, 4096
    s_add_u32 m0, s54, 4096
    v_pk_add_f32 v[8:9], v[8:9], v[208:209]
    v_pk_add_f32 v[10:11], v[10:11], v[188:189]
    v_pk_add_f32 v[8:9], v[8:9], v[210:211]
    v_pk_add_f32 v[10:11], v[10:11], v[190:191]
    v_pk_add_f32 v[8:9], v[8:9], v[212:213]
    v_pk_add_f32 v[10:11], v[10:11], v[192:193]
    v_pk_add_f32 v[8:9], v[8:9], v[214:215]
    v_pk_add_f32 v[10:11], v[10:11], v[194:195]
    v_pk_add_f32 v[8:9], v[8:9], v[216:217]
    v_pk_add_f32 v[10:11], v[10:11], v[196:197]
    v_pk_add_f32 v[8:9], v[8:9], v[218:219]
    v_pk_add_f32 v[10:11], v[10:11], v[198:199]
    buffer_load_dwordx4 v5, s[28:31], s98 offen offset:0 sc1 lds
    v_pk_add_f32 v[8:9], v[8:9], v[220:221]
    v_pk_add_f32 v[10:11], v[10:11], v[200:201]
    v_pk_add_f32 v[8:9], v[8:9], v[222:223]
    v_pk_add_f32 v[10:11], v[10:11], v[202:203]
    v_add_f32 v8, v8, v9
    v_add_f32 v10, v10, v11
    v_rcp_f32 v8, v8
    v_rcp_f32 v10, v10
    v_pk_mul_f32 v[204:205], v[204:205], v[8:9] op_sel_hi:[1,0]
    v_pk_mul_f32 v[206:207], v[206:207], v[8:9] op_sel_hi:[1,0]
    v_pk_mul_f32 v[208:209], v[208:209], v[8:9] op_sel_hi:[1,0]
    v_pk_mul_f32 v[210:211], v[210:211], v[8:9] op_sel_hi:[1,0]
    v_pk_mul_f32 v[212:213], v[212:213], v[8:9] op_sel_hi:[1,0]
    v_pk_mul_f32 v[214:215], v[214:215], v[8:9] op_sel_hi:[1,0]
    v_pk_mul_f32 v[216:217], v[216:217], v[8:9] op_sel_hi:[1,0]
    v_pk_mul_f32 v[218:219], v[218:219], v[8:9] op_sel_hi:[1,0]
    v_pk_mul_f32 v[220:221], v[220:221], v[8:9] op_sel_hi:[1,0]
    v_pk_mul_f32 v[222:223], v[222:223], v[8:9] op_sel_hi:[1,0]
    v_pk_mul_f32 v[184:185], v[184:185], v[10:11] op_sel_hi:[1,0]
    v_pk_mul_f32 v[186:187], v[186:187], v[10:11] op_sel_hi:[1,0]
    v_pk_mul_f32 v[188:189], v[188:189], v[10:11] op_sel_hi:[1,0]
    v_pk_mul_f32 v[190:191], v[190:191], v[10:11] op_sel_hi:[1,0]
    v_pk_mul_f32 v[192:193], v[192:193], v[10:11] op_sel_hi:[1,0]
    v_pk_mul_f32 v[194:195], v[194:195], v[10:11] op_sel_hi:[1,0]
    buffer_load_dwordx4 v[64:67], v35, s[36:39], s70 offen
    s_add_u32 s70, s70, 7680
    buffer_load_dwordx4 v[68:71], v35, s[36:39], s70 offen
    s_add_u32 s70, s70, 7680
    buffer_load_dwordx4 v[72:75], v35, s[36:39], s70 offen
    s_add_u32 s70, s70, 7680
    buffer_load_dwordx4 v[76:79], v35, s[36:39], s70 offen
    v_pk_mul_f32 v[196:197], v[196:197], v[10:11] op_sel_hi:[1,0]
    v_pk_mul_f32 v[198:199], v[198:199], v[10:11] op_sel_hi:[1,0]
    v_pk_mul_f32 v[200:201], v[200:201], v[10:11] op_sel_hi:[1,0]
    v_pk_mul_f32 v[202:203], v[202:203], v[10:11] op_sel_hi:[1,0]
    v_cvt_pk_bf16_f32 v40, v204, v205
    v_cvt_pk_bf16_f32 v41, v206, v207
    v_cvt_pk_bf16_f32 v42, v208, v209
    v_cvt_pk_bf16_f32 v43, v210, v211
    v_cvt_pk_bf16_f32 v44, v212, v213
    v_cvt_pk_bf16_f32 v45, v214, v215
    v_cvt_pk_bf16_f32 v46, v216, v217
    v_cvt_pk_bf16_f32 v47, v218, v219
    v_cvt_pk_bf16_f32 v48, v220, v221
    v_cvt_pk_bf16_f32 v49, v222, v223
    v_cvt_pk_bf16_f32 v50, v184, v185
    v_cvt_pk_bf16_f32 v51, v186, v187
    v_cvt_pk_bf16_f32 v52, v188, v189
    v_cvt_pk_bf16_f32 v53, v190, v191
    v_cvt_pk_bf16_f32 v54, v192, v193
    v_cvt_pk_bf16_f32 v55, v194, v195
    v_cvt_pk_bf16_f32 v56, v196, v197
    v_cvt_pk_bf16_f32 v57, v198, v199
    v_cvt_pk_bf16_f32 v58, v200, v201
    v_cvt_pk_bf16_f32 v59, v202, v203
    ds_write_b128 v85, v[40:43] offset:5120
    ds_write_b128 v85, v[44:47] offset:5136
    ds_write_b128 v85, v[48:51] offset:5152
    ds_write_b128 v85, v[52:55] offset:5168
    ds_write_b128 v85, v[56:59] offset:5184
    v_mov_b32 v244, s83
    s_mov_b32 s89, 0xff
    v_lshrrev_b32 v245, 8, v244
    v_lshrrev_b32 v246, 16, v244
    v_lshrrev_b32 v247, 24, v244
    s_waitcnt lgkmcnt(0)
    s_barrier
    ds_read_b64_tr_b16 a[12:13], v88 offset:10240
    ds_read_b64_tr_b16 a[14:15], v88 offset:11008
    ds_read_b64_tr_b16 a[16:17], v88 offset:10272
    ds_read_b64_tr_b16 a[18:19], v88 offset:11040
    ds_read_b64_tr_b16 a[0:1], v87 offset:5120
    ds_read_b64_tr_b16 a[2:3], v87 offset:6400
    ds_read_b64_tr_b16 a[4:5], v87 offset:5152
    ds_read_b64_tr_b16 a[6:7], v87 offset:6432
    ds_read_b64_tr_b16 a[8:9], v87 offset:5184
    ds_read_b64_tr_b16 a[10:11], v87 offset:6464
    ds_read_b64_tr_b16 a[32:33], v88 offset:11776
    ds_read_b64_tr_b16 a[34:35], v88 offset:12544
    ds_read_b64_tr_b16 a[36:37], v88 offset:11808
    ds_read_b64_tr_b16 a[38:39], v88 offset:12576
    ds_read_b64_tr_b16 a[20:21], v87 offset:7680
    s_waitcnt lgkmcnt(5)
    v_mfma_f32_16x16x32_bf16 v[40:43], a[0:3], a[12:15], 0
    v_mfma_f32_16x16x32_bf16 v[44:47], a[0:3], a[16:19], 0
    v_mfma_f32_16x16x32_bf16 v[48:51], a[4:7], a[12:15], 0
    v_mfma_f32_16x16x32_bf16 v[52:55], a[4:7], a[16:19], 0
    v_mfma_f32_16x16x32_bf16 v[56:59], a[8:11], a[12:15], 0
    v_mfma_f32_16x16x32_bf16 v[60:63], a[8:11], a[16:19], 0
    ds_read_b64_tr_b16 a[22:23], v87 offset:8960
    ds_read_b64_tr_b16 a[24:25], v87 offset:7712
    ds_read_b64_tr_b16 a[26:27], v87 offset:8992
    ds_read_b64_tr_b16 a[28:29], v87 offset:7744
    ds_read_b64_tr_b16 a[30:31], v87 offset:9024
    s_waitcnt lgkmcnt(0)
    v_mfma_f32_16x16x32_bf16 v[40:43], a[20:23], a[32:35], v[40:43]
    v_mfma_f32_16x16x32_bf16 v[44:47], a[20:23], a[36:39], v[44:47]
    v_mfma_f32_16x16x32_bf16 v[48:51], a[24:27], a[32:35], v[48:51]
    v_mfma_f32_16x16x32_bf16 v[52:55], a[24:27], a[36:39], v[52:55]
    v_mfma_f32_16x16x32_bf16 v[56:59], a[28:31], a[32:35], v[56:59]
    v_mfma_f32_16x16x32_bf16 v[60:63], a[28:31], a[36:39], v[60:63]
    s_nop 2
    v_bfi_b32 v40, s89, v244, v40
    v_bfi_b32 v41, s89, v245, v41
    v_bfi_b32 v42, s89, v246, v42
    v_bfi_b32 v43, s89, v247, v43
    buffer_store_dwordx4 v[40:43], v89, s[28:31], s4 offen sc1
    v_bfi_b32 v44, s89, v244, v44
    v_bfi_b32 v45, s89, v245, v45
    v_bfi_b32 v46, s89, v246, v46
    v_bfi_b32 v47, s89, v247, v47
    buffer_store_dwordx4 v[44:47], v90, s[28:31], s4 offen sc1
    v_bfi_b32 v48, s89, v244, v48
    v_bfi_b32 v49, s89, v245, v49
    v_bfi_b32 v50, s89, v246, v50
    v_bfi_b32 v51, s89, v247, v51
    buffer_store_dwordx4 v[48:51], v91, s[28:31], s4 offen sc1
    v_bfi_b32 v52, s89, v244, v52
    v_bfi_b32 v53, s89, v245, v53
    v_bfi_b32 v54, s89, v246, v54
    v_bfi_b32 v55, s89, v247, v55
    buffer_store_dwordx4 v[52:55], v92, s[28:31], s4 offen sc1
    v_bfi_b32 v56, s89, v244, v56
    v_bfi_b32 v57, s89, v245, v57
    v_bfi_b32 v58, s89, v246, v58
    v_bfi_b32 v59, s89, v247, v59
    buffer_store_dwordx4 v[56:59], v93, s[28:31], s4 offen sc1
    v_bfi_b32 v60, s89, v244, v60
    v_bfi_b32 v61, s89, v245, v61
    v_bfi_b32 v62, s89, v246, v62
    v_bfi_b32 v63, s89, v247, v63
    buffer_store_dwordx4 v[60:63], v94, s[28:31], s4 offen sc1
    s_waitcnt vmcnt(10)
    s_barrier
    ds_read_b128 a[0:3], v5 offset:61440
    ds_read_b128 a[4:7], v5 offset:62464
    ds_read_b128 a[8:11], v5 offset:63488
    ds_read_b128 a[12:15], v5 offset:64512
    ds_read_b128 a[16:19], v12 offset:0
    ds_read_b128 a[20:23], v12 offset:16384
    ds_read_b128 a[24:27], v12 offset:17408
    ds_read_b128 a[28:31], v12 offset:18432
    ds_read_b128 a[32:35], v12 offset:19456
    s_waitcnt lgkmcnt(4)
    v_mfma_f32_16x16x32_bf16 v[224:227], a[0:3], v[96:99], 0
    ds_read_b128 a[36:39], v12 offset:20480
    v_mfma_f32_16x16x32_bf16 v[228:231], a[4:7], v[96:99], 0
    ds_read_b128 a[0:3], v12 offset:36864
    v_mfma_f32_16x16x32_bf16 v[232:235], a[8:11], v[96:99], 0
    ds_read_b128 a[4:7], v12 offset:37888
    s_add_u32 s98, s49, 0
    s_add_u32 m0, s54, 5120
    s_nop 0
    buffer_load_dwordx4 v5, s[28:31], s98 offen offset:0 sc1 lds
    v_mfma_f32_16x16x32_bf16 v[236:239], a[12:15], v[96:99], 0
    ds_read_b128 a[8:11], v12 offset:38912
    v_mfma_f32_16x16x32_bf16 v[240:243], a[16:19], v[96:99], 0
    ds_read_b128 a[12:15], v12 offset:39936
    s_waitcnt lgkmcnt(4)
    v_mfma_f32_16x16x32_bf16 v[224:227], a[20:23], v[100:103], v[224:227]
    ds_read_b128 a[16:19], v12 offset:40960
    v_mfma_f32_16x16x32_bf16 v[228:231], a[24:27], v[100:103], v[228:231]
    ds_read_b128 a[20:23], v12 offset:57344
    v_mfma_f32_16x16x32_bf16 v[232:235], a[28:31], v[100:103], v[232:235]
    ds_read_b128 a[24:27], v12 offset:58368
    buffer_load_dwordx4 v5, s[28:31], s98 offen offset:1024 sc1 lds
    v_mfma_f32_16x16x32_bf16 v[236:239], a[32:35], v[100:103], v[236:239]
    ds_read_b128 a[28:31], v12 offset:59392
    v_mfma_f32_16x16x32_bf16 v[240:243], a[36:39], v[100:103], v[240:243]
    ds_read_b128 a[32:35], v12 offset:60416
    s_waitcnt lgkmcnt(4)
    v_mfma_f32_16x16x32_bf16 v[224:227], a[0:3], v[104:107], v[224:227]
    ds_read_b128 a[36:39], v12 offset:61440
    v_mfma_f32_16x16x32_bf16 v[228:231], a[4:7], v[104:107], v[228:231]
    ds_read_b128 a[0:3], v12 offset:1024
    v_mfma_f32_16x16x32_bf16 v[232:235], a[8:11], v[104:107], v[232:235]
    ds_read_b128 a[4:7], v12 offset:2048
    buffer_load_dwordx4 v5, s[28:31], s98 offen offset:2048 sc1 lds
    v_mfma_f32_16x16x32_bf16 v[236:239], a[12:15], v[104:107], v[236:239]
    ds_read_b128 a[8:11], v12 offset:3072
    v_mfma_f32_16x16x32_bf16 v[240:243], a[16:19], v[104:107], v[240:243]
    ds_read_b128 a[12:15], v12 offset:4096
    s_waitcnt lgkmcnt(4)
    v_mfma_f32_16x16x32_bf16 v[224:227], a[20:23], v[108:111], v[224:227]
    ds_read_b128 a[16:19], v12 offset:5120
    v_mfma_f32_16x16x32_bf16 v[228:231], a[24:27], v[108:111], v[228:231]
    ds_read_b128 a[20:23], v12 offset:21504
    v_mfma_f32_16x16x32_bf16 v[232:235], a[28:31], v[108:111], v[232:235]
    ds_read_b128 a[24:27], v12 offset:22528
    buffer_load_dwordx4 v5, s[28:31], s98 offen offset:3072 sc1 lds
    s_add_u32 s98, s98, 4096
    s_add_u32 m0, s54, 9216
    v_mfma_f32_16x16x32_bf16 v[236:239], a[32:35], v[108:111], v[236:239]
    ds_read_b128 a[28:31], v12 offset:23552
    v_mfma_f32_16x16x32_bf16 v[240:243], a[36:39], v[108:111], v[240:243]
    ds_read_b128 a[32:35], v12 offset:24576
    s_waitcnt lgkmcnt(4)
    v_mfma_f32_16x16x32_bf16 v[224:227], a[0:3], v[112:115], v[224:227]
    ds_read_b128 a[36:39], v12 offset:25600
    v_mfma_f32_16x16x32_bf16 v[228:231], a[4:7], v[112:115], v[228:231]
    ds_read_b128 a[0:3], v12 offset:41984
    v_mfma_f32_16x16x32_bf16 v[232:235], a[8:11], v[112:115], v[232:235]
    ds_read_b128 a[4:7], v12 offset:43008
    buffer_load_dwordx4 v5, s[28:31], s98 offen offset:0 sc1 lds
    v_mfma_f32_16x16x32_bf16 v[236:239], a[12:15], v[112:115], v[236:239]
    ds_read_b128 a[8:11], v12 offset:44032
    v_mfma_f32_16x16x32_bf16 v[240:243], a[16:19], v[112:115], v[240:243]
    ds_read_b128 a[12:15], v12 offset:45056
    s_waitcnt lgkmcnt(4)
    v_mfma_f32_16x16x32_bf16 v[224:227], a[20:23], v[116:119], v[224:227]
    ds_read_b128 a[16:19], v12 offset:46080
    v_mfma_f32_16x16x32_bf16 v[228:231], a[24:27], v[116:119], v[228:231]
    ds_read_b128 a[20:23], v12 offset:62464
    v_mfma_f32_16x16x32_bf16 v[232:235], a[28:31], v[116:119], v[232:235]
    ds_read_b128 a[24:27], v12 offset:63488
    buffer_load_dwordx4 v5, s[28:31], s98 offen offset:1024 sc1 lds
    v_mfma_f32_16x16x32_bf16 v[236:239], a[32:35], v[116:119], v[236:239]
    ds_read_b128 a[28:31], v12 offset:64512
    v_mfma_f32_16x16x32_bf16 v[240:243], a[36:39], v[116:119], v[240:243]
    ds_read_b128 a[32:35], v29 offset:0
    s_waitcnt lgkmcnt(4)
    v_mfma_f32_16x16x32_bf16 v[224:227], a[0:3], v[120:123], v[224:227]
    ds_read_b128 a[36:39], v29 offset:1024
    v_mfma_f32_16x16x32_bf16 v[228:231], a[4:7], v[120:123], v[228:231]
    ds_read_b128 a[0:3], v12 offset:6144
    v_mfma_f32_16x16x32_bf16 v[232:235], a[8:11], v[120:123], v[232:235]
    ds_read_b128 a[4:7], v12 offset:7168
    buffer_load_dwordx4 v5, s[28:31], s98 offen offset:2048 sc1 lds
    v_mfma_f32_16x16x32_bf16 v[236:239], a[12:15], v[120:123], v[236:239]
    ds_read_b128 a[8:11], v12 offset:8192
    v_mfma_f32_16x16x32_bf16 v[240:243], a[16:19], v[120:123], v[240:243]
    ds_read_b128 a[12:15], v12 offset:9216
    s_waitcnt lgkmcnt(4)
    v_mfma_f32_16x16x32_bf16 v[224:227], a[20:23], v[124:127], v[224:227]
    ds_read_b128 a[16:19], v12 offset:10240
    v_mfma_f32_16x16x32_bf16 v[228:231], a[24:27], v[124:127], v[228:231]
    ds_read_b128 a[20:23], v12 offset:26624
    v_mfma_f32_16x16x32_bf16 v[232:235], a[28:31], v[124:127], v[232:235]
    ds_read_b128 a[24:27], v12 offset:27648
    buffer_load_dwordx4 v5, s[28:31], s98 offen offset:3072 sc1 lds
    s_add_u32 s98, s98, 4096
    s_add_u32 m0, s54, 13312
    v_mfma_f32_16x16x32_bf16 v[236:239], a[32:35], v[124:127], v[236:239]
    ds_read_b128 a[28:31], v12 offset:28672
    v_mfma_f32_16x16x32_bf16 v[240:243], a[36:39], v[124:127], v[240:243]
    ds_read_b128 a[32:35], v12 offset:29696
    s_waitcnt lgkmcnt(4)
    v_mfma_f32_16x16x32_bf16 v[224:227], a[0:3], v[128:131], v[224:227]
    ds_read_b128 a[36:39], v12 offset:30720
    v_mfma_f32_16x16x32_bf16 v[228:231], a[4:7], v[128:131], v[228:231]
    ds_read_b128 a[0:3], v12 offset:47104
    v_mfma_f32_16x16x32_bf16 v[232:235], a[8:11], v[128:131], v[232:235]
    ds_read_b128 a[4:7], v12 offset:48128
    buffer_load_dwordx4 v5, s[28:31], s98 offen offset:0 sc1 lds
    v_mfma_f32_16x16x32_bf16 v[236:239], a[12:15], v[128:131], v[236:239]
    ds_read_b128 a[8:11], v12 offset:49152
    v_mfma_f32_16x16x32_bf16 v[240:243], a[16:19], v[128:131], v[240:243]
    ds_read_b128 a[12:15], v12 offset:50176
    s_waitcnt lgkmcnt(4)
    v_mfma_f32_16x16x32_bf16 v[224:227], a[20:23], v[132:135], v[224:227]
    ds_read_b128 a[16:19], v12 offset:51200
    v_mfma_f32_16x16x32_bf16 v[228:231], a[24:27], v[132:135], v[228:231]
    ds_read_b128 a[20:23], v29 offset:2048
    v_mfma_f32_16x16x32_bf16 v[232:235], a[28:31], v[132:135], v[232:235]
    ds_read_b128 a[24:27], v29 offset:3072
    buffer_load_dwordx4 v5, s[28:31], s98 offen offset:1024 sc1 lds
    v_mfma_f32_16x16x32_bf16 v[236:239], a[32:35], v[132:135], v[236:239]
    ds_read_b128 a[28:31], v29 offset:4096
    v_mfma_f32_16x16x32_bf16 v[240:243], a[36:39], v[132:135], v[240:243]
    ds_read_b128 a[32:35], v29 offset:5120
    s_waitcnt lgkmcnt(4)
    v_mfma_f32_16x16x32_bf16 v[224:227], a[0:3], v[136:139], v[224:227]
    ds_read_b128 a[36:39], v29 offset:6144
    v_mfma_f32_16x16x32_bf16 v[228:231], a[4:7], v[136:139], v[228:231]
    ds_read_b128 a[0:3], v12 offset:11264
    v_mfma_f32_16x16x32_bf16 v[232:235], a[8:11], v[136:139], v[232:235]
    ds_read_b128 a[4:7], v12 offset:12288
    global_load_dwordx4 v[184:187], v5, s[74:75]
    s_add_u32 s74, s74, 4096
    s_addc_u32 s75, s75, 0
    v_mfma_f32_16x16x32_bf16 v[236:239], a[12:15], v[136:139], v[236:239]
    ds_read_b128 a[8:11], v12 offset:13312
    v_mfma_f32_16x16x32_bf16 v[240:243], a[16:19], v[136:139], v[240:243]
    ds_read_b128 a[12:15], v12 offset:14336
    s_waitcnt lgkmcnt(4)
    v_mfma_f32_16x16x32_bf16 v[224:227], a[20:23], v[140:143], v[224:227]
    ds_read_b128 a[16:19], v12 offset:15360
    v_mfma_f32_16x16x32_bf16 v[228:231], a[24:27], v[140:143], v[228:231]
    ds_read_b128 a[20:23], v12 offset:31744
    v_mfma_f32_16x16x32_bf16 v[232:235], a[28:31], v[140:143], v[232:235]
    ds_read_b128 a[24:27], v12 offset:32768
    global_load_dwordx4 v[88:91], v5, s[74:75]
    s_add_u32 s74, s74, 4096
    s_addc_u32 s75, s75, 0
    v_mfma_f32_16x16x32_bf16 v[236:239], a[32:35], v[140:143], v[236:239]
    ds_read_b128 a[28:31], v12 offset:33792
    v_mfma_f32_16x16x32_bf16 v[240:243], a[36:39], v[140:143], v[240:243]
    ds_read_b128 a[32:35], v12 offset:34816
    s_waitcnt lgkmcnt(4)
    v_mfma_f32_16x16x32_bf16 v[224:227], a[0:3], v[144:147], v[224:227]
    ds_read_b128 a[36:39], v12 offset:35840
    v_mfma_f32_16x16x32_bf16 v[228:231], a[4:7], v[144:147], v[228:231]
    ds_read_b128 a[0:3], v12 offset:52224
    v_mfma_f32_16x16x32_bf16 v[232:235], a[8:11], v[144:147], v[232:235]
    ds_read_b128 a[4:7], v12 offset:53248
    global_load_dwordx4 v[92:95], v5, s[74:75]
    s_add_u32 s74, s74, 4096
    s_addc_u32 s75, s75, 0
    v_mfma_f32_16x16x32_bf16 v[236:239], a[12:15], v[144:147], v[236:239]
    ds_read_b128 a[8:11], v12 offset:54272
    v_mfma_f32_16x16x32_bf16 v[240:243], a[16:19], v[144:147], v[240:243]
    ds_read_b128 a[12:15], v12 offset:55296
    s_waitcnt lgkmcnt(4)
    v_mfma_f32_16x16x32_bf16 v[224:227], a[20:23], v[148:151], v[224:227]
    ds_read_b128 a[16:19], v12 offset:56320
    v_mfma_f32_16x16x32_bf16 v[228:231], a[24:27], v[148:151], v[228:231]
    ds_read_b128 a[20:23], v29 offset:7168
    v_mfma_f32_16x16x32_bf16 v[232:235], a[28:31], v[148:151], v[232:235]
    ds_read_b128 a[24:27], v29 offset:8192
    v_mfma_f32_16x16x32_bf16 v[236:239], a[32:35], v[148:151], v[236:239]
    ds_read_b128 a[28:31], v29 offset:9216
    v_mfma_f32_16x16x32_bf16 v[240:243], a[36:39], v[148:151], v[240:243]
    ds_read_b128 a[32:35], v29 offset:10240
    s_waitcnt lgkmcnt(4)
    v_mfma_f32_16x16x32_bf16 v[224:227], a[0:3], v[152:155], v[224:227]
    ds_read_b128 a[36:39], v29 offset:11264
    v_mfma_f32_16x16x32_bf16 v[228:231], a[4:7], v[152:155], v[228:231]
    ds_read_b128 a[0:3], v5 offset:0
    v_mfma_f32_16x16x32_bf16 v[232:235], a[8:11], v[152:155], v[232:235]
    ds_read_b128 a[4:7], v5 offset:1024
    v_mfma_f32_16x16x32_bf16 v[236:239], a[12:15], v[152:155], v[236:239]
    ds_read_b128 a[8:11], v5 offset:2048
    v_mfma_f32_16x16x32_bf16 v[240:243], a[16:19], v[152:155], v[240:243]
    ds_read_b128 a[12:15], v5 offset:3072
    s_waitcnt lgkmcnt(4)
    v_mfma_f32_16x16x32_bf16 v[224:227], a[20:23], v[156:159], v[224:227]
    ds_read_b128 a[16:19], v5 offset:4096
    v_mfma_f32_16x16x32_bf16 v[228:231], a[24:27], v[156:159], v[228:231]
    ds_read_b128 a[20:23], v5 offset:15360
    v_mfma_f32_16x16x32_bf16 v[232:235], a[28:31], v[156:159], v[232:235]
    ds_read_b128 a[24:27], v5 offset:16384
    v_mfma_f32_16x16x32_bf16 v[236:239], a[32:35], v[156:159], v[236:239]
    ds_read_b128 a[28:31], v5 offset:17408
    v_mfma_f32_16x16x32_bf16 v[240:243], a[36:39], v[156:159], v[240:243]
    ds_read_b128 a[32:35], v5 offset:18432
    s_waitcnt lgkmcnt(4)
    v_mfma_f32_16x16x32_bf16 v[224:227], a[0:3], v[160:163], v[224:227]
    ds_read_b128 a[36:39], v5 offset:19456
    v_mfma_f32_16x16x32_bf16 v[228:231], a[4:7], v[160:163], v[228:231]
    ds_read_b128 a[0:3], v5 offset:30720
    v_mfma_f32_16x16x32_bf16 v[232:235], a[8:11], v[160:163], v[232:235]
    ds_read_b128 a[4:7], v5 offset:31744
    s_waitcnt vmcnt(2)
    v_min_u32 v185, s76, v185
    v_add_u32 v184, v184, v185
    buffer_load_dwordx4 v[204:207], v184, s[28:31], s69 offen offset:0 sc1
    buffer_load_dwordx4 v[208:211], v184, s[28:31], s69 offen offset:512 sc1
    buffer_load_dwordx4 v[212:215], v184, s[28:31], s69 offen offset:1024 sc1
    buffer_load_dwordx4 v[216:219], v184, s[28:31], s69 offen offset:1536 sc1
    v_min_u32 v10, 23, v1
    v_lshlrev_b32 v10, 7, v10
    buffer_load_dword v32, v10, s[28:31], s14 offen sc1
    v_mfma_f32_16x16x32_bf16 v[236:239], a[12:15], v[160:163], v[236:239]
    ds_read_b128 a[8:11], v5 offset:32768
    v_mfma_f32_16x16x32_bf16 v[240:243], a[16:19], v[160:163], v[240:243]
    ds_read_b128 a[12:15], v5 offset:33792
    s_waitcnt lgkmcnt(4)
    v_mfma_f32_16x16x32_bf16 v[224:227], a[20:23], v[164:167], v[224:227]
    ds_read_b128 a[16:19], v5 offset:34816
    v_mfma_f32_16x16x32_bf16 v[228:231], a[24:27], v[164:167], v[228:231]
    ds_read_b128 a[20:23], v5 offset:46080
    v_mfma_f32_16x16x32_bf16 v[232:235], a[28:31], v[164:167], v[232:235]
    ds_read_b128 a[24:27], v5 offset:47104
    v_mfma_f32_16x16x32_bf16 v[236:239], a[32:35], v[164:167], v[236:239]
    ds_read_b128 a[28:31], v5 offset:48128
    v_mfma_f32_16x16x32_bf16 v[240:243], a[36:39], v[164:167], v[240:243]
    ds_read_b128 a[32:35], v5 offset:49152
    s_waitcnt lgkmcnt(4)
    v_mfma_f32_16x16x32_bf16 v[224:227], a[0:3], v[168:171], v[224:227]
    ds_read_b128 a[36:39], v5 offset:50176
    v_mfma_f32_16x16x32_bf16 v[228:231], a[4:7], v[168:171], v[228:231]
    v_mfma_f32_16x16x32_bf16 v[232:235], a[8:11], v[168:171], v[232:235]
    v_mfma_f32_16x16x32_bf16 v[236:239], a[12:15], v[168:171], v[236:239]
    v_mfma_f32_16x16x32_bf16 v[240:243], a[16:19], v[168:171], v[240:243]
    s_waitcnt lgkmcnt(0)
    v_mfma_f32_16x16x32_bf16 v[224:227], a[20:23], v[172:175], v[224:227]
    v_mfma_f32_16x16x32_bf16 v[228:231], a[24:27], v[172:175], v[228:231]
    v_mfma_f32_16x16x32_bf16 v[232:235], a[28:31], v[172:175], v[232:235]
    v_mfma_f32_16x16x32_bf16 v[236:239], a[32:35], v[172:175], v[236:239]
    v_mfma_f32_16x16x32_bf16 v[240:243], a[36:39], v[172:175], v[240:243]
    global_load_dwordx4 v[24:27], v5, s[74:75]
    s_add_u32 s74, s74, 4096
    s_addc_u32 s75, s75, 0
    global_load_dwordx4 v[28:31], v5, s[74:75]
    s_add_u32 s74, s74, 4096
    s_addc_u32 s75, s75, 0
    s_barrier
    v_lshrrev_b32 v185, 1, v185
    v_or3_b32 v185, v185, s77, v186
    s_waitcnt vmcnt(3)
    v_xor_b32 v6, v204, v244
    v_bitop3_b32 v6, v205, v245, v6 bitop3:0xbe
    v_bitop3_b32 v6, v206, v246, v6 bitop3:0xbe
    v_bitop3_b32 v6, v207, v247, v6 bitop3:0xbe
    v_bitop3_b32 v6, v208, v244, v6 bitop3:0xbe
    v_bitop3_b32 v6, v209, v245, v6 bitop3:0xbe
    v_bitop3_b32 v6, v210, v246, v6 bitop3:0xbe
    v_bitop3_b32 v6, v211, v247, v6 bitop3:0xbe
    v_bitop3_b32 v6, v212, v244, v6 bitop3:0xbe
    v_bitop3_b32 v6, v213, v245, v6 bitop3:0xbe
    v_bitop3_b32 v6, v214, v246, v6 bitop3:0xbe
    v_bitop3_b32 v6, v215, v247, v6 bitop3:0xbe
    v_bitop3_b32 v6, v216, v244, v6 bitop3:0xbe
    v_bitop3_b32 v6, v217, v245, v6 bitop3:0xbe
    v_bitop3_b32 v6, v218, v246, v6 bitop3:0xbe
    v_bitop3_b32 v6, v219, v247, v6 bitop3:0xbe
    v_and_b32 v6, 0xff, v6
    v_cmp_ne_u32 vcc, 0, v6
    s_nop 0
    s_cmp_lg_u64 vcc, 0
    s_cbranch_scc1 L_retry_23
L_ok_24:
    v_pk_add_f32 v[204:205], v[204:205], v[208:209]
    v_pk_add_f32 v[212:213], v[212:213], v[216:217]
    v_pk_add_f32 v[206:207], v[206:207], v[210:211]
    v_pk_add_f32 v[214:215], v[214:215], v[218:219]
    v_pk_add_f32 v[204:205], v[204:205], v[212:213]
    v_pk_add_f32 v[206:207], v[206:207], v[214:215]
    s_nop 1
    v_permlane32_swap_b32 v204, v206
    v_permlane32_swap_b32 v205, v207
    v_pk_add_f32 v[204:205], v[204:205], v[206:207]
    s_nop 1
    v_add_f32_dpp v204, v204, v204 row_ror:4 row_mask:0xf bank_mask:0xf
    v_add_f32_dpp v205, v205, v205 row_ror:4 row_mask:0xf bank_mask:0xf
    s_nop 0
    v_add_f32_dpp v204, v204, v204 row_ror:8 row_mask:0xf bank_mask:0xf
    v_add_f32_dpp v205, v205, v205 row_ror:8 row_mask:0xf bank_mask:0xf
    v_cvt_pk_bf16_f32 v208, v204, v205
    buffer_store_dword v208, v185, s[28:31], s5 offen sc1
    v_accvgpr_read_b32 v172, a48
    v_accvgpr_read_b32 v173, a49
    buffer_load_dword v32, v33, s[20:23], s56 offen
    s_mov_b32 s88, 0x05040100
    s_mov_b32 s89, 0x07060302
    v_perm_b32 v6, v68, v64, s88
    v_perm_b32 v7, v68, v64, s89
    v_dot2_f32_bf16 v176, v6, v172, 0
    v_dot2_f32_bf16 v177, v7, v172, 0
    v_perm_b32 v8, v69, v65, s88
    v_perm_b32 v9, v69, v65, s89
    v_dot2_f32_bf16 v178, v8, v172, 0
    v_dot2_f32_bf16 v179, v9, v172, 0
    s_add_u32 s98, s50, 0
    s_add_u32 m0, s54, 61440
    s_nop 0
    buffer_load_dwordx4 v5, s[28:31], s98 offen offset:0 sc1 lds
    v_perm_b32 v6, v70, v66, s88
    v_perm_b32 v7, v70, v66, s89
    v_dot2_f32_bf16 v180, v6, v172, 0
    v_dot2_f32_bf16 v181, v7, v172, 0
    v_perm_b32 v8, v71, v67, s88
    v_perm_b32 v9, v71, v67, s89
    v_dot2_f32_bf16 v182, v8, v172, 0
    v_dot2_f32_bf16 v183, v9, v172, 0
    buffer_load_dwordx4 v5, s[28:31], s98 offen offset:1024 sc1 lds
    v_perm_b32 v6, v76, v72, s88
    v_perm_b32 v7, v76, v72, s89
    v_dot2_f32_bf16 v176, v6, v173, v176
    v_dot2_f32_bf16 v177, v7, v173, v177
    v_perm_b32 v8, v77, v73, s88
    v_perm_b32 v9, v77, v73, s89
    v_dot2_f32_bf16 v178, v8, v173, v178
    v_dot2_f32_bf16 v179, v9, v173, v179
    buffer_load_dwordx4 v5, s[28:31], s98 offen offset:2048 sc1 lds
    v_perm_b32 v6, v78, v74, s88
    v_perm_b32 v7, v78, v74, s89
    v_dot2_f32_bf16 v180, v6, v173, v180
    v_dot2_f32_bf16 v181, v7, v173, v181
    v_perm_b32 v8, v79, v75, s88
    v_perm_b32 v9, v79, v75, s89
    v_dot2_f32_bf16 v182, v8, v173, v182
    v_dot2_f32_bf16 v183, v9, v173, v183
    buffer_load_dwordx4 v5, s[28:31], s98 offen offset:3072 sc1 lds
    s_add_u32 s98, s98, 4096
    s_add_u32 m0, s54, 65536
    v_and_b32 v6, 8, v1
    v_cmp_ne_u32 vcc, 0, v6
    v_lshlrev_b32 v6, 2, v0
    v_add_u32 v6, 160896, v6
    v_permlane32_swap_b32 v176, v177
    v_permlane32_swap_b32 v178, v179
    v_permlane32_swap_b32 v180, v181
    v_permlane32_swap_b32 v182, v183
    buffer_load_dwordx4 v5, s[28:31], s98 offen offset:0 sc1 lds
    v_add_f32 v176, v176, v177
    v_add_f32 v178, v178, v179
    v_add_f32 v180, v180, v181
    v_add_f32 v182, v182, v183
    v_permlane16_swap_b32 v176, v178
    s_nop 0
    v_permlane16_swap_b32 v180, v182
    v_add_f32 v176, v176, v178
    v_add_f32 v180, v180, v182
    buffer_load_dwordx4 v5, s[28:31], s98 offen offset:1024 sc1 lds
    v_cndmask_b32 v7, v180, v176, vcc
    v_cndmask_b32 v8, v176, v180, vcc
    s_nop 1
    v_add_f32_dpp v8, v7, v8 row_ror:8 row_mask:0xf bank_mask:0xf
    ds_write_b32 v6, v8
    s_waitcnt lgkmcnt(0)
    s_barrier
    s_or_b32 s88, s59, s82
    s_cbranch_scc0 L_bpub_25
L_bpubb_26:
    v_mov_b32 v254, 0
    v_mov_b32 v255, 0
    v_cvt_pk_bf16_f32 v244, v224, v225
    v_cvt_pk_bf16_f32 v245, v226, v227
    v_cvt_pk_bf16_f32 v246, v228, v229
    buffer_load_dwordx4 v5, s[28:31], s98 offen offset:2048 sc1 lds
    v_cvt_pk_bf16_f32 v247, v230, v231
    v_cvt_pk_bf16_f32 v248, v232, v233
    v_cvt_pk_bf16_f32 v249, v234, v235
    v_cvt_pk_bf16_f32 v250, v236, v237
    v_cvt_pk_bf16_f32 v251, v238, v239
    v_cvt_pk_bf16_f32 v252, v240, v241
    v_cvt_pk_bf16_f32 v253, v242, v243
    v_mfma_f32_16x16x32_bf16 v[40:43], a[148:151], v[244:247], 0
    v_mfma_f32_16x16x32_bf16 v[44:47], a[152:155], v[244:247], 0
    v_mfma_f32_16x16x32_bf16 v[48:51], a[156:159], v[244:247], 0
    v_mfma_f32_16x16x32_bf16 v[52:55], a[160:163], v[244:247], 0
    v_mfma_f32_16x16x32_bf16 v[56:59], a[164:167], v[244:247], 0
    v_mfma_f32_16x16x32_bf16 v[40:43], a[168:171], v[248:251], v[40:43]
    v_mfma_f32_16x16x32_bf16 v[44:47], a[172:175], v[248:251], v[44:47]
    v_mfma_f32_16x16x32_bf16 v[48:51], a[176:179], v[248:251], v[48:51]
    v_mfma_f32_16x16x32_bf16 v[52:55], a[180:183], v[248:251], v[52:55]
    v_mfma_f32_16x16x32_bf16 v[56:59], a[184:187], v[248:251], v[56:59]
    v_mfma_f32_16x16x32_bf16 v[40:43], a[188:191], v[252:255], v[40:43]
    v_mfma_f32_16x16x32_bf16 v[44:47], a[192:195], v[252:255], v[44:47]
    v_mfma_f32_16x16x32_bf16 v[48:51], a[196:199], v[252:255], v[48:51]
    v_mfma_f32_16x16x32_bf16 v[52:55], a[200:203], v[252:255], v[52:55]
    v_mfma_f32_16x16x32_bf16 v[56:59], a[204:207], v[252:255], v[56:59]
    s_nop 3
    v_max3_f32 v6, v40, v41, v42
    buffer_load_dwordx4 v5, s[28:31], s98 offen offset:3072 sc1 lds
    s_add_u32 s98, s98, 4096
    s_add_u32 m0, s54, 69632
    v_min3_f32 v7, v40, v41, v42
    v_max3_f32 v6, v6, v43, v44
    v_min3_f32 v7, v7, v43, v44
    v_max3_f32 v6, v6, v45, v46
    v_min3_f32 v7, v7, v45, v46
    v_max3_f32 v6, v6, v47, v48
    v_min3_f32 v7, v7, v47, v48
    v_max3_f32 v6, v6, v49, v50
    buffer_load_dwordx4 v5, s[28:31], s98 offen offset:0 sc1 lds
    v_min3_f32 v7, v7, v49, v50
    v_max3_f32 v6, v6, v51, v52
    v_min3_f32 v7, v7, v51, v52
    v_max3_f32 v6, v6, v53, v54
    v_min3_f32 v7, v7, v53, v54
    v_max3_f32 v6, v6, v55, v56
    v_min3_f32 v7, v7, v55, v56
    v_max3_f32 v6, v6, v57, v58
    buffer_load_dwordx4 v5, s[28:31], s98 offen offset:1024 sc1 lds
    v_min3_f32 v7, v7, v57, v58
    v_max_f32 v6, v6, v59
    v_min_f32 v7, v7, v59
    v_mul_f32 v6, 0xbfb8aa3b, v6
    v_mul_f32 v7, 0x3fb8aa3b, v7
    v_pk_fma_f32 v[204:205], v[40:41], s[86:87], v[6:7] op_sel:[0,0,0] op_sel_hi:[1,1,0]
    v_pk_fma_f32 v[184:185], v[40:41], s[86:87], v[6:7] op_sel:[0,0,1] op_sel_hi:[1,1,1] neg_lo:[1,0,0] neg_hi:[1,0,0]
    v_pk_fma_f32 v[206:207], v[42:43], s[86:87], v[6:7] op_sel:[0,0,0] op_sel_hi:[1,1,0]
    buffer_load_dwordx4 v5, s[28:31], s98 offen offset:2048 sc1 lds
    v_pk_fma_f32 v[186:187], v[42:43], s[86:87], v[6:7] op_sel:[0,0,1] op_sel_hi:[1,1,1] neg_lo:[1,0,0] neg_hi:[1,0,0]
    v_pk_fma_f32 v[208:209], v[44:45], s[86:87], v[6:7] op_sel:[0,0,0] op_sel_hi:[1,1,0]
    v_pk_fma_f32 v[188:189], v[44:45], s[86:87], v[6:7] op_sel:[0,0,1] op_sel_hi:[1,1,1] neg_lo:[1,0,0] neg_hi:[1,0,0]
    v_pk_fma_f32 v[210:211], v[46:47], s[86:87], v[6:7] op_sel:[0,0,0] op_sel_hi:[1,1,0]
    v_pk_fma_f32 v[190:191], v[46:47], s[86:87], v[6:7] op_sel:[0,0,1] op_sel_hi:[1,1,1] neg_lo:[1,0,0] neg_hi:[1,0,0]
    v_pk_fma_f32 v[212:213], v[48:49], s[86:87], v[6:7] op_sel:[0,0,0] op_sel_hi:[1,1,0]
    v_pk_fma_f32 v[192:193], v[48:49], s[86:87], v[6:7] op_sel:[0,0,1] op_sel_hi:[1,1,1] neg_lo:[1,0,0] neg_hi:[1,0,0]
    v_pk_fma_f32 v[214:215], v[50:51], s[86:87], v[6:7] op_sel:[0,0,0] op_sel_hi:[1,1,0]
    buffer_load_dwordx4 v5, s[28:31], s98 offen offset:3072 sc1 lds
    s_add_u32 s98, s98, 4096
    s_add_u32 m0, s54, 73728
    v_pk_fma_f32 v[194:195], v[50:51], s[86:87], v[6:7] op_sel:[0,0,1] op_sel_hi:[1,1,1] neg_lo:[1,0,0] neg_hi:[1,0,0]
    v_pk_fma_f32 v[216:217], v[52:53], s[86:87], v[6:7] op_sel:[0,0,0] op_sel_hi:[1,1,0]
    v_pk_fma_f32 v[196:197], v[52:53], s[86:87], v[6:7] op_sel:[0,0,1] op_sel_hi:[1,1,1] neg_lo:[1,0,0] neg_hi:[1,0,0]
    v_pk_fma_f32 v[218:219], v[54:55], s[86:87], v[6:7] op_sel:[0,0,0] op_sel_hi:[1,1,0]
    v_pk_fma_f32 v[198:199], v[54:55], s[86:87], v[6:7] op_sel:[0,0,1] op_sel_hi:[1,1,1] neg_lo:[1,0,0] neg_hi:[1,0,0]
    v_pk_fma_f32 v[220:221], v[56:57], s[86:87], v[6:7] op_sel:[0,0,0] op_sel_hi:[1,1,0]
    v_pk_fma_f32 v[200:201], v[56:57], s[86:87], v[6:7] op_sel:[0,0,1] op_sel_hi:[1,1,1] neg_lo:[1,0,0] neg_hi:[1,0,0]
    v_pk_fma_f32 v[222:223], v[58:59], s[86:87], v[6:7] op_sel:[0,0,0] op_sel_hi:[1,1,0]
    buffer_load_dwordx4 v5, s[28:31], s98 offen offset:0 sc1 lds
    v_pk_fma_f32 v[202:203], v[58:59], s[86:87], v[6:7] op_sel:[0,0,1] op_sel_hi:[1,1,1] neg_lo:[1,0,0] neg_hi:[1,0,0]
    v_exp_f32 v204, v204
    v_exp_f32 v205, v205
    v_exp_f32 v206, v206
    v_exp_f32 v207, v207
    v_exp_f32 v208, v208
    v_exp_f32 v209, v209
    v_exp_f32 v210, v210
    buffer_load_dwordx4 v5, s[28:31], s98 offen offset:1024 sc1 lds
    v_exp_f32 v211, v211
    v_exp_f32 v212, v212
    v_exp_f32 v213, v213
    v_exp_f32 v214, v214
    v_exp_f32 v215, v215
    v_exp_f32 v216, v216
    v_exp_f32 v217, v217
    v_exp_f32 v218, v218
    buffer_load_dwordx4 v5, s[28:31], s98 offen offset:2048 sc1 lds
    v_exp_f32 v219, v219
    v_exp_f32 v220, v220
    v_exp_f32 v221, v221
    v_exp_f32 v222, v222
    v_exp_f32 v223, v223
    v_exp_f32 v184, v184
    v_exp_f32 v185, v185
    v_exp_f32 v186, v186
    s_waitcnt vmcnt(17)
    v_exp_f32 v187, v187
    v_exp_f32 v188, v188
    v_exp_f32 v189, v189
    v_exp_f32 v190, v190
    v_exp_f32 v191, v191
    v_exp_f32 v192, v192
    v_exp_f32 v193, v193
    v_exp_f32 v194, v194
    buffer_load_dwordx2 v[148:149], v92, s[28:31], s6 offen sc1
    buffer_load_dwordx2 v[150:151], v93, s[28:31], s6 offen sc1
    buffer_load_dwordx2 v[152:153], v94, s[28:31], s6 offen sc1
    buffer_load_dwordx2 v[154:155], v95, s[28:31], s6 offen sc1
    v_exp_f32 v195, v195
    v_exp_f32 v196, v196
    v_exp_f32 v197, v197
    v_exp_f32 v198, v198
    v_exp_f32 v199, v199
    v_exp_f32 v200, v200
    v_exp_f32 v201, v201
    v_exp_f32 v202, v202
    v_exp_f32 v203, v203
    v_pk_add_f32 v[8:9], v[204:205], v[206:207]
    v_pk_add_f32 v[10:11], v[184:185], v[186:187]
    v_pk_add_f32 v[8:9], v[8:9], v[208:209]
    v_pk_add_f32 v[10:11], v[10:11], v[188:189]
    v_pk_add_f32 v[8:9], v[8:9], v[210:211]
    v_pk_add_f32 v[10:11], v[10:11], v[190:191]
    v_pk_add_f32 v[8:9], v[8:9], v[212:213]
    v_pk_add_f32 v[10:11], v[10:11], v[192:193]
    v_pk_add_f32 v[8:9], v[8:9], v[214:215]
    v_pk_add_f32 v[10:11], v[10:11], v[194:195]
    v_pk_add_f32 v[8:9], v[8:9], v[216:217]
    v_pk_add_f32 v[10:11], v[10:11], v[196:197]
    v_pk_add_f32 v[8:9], v[8:9], v[218:219]
    v_pk_add_f32 v[10:11], v[10:11], v[198:199]
    v_pk_add_f32 v[8:9], v[8:9], v[220:221]
    v_pk_add_f32 v[10:11], v[10:11], v[200:201]
    v_pk_add_f32 v[8:9], v[8:9], v[222:223]
    v_pk_add_f32 v[10:11], v[10:11], v[202:203]
    v_add_f32 v8, v8, v9
    v_add_f32 v10, v10, v11
    v_rcp_f32 v10, v10
    v_mov_b32 v255, v8
    v_mul_f32 v10, v10, v8
    v_pk_mul_f32 v[184:185], v[184:185], v[10:11] op_sel_hi:[1,0]
    v_pk_mul_f32 v[186:187], v[186:187], v[10:11] op_sel_hi:[1,0]
    v_pk_mul_f32 v[188:189], v[188:189], v[10:11] op_sel_hi:[1,0]
    v_pk_mul_f32 v[190:191], v[190:191], v[10:11] op_sel_hi:[1,0]
    v_pk_mul_f32 v[192:193], v[192:193], v[10:11] op_sel_hi:[1,0]
    v_pk_mul_f32 v[194:195], v[194:195], v[10:11] op_sel_hi:[1,0]
    v_pk_mul_f32 v[196:197], v[196:197], v[10:11] op_sel_hi:[1,0]
    v_pk_mul_f32 v[198:199], v[198:199], v[10:11] op_sel_hi:[1,0]
    v_pk_mul_f32 v[200:201], v[200:201], v[10:11] op_sel_hi:[1,0]
    v_pk_mul_f32 v[202:203], v[202:203], v[10:11] op_sel_hi:[1,0]
    v_cvt_pk_bf16_f32 v60, v204, v205
    v_cvt_pk_bf16_f32 v61, v206, v207
    v_cvt_pk_bf16_f32 v62, v208, v209
    v_cvt_pk_bf16_f32 v63, v210, v211
    v_cvt_pk_bf16_f32 v64, v212, v213
    v_cvt_pk_bf16_f32 v65, v214, v215
    v_cvt_pk_bf16_f32 v66, v216, v217
    v_cvt_pk_bf16_f32 v67, v218, v219
    v_cvt_pk_bf16_f32 v68, v220, v221
    v_cvt_pk_bf16_f32 v69, v222, v223
    v_cvt_pk_bf16_f32 v70, v184, v185
    v_cvt_pk_bf16_f32 v71, v186, v187
    v_cvt_pk_bf16_f32 v72, v188, v189
    v_cvt_pk_bf16_f32 v73, v190, v191
    v_cvt_pk_bf16_f32 v74, v192, v193
    v_cvt_pk_bf16_f32 v75, v194, v195
    v_cvt_pk_bf16_f32 v76, v196, v197
    v_cvt_pk_bf16_f32 v77, v198, v199
    v_cvt_pk_bf16_f32 v78, v200, v201
    v_cvt_pk_bf16_f32 v79, v202, v203
    s_mov_b32 s100, s56
    s_add_u32 m0, s66, 0
    s_nop 0
    buffer_load_dwordx4 v24, s[20:23], s100 offen lds
    buffer_load_dwordx4 v25, s[20:23], s100 offen offset:1024 lds
    s_add_u32 s100, s100, 128
    s_add_u32 m0, s66, 2048
    s_nop 0
    buffer_load_dwordx4 v24, s[20:23], s100 offen lds
    buffer_load_dwordx4 v25, s[20:23], s100 offen offset:1024 lds
    s_add_u32 s100, s100, 128
    s_add_u32 m0, s66, 4096
    s_nop 0
    buffer_load_dwordx4 v24, s[20:23], s100 offen lds
    buffer_load_dwordx4 v25, s[20:23], s100 offen offset:1024 lds
    s_add_u32 s100, s100, 128
    s_waitcnt vmcnt(4)
    ds_read_b128 a[192:195], v26 offset:0
    ds_read_b128 a[196:199], v27 offset:0
    s_add_u32 m0, s66, 6144
    s_nop 0
    buffer_load_dwordx4 v24, s[20:23], s100 offen lds
    buffer_load_dwordx4 v25, s[20:23], s100 offen offset:1024 lds
    s_add_u32 s100, s100, 128
    v_max3_u32 v6, v148, v149, v150
    v_max3_u32 v6, v6, v151, v152
    v_max3_u32 v6, v6, v153, v154
    v_max_u32 v6, v6, v155
    v_cmp_eq_u32 vcc, -1, v6
    s_nop 0
    s_cmp_lg_u64 vcc, 0
    s_cbranch_scc1 L_retry_27
L_ok_28:
    ds_write_b64 v88, v[148:149]
    ds_write_b64 v89, v[150:151]
    ds_write_b64 v90, v[152:153]
    ds_write_b64 v91, v[154:155]
    s_waitcnt lgkmcnt(0)
    s_barrier
    global_load_dwordx4 v[88:91], v5, s[74:75]
    s_add_u32 s74, s74, 4096
    s_addc_u32 s75, s75, 0
    global_load_dwordx4 v[92:95], v5, s[74:75]
    s_add_u32 s74, s74, 4096
    s_addc_u32 s75, s75, 0
    ds_read_b128 a[0:3], v31 offset:0
    ds_read_b128 a[4:7], v30 offset:0
    ds_read_b128 a[8:11], v30 offset:320
    ds_read_b128 a[12:15], v30 offset:640
    ds_read_b128 a[16:19], v30 offset:960
    ds_read_b128 a[20:23], v30 offset:1280
    ds_read_b128 a[24:27], v31 offset:16
    ds_read_b128 a[28:31], v30 offset:16
    ds_read_b128 a[32:35], v30 offset:336
    s_waitcnt lgkmcnt(6)
    v_mfma_f32_16x16x32_bf16 v[180:183], a[0:3], v[60:63], 0
    ds_read_b128 a[36:39], v30 offset:656
    v_mfma_f32_16x16x32_bf16 v[160:163], a[4:7], v[60:63], 0
    ds_read_b128 a[0:3], v30 offset:976
    v_mfma_f32_16x16x32_bf16 v[164:167], a[8:11], v[60:63], 0
    ds_read_b128 a[4:7], v30 offset:1296
    buffer_load_dword v32, v33, s[20:23], s62 offen
    s_waitcnt lgkmcnt(6)
    v_mfma_f32_16x16x32_bf16 v[168:171], a[12:15], v[60:63], 0
    ds_read_b128 a[8:11], v31 offset:32
    v_mfma_f32_16x16x32_bf16 v[172:175], a[16:19], v[60:63], 0
    ds_read_b128 a[12:15], v30 offset:32
    v_mfma_f32_16x16x32_bf16 v[176:179], a[20:23], v[60:63], 0
    ds_read_b128 a[16:19], v30 offset:352
    s_waitcnt lgkmcnt(6)
    v_mfma_f32_16x16x32_bf16 v[180:183], a[24:27], v[64:67], v[180:183]
    ds_read_b128 a[20:23], v30 offset:672
    v_mfma_f32_16x16x32_bf16 v[160:163], a[28:31], v[64:67], v[160:163]
    ds_read_b128 a[24:27], v30 offset:992
    v_mfma_f32_16x16x32_bf16 v[164:167], a[32:35], v[64:67], v[164:167]
    ds_read_b128 a[28:31], v30 offset:1312
    s_waitcnt lgkmcnt(6)
    v_mfma_f32_16x16x32_bf16 v[168:171], a[36:39], v[64:67], v[168:171]
    ds_read_b128 a[32:35], v31 offset:48
    v_mfma_f32_16x16x32_bf16 v[172:175], a[0:3], v[64:67], v[172:175]
    ds_read_b128 a[36:39], v30 offset:48
    v_mfma_f32_16x16x32_bf16 v[176:179], a[4:7], v[64:67], v[176:179]
    ds_read_b128 a[0:3], v30 offset:368
    s_waitcnt lgkmcnt(6)
    v_mfma_f32_16x16x32_bf16 v[180:183], a[8:11], v[68:71], v[180:183]
    ds_read_b128 a[4:7], v30 offset:688
    v_mfma_f32_16x16x32_bf16 v[160:163], a[12:15], v[68:71], v[160:163]
    ds_read_b128 a[8:11], v30 offset:1008
    v_mfma_f32_16x16x32_bf16 v[164:167], a[16:19], v[68:71], v[164:167]
    ds_read_b128 a[12:15], v30 offset:1328
    s_waitcnt lgkmcnt(6)
    v_mfma_f32_16x16x32_bf16 v[168:171], a[20:23], v[68:71], v[168:171]
    ds_read_b128 a[16:19], v31 offset:64
    v_mfma_f32_16x16x32_bf16 v[172:175], a[24:27], v[68:71], v[172:175]
    ds_read_b128 a[20:23], v30 offset:64
    v_mfma_f32_16x16x32_bf16 v[176:179], a[28:31], v[68:71], v[176:179]
    ds_read_b128 a[24:27], v30 offset:384
    s_waitcnt lgkmcnt(6)
    v_mfma_f32_16x16x32_bf16 v[180:183], a[32:35], v[72:75], v[180:183]
    ds_read_b128 a[28:31], v30 offset:704
    v_mfma_f32_16x16x32_bf16 v[160:163], a[36:39], v[72:75], v[160:163]
    ds_read_b128 a[32:35], v30 offset:1024
    v_mfma_f32_16x16x32_bf16 v[164:167], a[0:3], v[72:75], v[164:167]
    ds_read_b128 a[36:39], v30 offset:1344
    s_waitcnt lgkmcnt(6)
    v_mfma_f32_16x16x32_bf16 v[168:171], a[4:7], v[72:75], v[168:171]
    v_mfma_f32_16x16x32_bf16 v[172:175], a[8:11], v[72:75], v[172:175]
    v_mfma_f32_16x16x32_bf16 v[176:179], a[12:15], v[72:75], v[176:179]
    s_waitcnt lgkmcnt(3)
    v_mfma_f32_16x16x32_bf16 v[180:183], a[16:19], v[76:79], v[180:183]
    v_mfma_f32_16x16x32_bf16 v[160:163], a[20:23], v[76:79], v[160:163]
    v_mfma_f32_16x16x32_bf16 v[164:167], a[24:27], v[76:79], v[164:167]
    s_waitcnt lgkmcnt(0)
    v_mfma_f32_16x16x32_bf16 v[168:171], a[28:31], v[76:79], v[168:171]
    v_mfma_f32_16x16x32_bf16 v[172:175], a[32:35], v[76:79], v[172:175]
    v_mfma_f32_16x16x32_bf16 v[176:179], a[36:39], v[76:79], v[176:179]
    s_nop 1
    v_fmamk_f32 v6, v255, 0x358637bd, v180
    v_rcp_f32 v6, v6
    s_nop 0
    v_pk_mul_f32 v[160:161], v[160:161], v[6:7] op_sel_hi:[1,0]
    v_pk_mul_f32 v[162:163], v[162:163], v[6:7] op_sel_hi:[1,0]
    v_pk_mul_f32 v[164:165], v[164:165], v[6:7] op_sel_hi:[1,0]
    v_pk_mul_f32 v[166:167], v[166:167], v[6:7] op_sel_hi:[1,0]
    v_pk_mul_f32 v[168:169], v[168:169], v[6:7] op_sel_hi:[1,0]
    v_pk_mul_f32 v[170:171], v[170:171], v[6:7] op_sel_hi:[1,0]
    v_pk_mul_f32 v[172:173], v[172:173], v[6:7] op_sel_hi:[1,0]
    v_pk_mul_f32 v[174:175], v[174:175], v[6:7] op_sel_hi:[1,0]
    v_pk_mul_f32 v[176:177], v[176:177], v[6:7] op_sel_hi:[1,0]
    v_pk_mul_f32 v[178:179], v[178:179], v[6:7] op_sel_hi:[1,0]
    v_cvt_pk_bf16_f32 v244, v160, v161
    v_cvt_pk_bf16_f32 v245, v162, v163
    v_cvt_pk_bf16_f32 v246, v164, v165
    v_cvt_pk_bf16_f32 v247, v166, v167
    v_cvt_pk_bf16_f32 v248, v168, v169
    v_cvt_pk_bf16_f32 v249, v170, v171
    v_cvt_pk_bf16_f32 v250, v172, v173
    v_cvt_pk_bf16_f32 v251, v174, v175
    v_cvt_pk_bf16_f32 v252, v176, v177
    v_cvt_pk_bf16_f32 v253, v178, v179
    s_cmp_eq_u32 s3, 0
    s_cbranch_scc1 L_far_29
    buffer_store_dwordx4 v[244:247], v5, s[28:31], s7 offen
    buffer_store_dwordx4 v[248:251], v5, s[28:31], s7 offen offset:1024
    buffer_store_dwordx2 v[252:253], v5, s[28:31], s12 offen
L_st_30:
    s_waitcnt vmcnt(4)
    ds_read_b128 a[200:203], v26 offset:2048
    ds_read_b128 a[204:207], v27 offset:2048
    s_add_u32 m0, s66, 0
    s_nop 0
    buffer_load_dwordx4 v24, s[20:23], s100 offen lds
    buffer_load_dwordx4 v25, s[20:23], s100 offen offset:1024 lds
    s_add_u32 s100, s100, 128
    ds_read_b128 a[208:211], v26 offset:4096
    ds_read_b128 a[212:215], v27 offset:4096
    s_waitcnt lgkmcnt(2)
    s_add_u32 m0, s66, 2048
    s_nop 0
    buffer_load_dwordx4 v24, s[20:23], s100 offen lds
    buffer_load_dwordx4 v25, s[20:23], s100 offen offset:1024 lds
    s_add_u32 s100, s100, 128
    ds_read_b128 a[216:219], v26 offset:6144
    ds_read_b128 a[220:223], v27 offset:6144
    s_waitcnt lgkmcnt(2)
    s_add_u32 m0, s66, 4096
    s_nop 0
    buffer_load_dwordx4 v24, s[20:23], s100 offen lds
    buffer_load_dwordx4 v25, s[20:23], s100 offen offset:1024 lds
    s_add_u32 s100, s100, 128
    s_waitcnt vmcnt(6)
    v_mov_b32 v6, s83
    s_mov_b64 exec, 1
    s_cmp_eq_u32 s3, 0
    s_cbranch_scc1 L_far_31
    buffer_store_dword v6, off, s[28:31], s16
L_st_32:
    s_mov_b64 exec, -1
    v_lshlrev_b32 v56, 16, v14
    v_and_b32 v57, 0xffff0000, v14
    v_lshlrev_b32 v58, 16, v15
    v_and_b32 v59, 0xffff0000, v15
    v_lshlrev_b32 v60, 16, v16
    v_and_b32 v61, 0xffff0000, v16
    v_lshlrev_b32 v62, 16, v17
    v_and_b32 v63, 0xffff0000, v17
    v_lshlrev_b32 v64, 16, v18
    v_and_b32 v65, 0xffff0000, v18
    v_lshlrev_b32 v66, 16, v19
    v_and_b32 v67, 0xffff0000, v19
    v_lshlrev_b32 v68, 16, v20
    v_and_b32 v69, 0xffff0000, v20
    v_lshlrev_b32 v70, 16, v21
    v_and_b32 v71, 0xffff0000, v21
    v_lshlrev_b32 v72, 16, v22
    v_and_b32 v73, 0xffff0000, v22
    v_lshlrev_b32 v74, 16, v23
    v_and_b32 v75, 0xffff0000, v23
    s_waitcnt vmcnt(5)
    ds_read_b128 a[224:227], v26 offset:0
    ds_read_b128 a[228:231], v27 offset:0
    s_waitcnt lgkmcnt(2)
    s_add_u32 m0, s66, 6144
    s_nop 0
    buffer_load_dwordx4 v24, s[20:23], s100 offen lds
    buffer_load_dwordx4 v25, s[20:23], s100 offen offset:1024 lds
    s_waitcnt vmcnt(5)
    ds_read_b128 a[232:235], v26 offset:2048
    ds_read_b128 a[236:239], v27 offset:2048
    s_waitcnt lgkmcnt(2)
    s_mov_b32 s100, s62
    s_add_u32 m0, s66, 0
    s_nop 0
    buffer_load_dwordx4 v24, s[20:23], s100 offen lds
    buffer_load_dwordx4 v25, s[20:23], s100 offen offset:1024 lds
    s_add_u32 s100, s100, 128
    s_waitcnt vmcnt(5)
    ds_read_b128 a[240:243], v26 offset:4096
    ds_read_b128 a[244:247], v27 offset:4096
    s_waitcnt lgkmcnt(2)
    s_add_u32 m0, s66, 2048
    s_nop 0
    buffer_load_dwordx4 v24, s[20:23], s100 offen lds
    buffer_load_dwordx4 v25, s[20:23], s100 offen offset:1024 lds
    s_add_u32 s100, s100, 128
    s_mov_b32 s85, s13
    buffer_load_dword v6, v28, s[28:31], s15 offen sc1
    s_waitcnt lgkmcnt(0)
    ds_read_b128 v[192:195], v5 offset:5120
    ds_read_b128 v[196:199], v5 offset:6144
    ds_read_b128 v[200:203], v5 offset:7168
    ds_read_b128 v[204:207], v5 offset:8192
    ds_read_b128 v[208:211], v5 offset:9216
    ds_read_b128 v[212:215], v5 offset:10240
    ds_read_b128 v[216:219], v5 offset:11264
    ds_read_b128 v[220:223], v5 offset:12288
    ds_read_b128 v[224:227], v5 offset:13312
    ds_read_b128 v[228:231], v5 offset:14336
    ds_read_b128 v[232:235], v5 offset:20480
    ds_read_b128 v[236:239], v5 offset:21504
    ds_read_b128 v[240:243], v5 offset:22528
    ds_read_b128 v[244:247], v5 offset:23552
    s_waitcnt vmcnt(0)
    v_cmp_ne_u32 vcc, s83, v6
    s_nop 0
    s_cmp_lg_u64 vcc, 0
    s_cbranch_scc1 L_retry_33
L_ok_34:
    s_add_u32 s15, s15, 16384
    s_add_u32 s16, s16, 16384
    buffer_load_dwordx4 v[112:115], v5, s[28:31], s85 offen offset:0 sc1
    buffer_load_dwordx4 v[116:119], v5, s[28:31], s85 offen offset:1024 sc1
    buffer_load_dwordx4 v[120:123], v5, s[28:31], s85 offen offset:2048 sc1
    buffer_load_dwordx4 v[124:127], v5, s[28:31], s85 offen offset:3072 sc1
    s_add_u32 s85, s85, 4096
    buffer_load_dwordx4 v[128:131], v5, s[28:31], s85 offen offset:0 sc1
    buffer_load_dwordx4 v[132:135], v5, s[28:31], s85 offen offset:1024 sc1
    s_waitcnt vmcnt(5) lgkmcnt(9)
    v_mfma_f32_16x16x32_bf16 v[36:39], v[192:195], v[112:115], 0
    ds_read_b128 v[248:251], v5 offset:24576
    v_mfma_f32_16x16x32_bf16 v[40:43], v[196:199], v[112:115], 0
    ds_read_b128 v[252:255], v5 offset:25600
    buffer_load_dwordx4 v[136:139], v5, s[28:31], s85 offen offset:2048 sc1
    v_mfma_f32_16x16x32_bf16 v[44:47], v[200:203], v[112:115], 0
    ds_read_b128 v[192:195], v5 offset:26624
    v_mfma_f32_16x16x32_bf16 v[48:51], v[204:207], v[112:115], 0
    ds_read_b128 v[196:199], v5 offset:27648
    v_mfma_f32_16x16x32_bf16 v[52:55], v[208:211], v[112:115], 0
    ds_read_b128 v[200:203], v5 offset:28672
    buffer_load_dwordx4 v[140:143], v5, s[28:31], s85 offen offset:3072 sc1
    s_add_u32 s85, s85, 4096
    s_waitcnt vmcnt(6) lgkmcnt(9)
    v_mfma_f32_16x16x32_bf16 v[36:39], v[212:215], v[116:119], v[36:39]
    ds_read_b128 v[204:207], v5 offset:29696
    v_mfma_f32_16x16x32_bf16 v[40:43], v[216:219], v[116:119], v[40:43]
    ds_read_b128 v[208:211], v5 offset:35840
    v_mfma_f32_16x16x32_bf16 v[44:47], v[220:223], v[116:119], v[44:47]
    ds_read_b128 v[212:215], v5 offset:36864
    buffer_load_dwordx4 v[144:147], v5, s[28:31], s85 offen offset:0 sc1
    v_mfma_f32_16x16x32_bf16 v[48:51], v[224:227], v[116:119], v[48:51]
    ds_read_b128 v[216:219], v5 offset:37888
    v_mfma_f32_16x16x32_bf16 v[52:55], v[228:231], v[116:119], v[52:55]
    ds_read_b128 v[220:223], v5 offset:38912
    s_waitcnt vmcnt(6) lgkmcnt(9)
    v_mfma_f32_16x16x32_bf16 v[36:39], v[232:235], v[120:123], v[36:39]
    ds_read_b128 v[224:227], v5 offset:39936
    buffer_load_dwordx4 v[148:151], v5, s[28:31], s85 offen offset:1024 sc1
    v_mfma_f32_16x16x32_bf16 v[40:43], v[236:239], v[120:123], v[40:43]
    ds_read_b128 v[228:231], v5 offset:40960
    v_mfma_f32_16x16x32_bf16 v[44:47], v[240:243], v[120:123], v[44:47]
    ds_read_b128 v[232:235], v5 offset:41984
    v_mfma_f32_16x16x32_bf16 v[48:51], v[244:247], v[120:123], v[48:51]
    ds_read_b128 v[236:239], v5 offset:43008
    buffer_load_dwordx4 v[152:155], v5, s[28:31], s85 offen offset:2048 sc1
    v_mfma_f32_16x16x32_bf16 v[52:55], v[248:251], v[120:123], v[52:55]
    ds_read_b128 v[240:243], v5 offset:44032
    s_waitcnt vmcnt(7) lgkmcnt(9)
    v_mfma_f32_16x16x32_bf16 v[36:39], v[252:255], v[124:127], v[36:39]
    ds_read_b128 v[244:247], v5 offset:45056
    v_mfma_f32_16x16x32_bf16 v[40:43], v[192:195], v[124:127], v[40:43]
    ds_read_b128 v[248:251], v5 offset:51200
    buffer_load_dwordx4 v[156:159], v5, s[28:31], s85 offen offset:3072 sc1
    s_add_u32 s85, s85, 4096
    v_mfma_f32_16x16x32_bf16 v[44:47], v[196:199], v[124:127], v[44:47]
    ds_read_b128 v[252:255], v5 offset:52224
    v_mfma_f32_16x16x32_bf16 v[48:51], v[200:203], v[124:127], v[48:51]
    ds_read_b128 v[192:195], v5 offset:53248
    v_mfma_f32_16x16x32_bf16 v[52:55], v[204:207], v[124:127], v[52:55]
    ds_read_b128 v[196:199], v5 offset:54272
    buffer_load_dwordx4 v[160:163], v5, s[28:31], s85 offen offset:0 sc1
    s_waitcnt vmcnt(8) lgkmcnt(9)
    v_mfma_f32_16x16x32_bf16 v[36:39], v[208:211], v[128:131], v[36:39]
    ds_read_b128 v[200:203], v5 offset:55296
    v_mfma_f32_16x16x32_bf16 v[40:43], v[212:215], v[128:131], v[40:43]
    ds_read_b128 v[204:207], v5 offset:56320
    v_mfma_f32_16x16x32_bf16 v[44:47], v[216:219], v[128:131], v[44:47]
    ds_read_b128 v[208:211], v5 offset:57344
    buffer_load_dwordx4 v[164:167], v5, s[28:31], s85 offen offset:1024 sc1
    v_mfma_f32_16x16x32_bf16 v[48:51], v[220:223], v[128:131], v[48:51]
    ds_read_b128 v[212:215], v5 offset:58368
    v_mfma_f32_16x16x32_bf16 v[52:55], v[224:227], v[128:131], v[52:55]
    ds_read_b128 v[216:219], v5 offset:59392
    s_waitcnt vmcnt(8) lgkmcnt(9)
    v_mfma_f32_16x16x32_bf16 v[36:39], v[228:231], v[132:135], v[36:39]
    ds_read_b128 v[220:223], v5 offset:60416
    buffer_load_dwordx4 v[168:171], v5, s[28:31], s85 offen offset:2048 sc1
    v_mfma_f32_16x16x32_bf16 v[40:43], v[232:235], v[132:135], v[40:43]
    ds_read_b128 v[224:227], v5 offset:61440
    v_mfma_f32_16x16x32_bf16 v[44:47], v[236:239], v[132:135], v[44:47]
    ds_read_b128 v[228:231], v5 offset:62464
    v_mfma_f32_16x16x32_bf16 v[48:51], v[240:243], v[132:135], v[48:51]
    ds_read_b128 v[232:235], v5 offset:63488
    buffer_load_dwordx4 v[172:175], v5, s[28:31], s85 offen offset:3072 sc1
    s_add_u32 s85, s85, 4096
    v_mfma_f32_16x16x32_bf16 v[52:55], v[244:247], v[132:135], v[52:55]
    ds_read_b128 v[236:239], v5 offset:64512
    s_waitcnt vmcnt(9) lgkmcnt(9)
    v_mfma_f32_16x16x32_bf16 v[36:39], v[248:251], v[136:139], v[36:39]
    ds_read_b128 v[240:243], v12 offset:0
    v_mfma_f32_16x16x32_bf16 v[40:43], v[252:255], v[136:139], v[40:43]
    ds_read_b128 v[244:247], v12 offset:1024
    buffer_load_dwordx4 v[176:179], v5, s[28:31], s85 offen offset:0 sc1
    v_mfma_f32_16x16x32_bf16 v[44:47], v[192:195], v[136:139], v[44:47]
    ds_read_b128 v[248:251], v12 offset:2048
    v_mfma_f32_16x16x32_bf16 v[48:51], v[196:199], v[136:139], v[48:51]
    ds_read_b128 v[252:255], v12 offset:3072
    v_mfma_f32_16x16x32_bf16 v[52:55], v[200:203], v[136:139], v[52:55]
    ds_read_b128 v[192:195], v12 offset:4096
    buffer_load_dwordx4 v[180:183], v5, s[28:31], s85 offen offset:1024 sc1
    s_waitcnt vmcnt(10) lgkmcnt(9)
    v_mfma_f32_16x16x32_bf16 v[36:39], v[204:207], v[140:143], v[36:39]
    ds_read_b128 v[196:199], v12 offset:5120
    v_mfma_f32_16x16x32_bf16 v[40:43], v[208:211], v[140:143], v[40:43]
    ds_read_b128 v[200:203], v12 offset:6144
    v_mfma_f32_16x16x32_bf16 v[44:47], v[212:215], v[140:143], v[44:47]
    ds_read_b128 v[204:207], v12 offset:7168
    buffer_load_dwordx4 v[184:187], v5, s[28:31], s85 offen offset:2048 sc1
    v_mfma_f32_16x16x32_bf16 v[48:51], v[216:219], v[140:143], v[48:51]
    ds_read_b128 v[208:211], v12 offset:8192
    v_mfma_f32_16x16x32_bf16 v[52:55], v[220:223], v[140:143], v[52:55]
    ds_read_b128 v[212:215], v12 offset:9216
    s_waitcnt vmcnt(10) lgkmcnt(9)
    v_mfma_f32_16x16x32_bf16 v[36:39], v[224:227], v[144:147], v[36:39]
    ds_read_b128 v[216:219], v12 offset:10240
    buffer_load_dwordx4 v[188:191], v5, s[28:31], s85 offen offset:3072 sc1
    v_mfma_f32_16x16x32_bf16 v[40:43], v[228:231], v[144:147], v[40:43]
    ds_read_b128 v[220:223], v12 offset:11264
    v_mfma_f32_16x16x32_bf16 v[44:47], v[232:235], v[144:147], v[44:47]
    ds_read_b128 v[224:227], v12 offset:12288
    v_mfma_f32_16x16x32_bf16 v[48:51], v[236:239], v[144:147], v[48:51]
    ds_read_b128 v[228:231], v12 offset:13312
    buffer_load_dwordx4 v[16:19], v88, s[28:31], s17 offen sc1
    v_mfma_f32_16x16x32_bf16 v[52:55], v[240:243], v[144:147], v[52:55]
    ds_read_b128 v[232:235], v12 offset:14336
    s_waitcnt vmcnt(11) lgkmcnt(9)
    v_mfma_f32_16x16x32_bf16 v[36:39], v[244:247], v[148:151], v[36:39]
    ds_read_b128 v[236:239], v12 offset:15360
    v_mfma_f32_16x16x32_bf16 v[40:43], v[248:251], v[148:151], v[40:43]
    ds_read_b128 v[240:243], v12 offset:16384
    buffer_load_dwordx4 v[20:23], v88, s[28:31], s18 offen sc1
    v_mfma_f32_16x16x32_bf16 v[44:47], v[252:255], v[148:151], v[44:47]
    ds_read_b128 v[244:247], v12 offset:17408
    v_mfma_f32_16x16x32_bf16 v[48:51], v[192:195], v[148:151], v[48:51]
    ds_read_b128 v[248:251], v12 offset:18432
    v_mfma_f32_16x16x32_bf16 v[52:55], v[196:199], v[148:151], v[52:55]
    ds_read_b128 v[252:255], v12 offset:19456
    buffer_load_dwordx4 v[80:83], v88, s[28:31], s19 offen sc1
    s_waitcnt vmcnt(12) lgkmcnt(9)
    v_mfma_f32_16x16x32_bf16 v[36:39], v[200:203], v[152:155], v[36:39]
    ds_read_b128 v[192:195], v12 offset:20480
    v_mfma_f32_16x16x32_bf16 v[40:43], v[204:207], v[152:155], v[40:43]
    ds_read_b128 v[196:199], v12 offset:21504
    v_mfma_f32_16x16x32_bf16 v[44:47], v[208:211], v[152:155], v[44:47]
    ds_read_b128 v[200:203], v12 offset:22528
    buffer_load_dwordx4 v[84:87], v88, s[28:31], s24 offen sc1
    v_mfma_f32_16x16x32_bf16 v[48:51], v[212:215], v[152:155], v[48:51]
    ds_read_b128 v[204:207], v12 offset:23552
    v_mfma_f32_16x16x32_bf16 v[52:55], v[216:219], v[152:155], v[52:55]
    ds_read_b128 v[208:211], v12 offset:24576
    s_waitcnt vmcnt(12) lgkmcnt(9)
    v_mfma_f32_16x16x32_bf16 v[36:39], v[220:223], v[156:159], v[36:39]
    ds_read_b128 v[212:215], v12 offset:25600
    buffer_load_dwordx4 v[96:99], v88, s[28:31], s25 offen sc1
    s_barrier
    s_add_u32 s98, s48, 122880
    s_add_u32 m0, s54, 0
    s_nop 0
    buffer_load_dwordx4 v5, s[28:31], s98 offen offset:0 sc1 lds
    buffer_load_dwordx4 v5, s[28:31], s98 offen offset:1024 sc1 lds
    buffer_load_dwordx4 v5, s[28:31], s98 offen offset:2048 sc1 lds
    v_mfma_f32_16x16x32_bf16 v[40:43], v[224:227], v[156:159], v[40:43]
    ds_read_b128 v[216:219], v12 offset:26624
    v_mfma_f32_16x16x32_bf16 v[44:47], v[228:231], v[156:159], v[44:47]
    ds_read_b128 v[220:223], v12 offset:27648
    buffer_load_dwordx4 v5, s[28:31], s98 offen offset:3072 sc1 lds
    s_add_u32 s98, s98, 4096
    s_add_u32 m0, s54, 4096
    v_mfma_f32_16x16x32_bf16 v[48:51], v[232:235], v[156:159], v[48:51]
    ds_read_b128 v[224:227], v12 offset:28672
    v_mfma_f32_16x16x32_bf16 v[52:55], v[236:239], v[156:159], v[52:55]
    ds_read_b128 v[228:231], v12 offset:29696
    s_waitcnt vmcnt(16) lgkmcnt(9)
    v_mfma_f32_16x16x32_bf16 v[36:39], v[240:243], v[160:163], v[36:39]
    ds_read_b128 v[232:235], v12 offset:30720
    v_mfma_f32_16x16x32_bf16 v[40:43], v[244:247], v[160:163], v[40:43]
    ds_read_b128 v[236:239], v12 offset:31744
    buffer_load_dwordx4 v5, s[28:31], s98 offen offset:0 sc1 lds
    v_mfma_f32_16x16x32_bf16 v[44:47], v[248:251], v[160:163], v[44:47]
    ds_read_b128 v[240:243], v12 offset:32768
    v_mfma_f32_16x16x32_bf16 v[48:51], v[252:255], v[160:163], v[48:51]
    ds_read_b128 v[244:247], v12 offset:33792
    v_mfma_f32_16x16x32_bf16 v[52:55], v[192:195], v[160:163], v[52:55]
    ds_read_b128 v[248:251], v12 offset:34816
    s_waitcnt vmcnt(16) lgkmcnt(9)
    v_mfma_f32_16x16x32_bf16 v[36:39], v[196:199], v[164:167], v[36:39]
    ds_read_b128 v[252:255], v12 offset:35840
    buffer_load_dwordx4 v5, s[28:31], s98 offen offset:1024 sc1 lds
    v_mfma_f32_16x16x32_bf16 v[40:43], v[200:203], v[164:167], v[40:43]
    ds_read_b128 v[192:195], v12 offset:36864
    v_mfma_f32_16x16x32_bf16 v[44:47], v[204:207], v[164:167], v[44:47]
    ds_read_b128 v[196:199], v12 offset:37888
    v_mfma_f32_16x16x32_bf16 v[48:51], v[208:211], v[164:167], v[48:51]
    ds_read_b128 v[200:203], v12 offset:38912
    v_mfma_f32_16x16x32_bf16 v[52:55], v[212:215], v[164:167], v[52:55]
    ds_read_b128 v[204:207], v12 offset:39936
    buffer_load_dwordx4 v5, s[28:31], s98 offen offset:2048 sc1 lds
    s_waitcnt vmcnt(17) lgkmcnt(9)
    v_mfma_f32_16x16x32_bf16 v[36:39], v[216:219], v[168:171], v[36:39]
    ds_read_b128 v[208:211], v12 offset:40960
    v_mfma_f32_16x16x32_bf16 v[40:43], v[220:223], v[168:171], v[40:43]
    ds_read_b128 v[212:215], v12 offset:41984
    v_mfma_f32_16x16x32_bf16 v[44:47], v[224:227], v[168:171], v[44:47]
    ds_read_b128 v[216:219], v12 offset:43008
    v_mfma_f32_16x16x32_bf16 v[48:51], v[228:231], v[168:171], v[48:51]
    ds_read_b128 v[220:223], v12 offset:44032
    buffer_load_dwordx4 v5, s[28:31], s98 offen offset:3072 sc1 lds
    s_add_u32 s98, s98, 4096
    s_add_u32 m0, s54, 8192
    v_mfma_f32_16x16x32_bf16 v[52:55], v[232:235], v[168:171], v[52:55]
    ds_read_b128 v[224:227], v12 offset:45056
    s_waitcnt vmcnt(17) lgkmcnt(9)
    v_mfma_f32_16x16x32_bf16 v[36:39], v[236:239], v[172:175], v[36:39]
    ds_read_b128 v[228:231], v12 offset:46080
    v_mfma_f32_16x16x32_bf16 v[40:43], v[240:243], v[172:175], v[40:43]
    ds_read_b128 v[232:235], v12 offset:47104
    v_mfma_f32_16x16x32_bf16 v[44:47], v[244:247], v[172:175], v[44:47]
    ds_read_b128 v[236:239], v12 offset:48128
    buffer_load_dwordx4 v5, s[28:31], s98 offen offset:0 sc1 lds
    v_mfma_f32_16x16x32_bf16 v[48:51], v[248:251], v[172:175], v[48:51]
    ds_read_b128 v[240:243], v12 offset:49152
    v_mfma_f32_16x16x32_bf16 v[52:55], v[252:255], v[172:175], v[52:55]
    ds_read_b128 v[244:247], v12 offset:50176
    s_waitcnt vmcnt(17) lgkmcnt(9)
    v_mfma_f32_16x16x32_bf16 v[36:39], v[192:195], v[176:179], v[36:39]
    ds_read_b128 v[248:251], v12 offset:51200
    v_mfma_f32_16x16x32_bf16 v[40:43], v[196:199], v[176:179], v[40:43]
    ds_read_b128 v[252:255], v12 offset:52224
    buffer_load_dwordx4 v5, s[28:31], s98 offen offset:1024 sc1 lds
    v_mfma_f32_16x16x32_bf16 v[44:47], v[200:203], v[176:179], v[44:47]
    ds_read_b128 v[192:195], v12 offset:53248
    v_mfma_f32_16x16x32_bf16 v[48:51], v[204:207], v[176:179], v[48:51]
    ds_read_b128 v[196:199], v12 offset:54272
    v_mfma_f32_16x16x32_bf16 v[52:55], v[208:211], v[176:179], v[52:55]
    ds_read_b128 v[200:203], v12 offset:55296
    s_waitcnt vmcnt(17) lgkmcnt(9)
    v_mfma_f32_16x16x32_bf16 v[36:39], v[212:215], v[180:183], v[36:39]
    ds_read_b128 v[204:207], v12 offset:56320
    buffer_load_dwordx4 v5, s[28:31], s98 offen offset:2048 sc1 lds
    v_mfma_f32_16x16x32_bf16 v[40:43], v[216:219], v[180:183], v[40:43]
    v_mfma_f32_16x16x32_bf16 v[44:47], v[220:223], v[180:183], v[44:47]
    v_mfma_f32_16x16x32_bf16 v[48:51], v[224:227], v[180:183], v[48:51]
    v_mfma_f32_16x16x32_bf16 v[52:55], v[228:231], v[180:183], v[52:55]
    buffer_load_dwordx4 v5, s[28:31], s98 offen offset:3072 sc1 lds
    s_add_u32 s98, s98, 4096
    s_add_u32 m0, s54, 12288
    s_waitcnt vmcnt(18) lgkmcnt(5)
    v_mfma_f32_16x16x32_bf16 v[36:39], v[232:235], v[184:187], v[36:39]
    v_mfma_f32_16x16x32_bf16 v[40:43], v[236:239], v[184:187], v[40:43]
    v_mfma_f32_16x16x32_bf16 v[44:47], v[240:243], v[184:187], v[44:47]
    v_mfma_f32_16x16x32_bf16 v[48:51], v[244:247], v[184:187], v[48:51]
    buffer_load_dwordx4 v5, s[28:31], s98 offen offset:0 sc1 lds
    v_mfma_f32_16x16x32_bf16 v[52:55], v[248:251], v[184:187], v[52:55]
    s_waitcnt vmcnt(18) lgkmcnt(0)
    v_mfma_f32_16x16x32_bf16 v[36:39], v[252:255], v[188:191], v[36:39]
    v_mfma_f32_16x16x32_bf16 v[40:43], v[192:195], v[188:191], v[40:43]
    v_mfma_f32_16x16x32_bf16 v[44:47], v[196:199], v[188:191], v[44:47]
    buffer_load_dwordx4 v5, s[28:31], s98 offen offset:1024 sc1 lds
    v_mfma_f32_16x16x32_bf16 v[48:51], v[200:203], v[188:191], v[48:51]
    v_mfma_f32_16x16x32_bf16 v[52:55], v[204:207], v[188:191], v[52:55]
    s_waitcnt vmcnt(14)
    v_min3_u32 v6, v17, v19, v21
    v_min3_u32 v6, v6, v23, v81
    v_min3_u32 v6, v6, v83, v85
    v_min3_u32 v6, v6, v87, v97
    v_min_u32 v6, v6, v99
    v_max3_u32 v7, v17, v19, v21
    v_max3_u32 v7, v7, v23, v81
    v_max3_u32 v7, v7, v83, v85
    v_max3_u32 v7, v7, v87, v97
    v_max_u32 v7, v7, v99
    v_cmp_ne_u32 vcc, s83, v6
    v_cmp_ne_u32 s[70:71], s83, v7
    s_nop 0
    s_or_b64 vcc, vcc, s[70:71]
    s_cmp_lg_u64 vcc, 0
    s_cbranch_scc1 L_retry_35
L_ok_36:
    v_add_f32 v16, v16, v20
    v_add_f32 v80, v80, v84
    v_add_f32 v96, v96, v92
    v_add_f32 v18, v18, v22
    v_add_f32 v82, v82, v86
    v_add_f32 v98, v98, v92
    v_add_f32 v16, v16, v80
    v_add_f32 v18, v18, v82
    v_add_f32 v6, v16, v96
    v_add_f32 v7, v18, v98
    ds_write_b64 v89, v[6:7]
    s_waitcnt lgkmcnt(0)
    s_barrier
    ds_read_b128 v[192:195], v29 offset:0
    ds_read_b128 v[196:199], v29 offset:64
    ds_read_b128 v[200:203], v29 offset:128
    ds_read_b128 v[204:207], v29 offset:192
    ds_read_b128 v[208:211], v29 offset:256
    ds_read_b128 v[212:215], v29 offset:640
    ds_read_b128 v[216:219], v29 offset:704
    ds_read_b128 v[220:223], v29 offset:768
    ds_read_b128 v[224:227], v29 offset:832
    ds_read_b128 v[228:231], v29 offset:896
    ds_read_b128 v[232:235], v29 offset:320
    ds_read_b128 v[236:239], v29 offset:384
    ds_read_b128 v[240:243], v29 offset:448
    ds_read_b128 v[244:247], v29 offset:512
    ds_read_b128 v[248:251], v29 offset:576
    buffer_load_dwordx4 v5, s[28:31], s98 offen offset:2048 sc1 lds
    s_add_u32 m0, s54, 61440
    s_waitcnt lgkmcnt(10)
    v_pk_fma_f32 v[36:37], v[36:37], v[192:193], v[56:57]
    v_pk_fma_f32 v[38:39], v[38:39], v[194:195], v[58:59]
    v_pk_fma_f32 v[40:41], v[40:41], v[196:197], v[60:61]
    v_pk_fma_f32 v[42:43], v[42:43], v[198:199], v[62:63]
    v_pk_fma_f32 v[44:45], v[44:45], v[200:201], v[64:65]
    v_pk_fma_f32 v[46:47], v[46:47], v[202:203], v[66:67]
    v_pk_fma_f32 v[48:49], v[48:49], v[204:205], v[68:69]
    v_pk_fma_f32 v[50:51], v[50:51], v[206:207], v[70:71]
    v_pk_fma_f32 v[52:53], v[52:53], v[208:209], v[72:73]
    v_pk_fma_f32 v[54:55], v[54:55], v[210:211], v[74:75]
    v_pk_add_f32 v[6:7], v[36:37], v[38:39]
    v_pk_mul_f32 v[8:9], v[36:37], v[36:37]
    v_pk_fma_f32 v[8:9], v[38:39], v[38:39], v[8:9]
    v_pk_add_f32 v[6:7], v[6:7], v[40:41]
    v_pk_fma_f32 v[8:9], v[40:41], v[40:41], v[8:9]
    v_pk_add_f32 v[6:7], v[6:7], v[42:43]
    v_pk_fma_f32 v[8:9], v[42:43], v[42:43], v[8:9]
    v_pk_add_f32 v[6:7], v[6:7], v[44:45]
    v_pk_fma_f32 v[8:9], v[44:45], v[44:45], v[8:9]
    v_pk_add_f32 v[6:7], v[6:7], v[46:47]
    v_pk_fma_f32 v[8:9], v[46:47], v[46:47], v[8:9]
    v_pk_add_f32 v[6:7], v[6:7], v[48:49]
    v_pk_fma_f32 v[8:9], v[48:49], v[48:49], v[8:9]
    v_pk_add_f32 v[6:7], v[6:7], v[50:51]
    v_pk_fma_f32 v[8:9], v[50:51], v[50:51], v[8:9]
    v_pk_add_f32 v[6:7], v[6:7], v[52:53]
    v_pk_fma_f32 v[8:9], v[52:53], v[52:53], v[8:9]
    v_pk_add_f32 v[6:7], v[6:7], v[54:55]
    v_pk_fma_f32 v[8:9], v[54:55], v[54:55], v[8:9]
    v_add_f32 v6, v6, v7
    v_add_f32 v7, v8, v9
    s_nop 1
    v_permlane32_swap_b32 v6, v7
    v_add_f32 v6, v6, v7
    v_mov_b32 v7, v6
    s_nop 1
    v_permlane16_swap_b32 v6, v7
    v_add_f32 v6, v6, v7
    s_cmp_eq_u32 s3, 0
    s_cbranch_scc1 L_far_37
    buffer_store_dword v6, v93, s[28:31], s26 offen
L_st_38:
    s_add_u32 s98, s48, 184320
    buffer_load_dwordx4 v5, s[28:31], s98 offen offset:0 sc1 lds
    buffer_load_dwordx4 v5, s[28:31], s98 offen offset:1024 sc1 lds
    buffer_load_dwordx4 v5, s[28:31], s98 offen offset:2048 sc1 lds
    buffer_load_dwordx4 v5, s[28:31], s98 offen offset:3072 sc1 lds
    s_add_u32 s98, s98, 4096
    s_add_u32 m0, s54, 65536
    buffer_load_dword v76, v94, s[28:31], s27 offen offset:0 sc1
    buffer_load_dword v77, v94, s[28:31], s27 offen offset:64 sc1
    buffer_load_dword v78, v94, s[28:31], s27 offen offset:128 sc1
    buffer_load_dword v79, v94, s[28:31], s27 offen offset:192 sc1
    buffer_load_dwordx4 v5, s[28:31], s98 offen offset:0 sc1 lds
    buffer_load_dwordx4 v5, s[28:31], s98 offen offset:1024 sc1 lds
    buffer_load_dwordx4 v5, s[28:31], s98 offen offset:2048 sc1 lds
    buffer_load_dwordx4 v5, s[28:31], s98 offen offset:3072 sc1 lds
    s_add_u32 s98, s98, 4096
    s_add_u32 m0, s54, 69632
    s_waitcnt vmcnt(4)
    v_max3_u32 v6, v76, v77, v78
    v_max_u32 v6, v6, v79
    v_cmp_eq_u32 vcc, -1, v6
    s_nop 0
    s_cmp_lg_u64 vcc, 0
    s_cbranch_scc1 L_retry_39
L_ok_40:
    v_add_f32 v76, v76, v78
    v_add_f32 v77, v77, v79
    v_mov_b32 v6, v76
    v_mov_b32 v7, v77
    s_nop 0
    v_permlane32_swap_b32 v76, v6
    v_permlane32_swap_b32 v77, v7
    v_add_f32 v76, v76, v6
    v_add_f32 v77, v77, v7
    v_mov_b32 v6, v76
    v_mov_b32 v7, v77
    s_nop 0
    v_permlane16_swap_b32 v76, v6
    v_permlane16_swap_b32 v77, v7
    v_add_f32 v76, v76, v6
    v_add_f32 v77, v77, v7
    v_mul_f32 v76, 0x3acccccd, v76
    v_mul_f32 v77, 0x3acccccd, v77
    v_fma_f32 v77, -v76, v76, v77
    v_max_f32 v77, 0, v77
    v_add_f32 v77, 0x3727c5ac, v77
    v_rsq_f32 v6, v77
    s_nop 0
    v_mul_f32 v7, -v76, v6
    s_waitcnt lgkmcnt(0)
    v_pk_fma_f32 v[112:113], v[36:37], v[6:7], v[6:7] op_sel:[0,0,1] op_sel_hi:[1,0,1]
    v_pk_fma_f32 v[114:115], v[38:39], v[6:7], v[6:7] op_sel:[0,0,1] op_sel_hi:[1,0,1]
    v_pk_fma_f32 v[116:117], v[40:41], v[6:7], v[6:7] op_sel:[0,0,1] op_sel_hi:[1,0,1]
    v_pk_fma_f32 v[118:119], v[42:43], v[6:7], v[6:7] op_sel:[0,0,1] op_sel_hi:[1,0,1]
    v_pk_fma_f32 v[120:121], v[44:45], v[6:7], v[6:7] op_sel:[0,0,1] op_sel_hi:[1,0,1]
    v_pk_fma_f32 v[122:123], v[46:47], v[6:7], v[6:7] op_sel:[0,0,1] op_sel_hi:[1,0,1]
    v_pk_fma_f32 v[124:125], v[48:49], v[6:7], v[6:7] op_sel:[0,0,1] op_sel_hi:[1,0,1]
    v_pk_fma_f32 v[126:127], v[50:51], v[6:7], v[6:7] op_sel:[0,0,1] op_sel_hi:[1,0,1]
    v_pk_fma_f32 v[128:129], v[52:53], v[6:7], v[6:7] op_sel:[0,0,1] op_sel_hi:[1,0,1]
    v_pk_fma_f32 v[130:131], v[54:55], v[6:7], v[6:7] op_sel:[0,0,1] op_sel_hi:[1,0,1]
    v_pk_fma_f32 v[112:113], v[112:113], v[212:213], v[232:233]
    v_pk_fma_f32 v[114:115], v[114:115], v[214:215], v[234:235]
    v_pk_fma_f32 v[116:117], v[116:117], v[216:217], v[236:237]
    v_pk_fma_f32 v[118:119], v[118:119], v[218:219], v[238:239]
    v_pk_fma_f32 v[120:121], v[120:121], v[220:221], v[240:241]
    v_pk_fma_f32 v[122:123], v[122:123], v[222:223], v[242:243]
    v_pk_fma_f32 v[124:125], v[124:125], v[224:225], v[244:245]
    v_pk_fma_f32 v[126:127], v[126:127], v[226:227], v[246:247]
    v_pk_fma_f32 v[128:129], v[128:129], v[228:229], v[248:249]
    v_pk_fma_f32 v[130:131], v[130:131], v[230:231], v[250:251]
    v_cvt_pk_bf16_f32 v132, v112, v113
    v_cvt_pk_bf16_f32 v133, v114, v115
    v_cvt_pk_bf16_f32 v134, v116, v117
    v_cvt_pk_bf16_f32 v135, v118, v119
    v_cvt_pk_bf16_f32 v136, v120, v121
    v_cvt_pk_bf16_f32 v137, v122, v123
    v_cvt_pk_bf16_f32 v138, v124, v125
    v_cvt_pk_bf16_f32 v139, v126, v127
    v_cvt_pk_bf16_f32 v140, v128, v129
    v_cvt_pk_bf16_f32 v141, v130, v131
    s_cmp_eq_u32 s3, 0
    s_cbranch_scc1 L_far_41
    buffer_store_dwordx4 v[132:135], v5, s[28:31], s7 offen
    buffer_store_dwordx4 v[136:139], v5, s[28:31], s7 offen offset:1024
    buffer_store_dwordx2 v[140:141], v5, s[28:31], s12 offen
L_st_42:
    buffer_load_dwordx4 v5, s[28:31], s98 offen offset:0 sc1 lds
    buffer_load_dwordx4 v5, s[28:31], s98 offen offset:1024 sc1 lds
    buffer_load_dwordx4 v5, s[28:31], s98 offen offset:2048 sc1 lds
    buffer_load_dwordx4 v5, s[28:31], s98 offen offset:3072 sc1 lds
    s_add_u32 s98, s98, 4096
    s_add_u32 m0, s54, 73728
    s_nop 0
    buffer_load_dwordx4 v5, s[28:31], s98 offen offset:0 sc1 lds
    buffer_load_dwordx4 v5, s[28:31], s98 offen offset:1024 sc1 lds
    buffer_load_dwordx4 v5, s[28:31], s98 offen offset:2048 sc1 lds
    s_waitcnt vmcnt(7)
    v_mov_b32 v6, s83
    s_mov_b64 exec, 1
    s_cmp_eq_u32 s3, 0
    s_cbranch_scc1 L_far_43
    buffer_store_dword v6, off, s[28:31], s16
L_st_44:
    s_mov_b64 exec, -1
    global_load_dwordx4 v[16:19], v5, s[74:75]
    s_add_u32 s74, s74, 4096
    s_addc_u32 s75, s75, 0
    ds_read_b128 a[248:251], v26 offset:6144
    ds_read_b128 a[252:255], v27 offset:6144
    s_add_u32 m0, s66, 4096
    s_nop 0
    buffer_load_dwordx4 v24, s[20:23], s100 offen lds
    buffer_load_dwordx4 v25, s[20:23], s100 offen offset:1024 lds
    s_add_u32 s100, s100, 128
    ds_read_b128 a[128:131], v26 offset:0
    ds_read_b128 a[132:135], v27 offset:0
    s_waitcnt lgkmcnt(2)
    s_add_u32 m0, s66, 6144
    s_nop 0
    buffer_load_dwordx4 v24, s[20:23], s100 offen lds
    buffer_load_dwordx4 v25, s[20:23], s100 offen offset:1024 lds
    s_add_u32 s100, s100, 128
    s_mov_b32 s85, s13
    buffer_load_dword v6, v28, s[28:31], s15 offen sc1
    s_waitcnt vmcnt(7)
    s_barrier
    s_waitcnt lgkmcnt(0)
    ds_read_b128 v[192:195], v5 offset:0
    ds_read_b128 v[196:199], v5 offset:1024
    ds_read_b128 v[200:203], v5 offset:2048
    ds_read_b128 v[204:207], v5 offset:3072
    ds_read_b128 v[208:211], v5 offset:4096
    ds_read_b128 v[212:215], v5 offset:5120
    ds_read_b128 v[216:219], v5 offset:6144
    ds_read_b128 v[220:223], v5 offset:7168
    ds_read_b128 v[224:227], v5 offset:8192
    ds_read_b128 v[228:231], v5 offset:9216
    ds_read_b128 v[232:235], v5 offset:10240
    ds_read_b128 v[236:239], v5 offset:11264
    ds_read_b128 v[240:243], v5 offset:12288
    ds_read_b128 v[244:247], v5 offset:13312
    s_waitcnt vmcnt(0)
    v_cmp_ne_u32 vcc, s83, v6
    s_nop 0
    s_cmp_lg_u64 vcc, 0
    s_cbranch_scc1 L_retry_45
L_ok_46:
    s_add_u32 s15, s15, 16384
    s_add_u32 s16, s16, 16384
    buffer_load_dwordx4 v[112:115], v5, s[28:31], s85 offen offset:0 sc1
    buffer_load_dwordx4 v[116:119], v5, s[28:31], s85 offen offset:1024 sc1
    buffer_load_dwordx4 v[120:123], v5, s[28:31], s85 offen offset:2048 sc1
    buffer_load_dwordx4 v[124:127], v5, s[28:31], s85 offen offset:3072 sc1
    s_add_u32 s85, s85, 4096
    buffer_load_dwordx4 v[128:131], v5, s[28:31], s85 offen offset:0 sc1
    buffer_load_dwordx4 v[132:135], v5, s[28:31], s85 offen offset:1024 sc1
    s_waitcnt vmcnt(5) lgkmcnt(8)
    v_mfma_f32_16x16x32_bf16 v[80:83], v[112:115], v[192:195], 0
    ds_read_b128 v[248:251], v5 offset:14336
    v_mfma_f32_16x16x32_bf16 v[84:87], v[112:115], v[196:199], 0
    ds_read_b128 v[252:255], v5 offset:15360
    buffer_load_dwordx4 v[136:139], v5, s[28:31], s85 offen offset:2048 sc1
    v_mfma_f32_16x16x32_bf16 v[88:91], v[112:115], v[200:203], 0
    ds_read_b128 v[192:195], v5 offset:16384
    v_mfma_f32_16x16x32_bf16 v[92:95], v[112:115], v[204:207], 0
    ds_read_b128 v[196:199], v5 offset:17408
    v_mfma_f32_16x16x32_bf16 v[96:99], v[112:115], v[208:211], 0
    ds_read_b128 v[200:203], v5 offset:18432
    buffer_load_dwordx4 v[140:143], v5, s[28:31], s85 offen offset:3072 sc1
    s_add_u32 s85, s85, 4096
    v_mfma_f32_16x16x32_bf16 v[100:103], v[112:115], v[212:215], 0
    ds_read_b128 v[204:207], v5 offset:19456
    s_waitcnt vmcnt(6) lgkmcnt(8)
    v_mfma_f32_16x16x32_bf16 v[80:83], v[116:119], v[216:219], v[80:83]
    ds_read_b128 v[208:211], v5 offset:20480
    v_mfma_f32_16x16x32_bf16 v[84:87], v[116:119], v[220:223], v[84:87]
    ds_read_b128 v[212:215], v5 offset:21504
    buffer_load_dwordx4 v[144:147], v5, s[28:31], s85 offen offset:0 sc1
    v_mfma_f32_16x16x32_bf16 v[88:91], v[116:119], v[224:227], v[88:91]
    ds_read_b128 v[216:219], v5 offset:22528
    v_mfma_f32_16x16x32_bf16 v[92:95], v[116:119], v[228:231], v[92:95]
    ds_read_b128 v[220:223], v5 offset:23552
    v_mfma_f32_16x16x32_bf16 v[96:99], v[116:119], v[232:235], v[96:99]
    ds_read_b128 v[224:227], v5 offset:24576
    buffer_load_dwordx4 v[148:151], v5, s[28:31], s85 offen offset:1024 sc1
    v_mfma_f32_16x16x32_bf16 v[100:103], v[116:119], v[236:239], v[100:103]
    ds_read_b128 v[228:231], v5 offset:25600
    s_waitcnt vmcnt(7) lgkmcnt(8)
    v_mfma_f32_16x16x32_bf16 v[80:83], v[120:123], v[240:243], v[80:83]
    ds_read_b128 v[232:235], v5 offset:26624
    v_mfma_f32_16x16x32_bf16 v[84:87], v[120:123], v[244:247], v[84:87]
    ds_read_b128 v[236:239], v5 offset:27648
    buffer_load_dwordx4 v[152:155], v5, s[28:31], s85 offen offset:2048 sc1
    v_mfma_f32_16x16x32_bf16 v[88:91], v[120:123], v[248:251], v[88:91]
    ds_read_b128 v[240:243], v5 offset:28672
    v_mfma_f32_16x16x32_bf16 v[92:95], v[120:123], v[252:255], v[92:95]
    ds_read_b128 v[244:247], v5 offset:29696
    v_mfma_f32_16x16x32_bf16 v[96:99], v[120:123], v[192:195], v[96:99]
    ds_read_b128 v[248:251], v5 offset:30720
    buffer_load_dwordx4 v[156:159], v5, s[28:31], s85 offen offset:3072 sc1
    s_add_u32 s85, s85, 4096
    v_mfma_f32_16x16x32_bf16 v[100:103], v[120:123], v[196:199], v[100:103]
    ds_read_b128 v[252:255], v5 offset:31744
    s_waitcnt vmcnt(8) lgkmcnt(8)
    v_mfma_f32_16x16x32_bf16 v[80:83], v[124:127], v[200:203], v[80:83]
    ds_read_b128 v[192:195], v5 offset:32768
    v_mfma_f32_16x16x32_bf16 v[84:87], v[124:127], v[204:207], v[84:87]
    ds_read_b128 v[196:199], v5 offset:33792
    buffer_load_dwordx4 v[160:163], v5, s[28:31], s85 offen offset:0 sc1
    v_mfma_f32_16x16x32_bf16 v[88:91], v[124:127], v[208:211], v[88:91]
    ds_read_b128 v[200:203], v5 offset:34816
    v_mfma_f32_16x16x32_bf16 v[92:95], v[124:127], v[212:215], v[92:95]
    ds_read_b128 v[204:207], v5 offset:35840
    v_mfma_f32_16x16x32_bf16 v[96:99], v[124:127], v[216:219], v[96:99]
    ds_read_b128 v[208:211], v5 offset:36864
    buffer_load_dwordx4 v[164:167], v5, s[28:31], s85 offen offset:1024 sc1
    v_mfma_f32_16x16x32_bf16 v[100:103], v[124:127], v[220:223], v[100:103]
    ds_read_b128 v[212:215], v5 offset:37888
    s_waitcnt vmcnt(9) lgkmcnt(8)
    v_mfma_f32_16x16x32_bf16 v[80:83], v[128:131], v[224:227], v[80:83]
    ds_read_b128 v[216:219], v5 offset:38912
    v_mfma_f32_16x16x32_bf16 v[84:87], v[128:131], v[228:231], v[84:87]
    ds_read_b128 v[220:223], v5 offset:39936
    buffer_load_dwordx4 v[168:171], v5, s[28:31], s85 offen offset:2048 sc1
    v_mfma_f32_16x16x32_bf16 v[88:91], v[128:131], v[232:235], v[88:91]
    ds_read_b128 v[224:227], v5 offset:40960
    v_mfma_f32_16x16x32_bf16 v[92:95], v[128:131], v[236:239], v[92:95]
    ds_read_b128 v[228:231], v5 offset:41984
    v_mfma_f32_16x16x32_bf16 v[96:99], v[128:131], v[240:243], v[96:99]
    ds_read_b128 v[232:235], v5 offset:43008
    buffer_load_dwordx4 v[172:175], v5, s[28:31], s85 offen offset:3072 sc1
    s_add_u32 s85, s85, 4096
    v_mfma_f32_16x16x32_bf16 v[100:103], v[128:131], v[244:247], v[100:103]
    ds_read_b128 v[236:239], v5 offset:44032
    s_waitcnt vmcnt(10) lgkmcnt(8)
    v_mfma_f32_16x16x32_bf16 v[80:83], v[132:135], v[248:251], v[80:83]
    ds_read_b128 v[240:243], v5 offset:45056
    v_mfma_f32_16x16x32_bf16 v[84:87], v[132:135], v[252:255], v[84:87]
    ds_read_b128 v[244:247], v5 offset:46080
    buffer_load_dwordx4 v[176:179], v5, s[28:31], s85 offen offset:0 sc1
    v_mfma_f32_16x16x32_bf16 v[88:91], v[132:135], v[192:195], v[88:91]
    ds_read_b128 v[248:251], v5 offset:47104
    v_mfma_f32_16x16x32_bf16 v[92:95], v[132:135], v[196:199], v[92:95]
    ds_read_b128 v[252:255], v5 offset:48128
    v_mfma_f32_16x16x32_bf16 v[96:99], v[132:135], v[200:203], v[96:99]
    ds_read_b128 v[192:195], v5 offset:49152
    buffer_load_dwordx4 v[180:183], v5, s[28:31], s85 offen offset:1024 sc1
    v_mfma_f32_16x16x32_bf16 v[100:103], v[132:135], v[204:207], v[100:103]
    ds_read_b128 v[196:199], v5 offset:50176
    s_waitcnt vmcnt(11) lgkmcnt(8)
    v_mfma_f32_16x16x32_bf16 v[80:83], v[136:139], v[208:211], v[80:83]
    ds_read_b128 v[200:203], v5 offset:51200
    v_mfma_f32_16x16x32_bf16 v[84:87], v[136:139], v[212:215], v[84:87]
    ds_read_b128 v[204:207], v5 offset:52224
    buffer_load_dwordx4 v[184:187], v5, s[28:31], s85 offen offset:2048 sc1
    v_mfma_f32_16x16x32_bf16 v[88:91], v[136:139], v[216:219], v[88:91]
    ds_read_b128 v[208:211], v5 offset:53248
    v_mfma_f32_16x16x32_bf16 v[92:95], v[136:139], v[220:223], v[92:95]
    ds_read_b128 v[212:215], v5 offset:54272
    v_mfma_f32_16x16x32_bf16 v[96:99], v[136:139], v[224:227], v[96:99]
    ds_read_b128 v[216:219], v5 offset:55296
    buffer_load_dwordx4 v[188:191], v5, s[28:31], s85 offen offset:3072 sc1
    v_mfma_f32_16x16x32_bf16 v[100:103], v[136:139], v[228:231], v[100:103]
    ds_read_b128 v[220:223], v5 offset:56320
    s_waitcnt vmcnt(12) lgkmcnt(8)
    v_mfma_f32_16x16x32_bf16 v[80:83], v[140:143], v[232:235], v[80:83]
    ds_read_b128 v[224:227], v5 offset:57344
    v_mfma_f32_16x16x32_bf16 v[84:87], v[140:143], v[236:239], v[84:87]
    ds_read_b128 v[228:231], v5 offset:58368
    buffer_load_dword v32, v33, s[20:23], s63 offen
    v_mfma_f32_16x16x32_bf16 v[88:91], v[140:143], v[240:243], v[88:91]
    ds_read_b128 v[232:235], v5 offset:59392
    v_mfma_f32_16x16x32_bf16 v[92:95], v[140:143], v[244:247], v[92:95]
    ds_read_b128 v[236:239], v5 offset:60416
    v_mfma_f32_16x16x32_bf16 v[96:99], v[140:143], v[248:251], v[96:99]
    ds_read_b128 v[240:243], v5 offset:61440
    v_mfma_f32_16x16x32_bf16 v[100:103], v[140:143], v[252:255], v[100:103]
    ds_read_b128 v[244:247], v5 offset:62464
    s_waitcnt vmcnt(12) lgkmcnt(8)
    v_mfma_f32_16x16x32_bf16 v[80:83], v[144:147], v[192:195], v[80:83]
    ds_read_b128 v[248:251], v5 offset:63488
    v_mfma_f32_16x16x32_bf16 v[84:87], v[144:147], v[196:199], v[84:87]
    ds_read_b128 v[252:255], v5 offset:64512
    v_mfma_f32_16x16x32_bf16 v[88:91], v[144:147], v[200:203], v[88:91]
    ds_read_b128 v[192:195], v12 offset:0
    v_mfma_f32_16x16x32_bf16 v[92:95], v[144:147], v[204:207], v[92:95]
    ds_read_b128 v[196:199], v12 offset:1024
    v_mfma_f32_16x16x32_bf16 v[96:99], v[144:147], v[208:211], v[96:99]
    ds_read_b128 v[200:203], v12 offset:2048
    v_mfma_f32_16x16x32_bf16 v[100:103], v[144:147], v[212:215], v[100:103]
    ds_read_b128 v[204:207], v12 offset:3072
    s_waitcnt vmcnt(11) lgkmcnt(8)
    v_mfma_f32_16x16x32_bf16 v[80:83], v[148:151], v[216:219], v[80:83]
    ds_read_b128 v[208:211], v12 offset:4096
    v_mfma_f32_16x16x32_bf16 v[84:87], v[148:151], v[220:223], v[84:87]
    ds_read_b128 v[212:215], v12 offset:5120
    v_mfma_f32_16x16x32_bf16 v[88:91], v[148:151], v[224:227], v[88:91]
    ds_read_b128 v[216:219], v12 offset:6144
    v_mfma_f32_16x16x32_bf16 v[92:95], v[148:151], v[228:231], v[92:95]
    ds_read_b128 v[220:223], v12 offset:7168
    v_mfma_f32_16x16x32_bf16 v[96:99], v[148:151], v[232:235], v[96:99]
    ds_read_b128 v[224:227], v12 offset:8192
    v_mfma_f32_16x16x32_bf16 v[100:103], v[148:151], v[236:239], v[100:103]
    ds_read_b128 v[228:231], v12 offset:9216
    s_waitcnt vmcnt(10) lgkmcnt(8)
    v_mfma_f32_16x16x32_bf16 v[80:83], v[152:155], v[240:243], v[80:83]
    ds_read_b128 v[232:235], v12 offset:10240
    s_barrier
    s_add_u32 s98, s48, 0
    s_add_u32 m0, s54, 0
    s_nop 0
    buffer_load_dwordx4 v5, s[28:31], s98 offen offset:0 sc1 lds
    buffer_load_dwordx4 v5, s[28:31], s98 offen offset:1024 sc1 lds
    buffer_load_dwordx4 v5, s[28:31], s98 offen offset:2048 sc1 lds
    v_mfma_f32_16x16x32_bf16 v[84:87], v[152:155], v[244:247], v[84:87]
    ds_read_b128 v[236:239], v12 offset:11264
    buffer_load_dwordx4 v5, s[28:31], s98 offen offset:3072 sc1 lds
    s_add_u32 s98, s98, 4096
    s_add_u32 m0, s54, 4096
    v_mfma_f32_16x16x32_bf16 v[88:91], v[152:155], v[248:251], v[88:91]
    ds_read_b128 v[240:243], v12 offset:12288
    v_mfma_f32_16x16x32_bf16 v[92:95], v[152:155], v[252:255], v[92:95]
    ds_read_b128 v[244:247], v12 offset:13312
    v_mfma_f32_16x16x32_bf16 v[96:99], v[152:155], v[192:195], v[96:99]
    ds_read_b128 v[248:251], v12 offset:14336
    v_mfma_f32_16x16x32_bf16 v[100:103], v[152:155], v[196:199], v[100:103]
    ds_read_b128 v[252:255], v12 offset:15360
    buffer_load_dwordx4 v5, s[28:31], s98 offen offset:0 sc1 lds
    s_waitcnt vmcnt(14) lgkmcnt(8)
    v_mfma_f32_16x16x32_bf16 v[80:83], v[156:159], v[200:203], v[80:83]
    ds_read_b128 v[192:195], v12 offset:16384
    v_mfma_f32_16x16x32_bf16 v[84:87], v[156:159], v[204:207], v[84:87]
    ds_read_b128 v[196:199], v12 offset:17408
    v_mfma_f32_16x16x32_bf16 v[88:91], v[156:159], v[208:211], v[88:91]
    ds_read_b128 v[200:203], v12 offset:18432
    v_mfma_f32_16x16x32_bf16 v[92:95], v[156:159], v[212:215], v[92:95]
    ds_read_b128 v[204:207], v12 offset:19456
    buffer_load_dwordx4 v5, s[28:31], s98 offen offset:1024 sc1 lds
    v_mfma_f32_16x16x32_bf16 v[96:99], v[156:159], v[216:219], v[96:99]
    ds_read_b128 v[208:211], v12 offset:20480
    v_mfma_f32_16x16x32_bf16 v[100:103], v[156:159], v[220:223], v[100:103]
    ds_read_b128 v[212:215], v12 offset:21504
    s_waitcnt vmcnt(14) lgkmcnt(8)
    v_mfma_f32_16x16x32_bf16 v[80:83], v[160:163], v[224:227], v[80:83]
    ds_read_b128 v[216:219], v12 offset:22528
    v_mfma_f32_16x16x32_bf16 v[84:87], v[160:163], v[228:231], v[84:87]
    ds_read_b128 v[220:223], v12 offset:23552
    buffer_load_dwordx4 v5, s[28:31], s98 offen offset:2048 sc1 lds
    v_mfma_f32_16x16x32_bf16 v[88:91], v[160:163], v[232:235], v[88:91]
    ds_read_b128 v[224:227], v12 offset:24576
    v_mfma_f32_16x16x32_bf16 v[92:95], v[160:163], v[236:239], v[92:95]
    ds_read_b128 v[228:231], v12 offset:25600
    v_mfma_f32_16x16x32_bf16 v[96:99], v[160:163], v[240:243], v[96:99]
    ds_read_b128 v[232:235], v12 offset:26624
    v_mfma_f32_16x16x32_bf16 v[100:103], v[160:163], v[244:247], v[100:103]
    ds_read_b128 v[236:239], v12 offset:27648
    buffer_load_dwordx4 v5, s[28:31], s98 offen offset:3072 sc1 lds
    s_add_u32 s98, s98, 4096
    s_add_u32 m0, s54, 8192
    s_waitcnt vmcnt(15) lgkmcnt(8)
    v_mfma_f32_16x16x32_bf16 v[80:83], v[164:167], v[248:251], v[80:83]
    ds_read_b128 v[240:243], v12 offset:28672
    v_mfma_f32_16x16x32_bf16 v[84:87], v[164:167], v[252:255], v[84:87]
    ds_read_b128 v[244:247], v12 offset:29696
    v_mfma_f32_16x16x32_bf16 v[88:91], v[164:167], v[192:195], v[88:91]
    ds_read_b128 v[248:251], v12 offset:30720
    v_mfma_f32_16x16x32_bf16 v[92:95], v[164:167], v[196:199], v[92:95]
    ds_read_b128 v[252:255], v12 offset:31744
    buffer_load_dwordx4 v5, s[28:31], s98 offen offset:0 sc1 lds
    v_mfma_f32_16x16x32_bf16 v[96:99], v[164:167], v[200:203], v[96:99]
    ds_read_b128 v[192:195], v12 offset:32768
    v_mfma_f32_16x16x32_bf16 v[100:103], v[164:167], v[204:207], v[100:103]
    ds_read_b128 v[196:199], v12 offset:33792
    s_waitcnt vmcnt(15) lgkmcnt(8)
    v_mfma_f32_16x16x32_bf16 v[80:83], v[168:171], v[208:211], v[80:83]
    ds_read_b128 v[200:203], v12 offset:34816
    v_mfma_f32_16x16x32_bf16 v[84:87], v[168:171], v[212:215], v[84:87]
    ds_read_b128 v[204:207], v12 offset:35840
    buffer_load_dwordx4 v5, s[28:31], s98 offen offset:1024 sc1 lds
    v_mfma_f32_16x16x32_bf16 v[88:91], v[168:171], v[216:219], v[88:91]
    ds_read_b128 v[208:211], v12 offset:36864
    v_mfma_f32_16x16x32_bf16 v[92:95], v[168:171], v[220:223], v[92:95]
    ds_read_b128 v[212:215], v12 offset:37888
    v_mfma_f32_16x16x32_bf16 v[96:99], v[168:171], v[224:227], v[96:99]
    ds_read_b128 v[216:219], v12 offset:38912
    v_mfma_f32_16x16x32_bf16 v[100:103], v[168:171], v[228:231], v[100:103]
    ds_read_b128 v[220:223], v12 offset:39936
    buffer_load_dwordx4 v5, s[28:31], s98 offen offset:2048 sc1 lds
    s_waitcnt vmcnt(16) lgkmcnt(8)
    v_mfma_f32_16x16x32_bf16 v[80:83], v[172:175], v[232:235], v[80:83]
    ds_read_b128 v[224:227], v12 offset:40960
    v_mfma_f32_16x16x32_bf16 v[84:87], v[172:175], v[236:239], v[84:87]
    ds_read_b128 v[228:231], v12 offset:41984
    v_mfma_f32_16x16x32_bf16 v[88:91], v[172:175], v[240:243], v[88:91]
    ds_read_b128 v[232:235], v12 offset:43008
    v_mfma_f32_16x16x32_bf16 v[92:95], v[172:175], v[244:247], v[92:95]
    ds_read_b128 v[236:239], v12 offset:44032
    buffer_load_dwordx4 v5, s[28:31], s98 offen offset:3072 sc1 lds
    s_add_u32 s98, s98, 4096
    s_add_u32 m0, s54, 12288
    v_mfma_f32_16x16x32_bf16 v[96:99], v[172:175], v[248:251], v[96:99]
    ds_read_b128 v[240:243], v12 offset:45056
    v_mfma_f32_16x16x32_bf16 v[100:103], v[172:175], v[252:255], v[100:103]
    ds_read_b128 v[244:247], v12 offset:46080
    s_waitcnt vmcnt(16) lgkmcnt(8)
    v_mfma_f32_16x16x32_bf16 v[80:83], v[176:179], v[192:195], v[80:83]
    ds_read_b128 v[248:251], v12 offset:47104
    v_mfma_f32_16x16x32_bf16 v[84:87], v[176:179], v[196:199], v[84:87]
    ds_read_b128 v[252:255], v12 offset:48128
    buffer_load_dwordx4 v5, s[28:31], s98 offen offset:0 sc1 lds
    v_mfma_f32_16x16x32_bf16 v[88:91], v[176:179], v[200:203], v[88:91]
    ds_read_b128 v[192:195], v12 offset:49152
    v_mfma_f32_16x16x32_bf16 v[92:95], v[176:179], v[204:207], v[92:95]
    ds_read_b128 v[196:199], v12 offset:50176
    v_mfma_f32_16x16x32_bf16 v[96:99], v[176:179], v[208:211], v[96:99]
    ds_read_b128 v[200:203], v12 offset:51200
    v_mfma_f32_16x16x32_bf16 v[100:103], v[176:179], v[212:215], v[100:103]
    ds_read_b128 v[204:207], v12 offset:52224
    buffer_load_dwordx4 v5, s[28:31], s98 offen offset:1024 sc1 lds
    s_waitcnt vmcnt(17) lgkmcnt(8)
    v_mfma_f32_16x16x32_bf16 v[80:83], v[180:183], v[216:219], v[80:83]
    ds_read_b128 v[208:211], v12 offset:53248
    v_mfma_f32_16x16x32_bf16 v[84:87], v[180:183], v[220:223], v[84:87]
    ds_read_b128 v[212:215], v12 offset:54272
    v_mfma_f32_16x16x32_bf16 v[88:91], v[180:183], v[224:227], v[88:91]
    ds_read_b128 v[216:219], v12 offset:55296
    v_mfma_f32_16x16x32_bf16 v[92:95], v[180:183], v[228:231], v[92:95]
    ds_read_b128 v[220:223], v12 offset:56320
    buffer_load_dwordx4 v5, s[28:31], s98 offen offset:2048 sc1 lds
    v_mfma_f32_16x16x32_bf16 v[96:99], v[180:183], v[232:235], v[96:99]
    v_mfma_f32_16x16x32_bf16 v[100:103], v[180:183], v[236:239], v[100:103]
    s_waitcnt vmcnt(17) lgkmcnt(6)
    v_mfma_f32_16x16x32_bf16 v[80:83], v[184:187], v[240:243], v[80:83]
    v_mfma_f32_16x16x32_bf16 v[84:87], v[184:187], v[244:247], v[84:87]
    v_mfma_f32_16x16x32_bf16 v[88:91], v[184:187], v[248:251], v[88:91]
    v_mfma_f32_16x16x32_bf16 v[92:95], v[184:187], v[252:255], v[92:95]
    v_mfma_f32_16x16x32_bf16 v[96:99], v[184:187], v[192:195], v[96:99]
    v_mfma_f32_16x16x32_bf16 v[100:103], v[184:187], v[196:199], v[100:103]
    s_waitcnt vmcnt(16) lgkmcnt(0)
    v_mfma_f32_16x16x32_bf16 v[80:83], v[188:191], v[200:203], v[80:83]
    v_mfma_f32_16x16x32_bf16 v[84:87], v[188:191], v[204:207], v[84:87]
    v_mfma_f32_16x16x32_bf16 v[88:91], v[188:191], v[208:211], v[88:91]
    v_mfma_f32_16x16x32_bf16 v[92:95], v[188:191], v[212:215], v[92:95]
    v_mfma_f32_16x16x32_bf16 v[96:99], v[188:191], v[216:219], v[96:99]
    v_mfma_f32_16x16x32_bf16 v[100:103], v[188:191], v[220:223], v[100:103]
    s_barrier
    s_mov_b32 s88, 0xbdd2d3e8
    s_mov_b32 s89, 0xbdd2d3e8
    v_mov_b32 v6, 0xc0135761
    v_mov_b32 v7, 1.0
    v_pk_mul_f32 v[208:209], v[80:81], v[80:81]
    v_pk_mul_f32 v[210:211], v[82:83], v[82:83]
    v_pk_mul_f32 v[212:213], v[84:85], v[84:85]
    v_pk_mul_f32 v[214:215], v[86:87], v[86:87]
    v_pk_mul_f32 v[216:217], v[88:89], v[88:89]
    v_pk_mul_f32 v[218:219], v[90:91], v[90:91]
    v_pk_mul_f32 v[220:221], v[92:93], v[92:93]
    v_pk_mul_f32 v[222:223], v[94:95], v[94:95]
    s_add_u32 s98, s48, 61440
    s_add_u32 m0, s54, 61440
    s_nop 0
    buffer_load_dwordx4 v5, s[28:31], s98 offen offset:0 sc1 lds
    v_pk_mul_f32 v[224:225], v[96:97], v[96:97]
    v_pk_mul_f32 v[226:227], v[98:99], v[98:99]
    v_pk_mul_f32 v[228:229], v[100:101], v[100:101]
    v_pk_mul_f32 v[230:231], v[102:103], v[102:103]
    v_pk_fma_f32 v[208:209], v[208:209], s[88:89], v[6:7] op_sel_hi:[1,1,0]
    v_pk_fma_f32 v[210:211], v[210:211], s[88:89], v[6:7] op_sel_hi:[1,1,0]
    v_pk_fma_f32 v[212:213], v[212:213], s[88:89], v[6:7] op_sel_hi:[1,1,0]
    v_pk_fma_f32 v[214:215], v[214:215], s[88:89], v[6:7] op_sel_hi:[1,1,0]
    v_pk_fma_f32 v[216:217], v[216:217], s[88:89], v[6:7] op_sel_hi:[1,1,0]
    v_pk_fma_f32 v[218:219], v[218:219], s[88:89], v[6:7] op_sel_hi:[1,1,0]
    buffer_load_dwordx4 v5, s[28:31], s98 offen offset:1024 sc1 lds
    v_pk_fma_f32 v[220:221], v[220:221], s[88:89], v[6:7] op_sel_hi:[1,1,0]
    v_pk_fma_f32 v[222:223], v[222:223], s[88:89], v[6:7] op_sel_hi:[1,1,0]
    v_pk_fma_f32 v[224:225], v[224:225], s[88:89], v[6:7] op_sel_hi:[1,1,0]
    v_pk_fma_f32 v[226:227], v[226:227], s[88:89], v[6:7] op_sel_hi:[1,1,0]
    v_pk_fma_f32 v[228:229], v[228:229], s[88:89], v[6:7] op_sel_hi:[1,1,0]
    v_pk_fma_f32 v[230:231], v[230:231], s[88:89], v[6:7] op_sel_hi:[1,1,0]
    v_pk_mul_f32 v[208:209], v[208:209], v[80:81]
    v_pk_mul_f32 v[210:211], v[210:211], v[82:83]
    v_pk_mul_f32 v[212:213], v[212:213], v[84:85]
    v_pk_mul_f32 v[214:215], v[214:215], v[86:87]
    buffer_load_dwordx4 v5, s[28:31], s98 offen offset:2048 sc1 lds
    v_pk_mul_f32 v[216:217], v[216:217], v[88:89]
    v_pk_mul_f32 v[218:219], v[218:219], v[90:91]
    v_pk_mul_f32 v[220:221], v[220:221], v[92:93]
    v_pk_mul_f32 v[222:223], v[222:223], v[94:95]
    v_pk_mul_f32 v[224:225], v[224:225], v[96:97]
    v_pk_mul_f32 v[226:227], v[226:227], v[98:99]
    v_pk_mul_f32 v[228:229], v[228:229], v[100:101]
    v_pk_mul_f32 v[230:231], v[230:231], v[102:103]
    v_exp_f32 v208, v208
    v_exp_f32 v209, v209
    buffer_load_dwordx4 v5, s[28:31], s98 offen offset:3072 sc1 lds
    s_add_u32 s98, s98, 4096
    s_add_u32 m0, s54, 65536
    v_exp_f32 v210, v210
    v_exp_f32 v211, v211
    v_exp_f32 v212, v212
    v_exp_f32 v213, v213
    v_exp_f32 v214, v214
    v_exp_f32 v215, v215
    v_exp_f32 v216, v216
    v_exp_f32 v217, v217
    v_exp_f32 v218, v218
    v_exp_f32 v219, v219
    buffer_load_dwordx4 v5, s[28:31], s98 offen offset:0 sc1 lds
    v_exp_f32 v220, v220
    v_exp_f32 v221, v221
    v_exp_f32 v222, v222
    v_exp_f32 v223, v223
    v_exp_f32 v224, v224
    v_exp_f32 v225, v225
    v_exp_f32 v226, v226
    v_exp_f32 v227, v227
    v_exp_f32 v228, v228
    v_exp_f32 v229, v229
    buffer_load_dwordx4 v5, s[28:31], s98 offen offset:1024 sc1 lds
    v_exp_f32 v230, v230
    v_exp_f32 v231, v231
    v_pk_add_f32 v[208:209], v[208:209], v[6:7] op_sel:[0,1] op_sel_hi:[1,1]
    v_pk_add_f32 v[210:211], v[210:211], v[6:7] op_sel:[0,1] op_sel_hi:[1,1]
    v_pk_add_f32 v[212:213], v[212:213], v[6:7] op_sel:[0,1] op_sel_hi:[1,1]
    v_pk_add_f32 v[214:215], v[214:215], v[6:7] op_sel:[0,1] op_sel_hi:[1,1]
    v_pk_add_f32 v[216:217], v[216:217], v[6:7] op_sel:[0,1] op_sel_hi:[1,1]
    v_pk_add_f32 v[218:219], v[218:219], v[6:7] op_sel:[0,1] op_sel_hi:[1,1]
    v_pk_add_f32 v[220:221], v[220:221], v[6:7] op_sel:[0,1] op_sel_hi:[1,1]
    v_pk_add_f32 v[222:223], v[222:223], v[6:7] op_sel:[0,1] op_sel_hi:[1,1]
    buffer_load_dwordx4 v5, s[28:31], s98 offen offset:2048 sc1 lds
    v_pk_add_f32 v[224:225], v[224:225], v[6:7] op_sel:[0,1] op_sel_hi:[1,1]
    v_pk_add_f32 v[226:227], v[226:227], v[6:7] op_sel:[0,1] op_sel_hi:[1,1]
    v_pk_add_f32 v[228:229], v[228:229], v[6:7] op_sel:[0,1] op_sel_hi:[1,1]
    v_pk_add_f32 v[230:231], v[230:231], v[6:7] op_sel:[0,1] op_sel_hi:[1,1]
    v_rcp_f32 v208, v208
    v_rcp_f32 v209, v209
    v_rcp_f32 v210, v210
    v_rcp_f32 v211, v211
    v_rcp_f32 v212, v212
    v_rcp_f32 v213, v213
    buffer_load_dwordx4 v5, s[28:31], s98 offen offset:3072 sc1 lds
    s_add_u32 s98, s98, 4096
    s_add_u32 m0, s54, 69632
    v_rcp_f32 v214, v214
    v_rcp_f32 v215, v215
    v_rcp_f32 v216, v216
    v_rcp_f32 v217, v217
    v_rcp_f32 v218, v218
    v_rcp_f32 v219, v219
    v_rcp_f32 v220, v220
    v_rcp_f32 v221, v221
    v_rcp_f32 v222, v222
    v_rcp_f32 v223, v223
    buffer_load_dwordx4 v5, s[28:31], s98 offen offset:0 sc1 lds
    v_rcp_f32 v224, v224
    v_rcp_f32 v225, v225
    v_rcp_f32 v226, v226
    v_rcp_f32 v227, v227
    v_rcp_f32 v228, v228
    v_rcp_f32 v229, v229
    v_rcp_f32 v230, v230
    v_rcp_f32 v231, v231
    v_pk_mul_f32 v[80:81], v[80:81], v[208:209]
    v_pk_mul_f32 v[82:83], v[82:83], v[210:211]
    buffer_load_dwordx4 v5, s[28:31], s98 offen offset:1024 sc1 lds
    v_pk_mul_f32 v[84:85], v[84:85], v[212:213]
    v_pk_mul_f32 v[86:87], v[86:87], v[214:215]
    v_pk_mul_f32 v[88:89], v[88:89], v[216:217]
    v_pk_mul_f32 v[90:91], v[90:91], v[218:219]
    v_pk_mul_f32 v[92:93], v[92:93], v[220:221]
    v_pk_mul_f32 v[94:95], v[94:95], v[222:223]
    v_pk_mul_f32 v[96:97], v[96:97], v[224:225]
    v_pk_mul_f32 v[98:99], v[98:99], v[226:227]
    v_pk_mul_f32 v[100:101], v[100:101], v[228:229]
    v_pk_mul_f32 v[102:103], v[102:103], v[230:231]
    buffer_load_dwordx4 v5, s[28:31], s98 offen offset:2048 sc1 lds
    v_pk_add_f32 v[192:193], v[80:81], v[84:85]
    v_pk_mul_f32 v[196:197], v[80:81], v[80:81]
    v_pk_add_f32 v[194:195], v[82:83], v[86:87]
    v_pk_mul_f32 v[198:199], v[82:83], v[82:83]
    v_pk_fma_f32 v[196:197], v[84:85], v[84:85], v[196:197]
    v_pk_fma_f32 v[198:199], v[86:87], v[86:87], v[198:199]
    v_pk_add_f32 v[192:193], v[192:193], v[88:89]
    v_pk_fma_f32 v[196:197], v[88:89], v[88:89], v[196:197]
    v_pk_add_f32 v[194:195], v[194:195], v[90:91]
    v_pk_fma_f32 v[198:199], v[90:91], v[90:91], v[198:199]
    buffer_load_dwordx4 v5, s[28:31], s98 offen offset:3072 sc1 lds
    s_add_u32 s98, s98, 4096
    s_add_u32 m0, s54, 73728
    v_pk_add_f32 v[192:193], v[192:193], v[92:93]
    v_pk_fma_f32 v[196:197], v[92:93], v[92:93], v[196:197]
    v_pk_add_f32 v[194:195], v[194:195], v[94:95]
    v_pk_fma_f32 v[198:199], v[94:95], v[94:95], v[198:199]
    v_pk_add_f32 v[192:193], v[192:193], v[96:97]
    v_pk_fma_f32 v[196:197], v[96:97], v[96:97], v[196:197]
    v_pk_add_f32 v[194:195], v[194:195], v[98:99]
    v_pk_fma_f32 v[198:199], v[98:99], v[98:99], v[198:199]
    v_pk_add_f32 v[192:193], v[192:193], v[100:101]
    v_pk_fma_f32 v[196:197], v[100:101], v[100:101], v[196:197]
    buffer_load_dwordx4 v5, s[28:31], s98 offen offset:0 sc1 lds
    v_pk_add_f32 v[194:195], v[194:195], v[102:103]
    v_pk_fma_f32 v[198:199], v[102:103], v[102:103], v[198:199]
    v_add_f32_dpp v192, v192, v192 quad_perm:[1,0,3,2] row_mask:0xf bank_mask:0xf
    v_add_f32_dpp v193, v193, v193 quad_perm:[1,0,3,2] row_mask:0xf bank_mask:0xf
    v_add_f32_dpp v194, v194, v194 quad_perm:[1,0,3,2] row_mask:0xf bank_mask:0xf
    v_add_f32_dpp v195, v195, v195 quad_perm:[1,0,3,2] row_mask:0xf bank_mask:0xf
    v_add_f32_dpp v196, v196, v196 quad_perm:[1,0,3,2] row_mask:0xf bank_mask:0xf
    v_add_f32_dpp v197, v197, v197 quad_perm:[1,0,3,2] row_mask:0xf bank_mask:0xf
    v_add_f32_dpp v198, v198, v198 quad_perm:[1,0,3,2] row_mask:0xf bank_mask:0xf
    v_add_f32_dpp v199, v199, v199 quad_perm:[1,0,3,2] row_mask:0xf bank_mask:0xf
    buffer_load_dwordx4 v5, s[28:31], s98 offen offset:1024 sc1 lds
    v_add_f32_dpp v192, v192, v192 quad_perm:[2,3,0,1] row_mask:0xf bank_mask:0xf
    v_add_f32_dpp v193, v193, v193 quad_perm:[2,3,0,1] row_mask:0xf bank_mask:0xf
    v_add_f32_dpp v194, v194, v194 quad_perm:[2,3,0,1] row_mask:0xf bank_mask:0xf
    v_add_f32_dpp v195, v195, v195 quad_perm:[2,3,0,1] row_mask:0xf bank_mask:0xf
    v_add_f32_dpp v196, v196, v196 quad_perm:[2,3,0,1] row_mask:0xf bank_mask:0xf
    v_add_f32_dpp v197, v197, v197 quad_perm:[2,3,0,1] row_mask:0xf bank_mask:0xf
    v_add_f32_dpp v198, v198, v198 quad_perm:[2,3,0,1] row_mask:0xf bank_mask:0xf
    v_add_f32_dpp v199, v199, v199 quad_perm:[2,3,0,1] row_mask:0xf bank_mask:0xf
    v_add_f32_dpp v192, v192, v192 row_half_mirror row_mask:0xf bank_mask:0xf
    v_add_f32_dpp v193, v193, v193 row_half_mirror row_mask:0xf bank_mask:0xf
    buffer_load_dwordx4 v5, s[28:31], s98 offen offset:2048 sc1 lds
    v_add_f32_dpp v194, v194, v194 row_half_mirror row_mask:0xf bank_mask:0xf
    v_add_f32_dpp v195, v195, v195 row_half_mirror row_mask:0xf bank_mask:0xf
    v_add_f32_dpp v196, v196, v196 row_half_mirror row_mask:0xf bank_mask:0xf
    v_add_f32_dpp v197, v197, v197 row_half_mirror row_mask:0xf bank_mask:0xf
    v_add_f32_dpp v198, v198, v198 row_half_mirror row_mask:0xf bank_mask:0xf
    v_add_f32_dpp v199, v199, v199 row_half_mirror row_mask:0xf bank_mask:0xf
    v_add_f32_dpp v192, v192, v192 row_mirror row_mask:0xf bank_mask:0xf
    v_add_f32_dpp v193, v193, v193 row_mirror row_mask:0xf bank_mask:0xf
    v_add_f32_dpp v194, v194, v194 row_mirror row_mask:0xf bank_mask:0xf
    v_add_f32_dpp v195, v195, v195 row_mirror row_mask:0xf bank_mask:0xf
    v_add_f32_dpp v196, v196, v196 row_mirror row_mask:0xf bank_mask:0xf
    v_add_f32_dpp v197, v197, v197 row_mirror row_mask:0xf bank_mask:0xf
    v_add_f32_dpp v198, v198, v198 row_mirror row_mask:0xf bank_mask:0xf
    v_add_f32_dpp v199, v199, v199 row_mirror row_mask:0xf bank_mask:0xf
    s_cmp_eq_u32 s3, 0
    s_cbranch_scc1 L_far_47
    buffer_store_dwordx4 v[192:195], v16, s[28:31], s40 offen
    buffer_store_dwordx4 v[196:199], v16, s[28:31], s40 offen offset:64
L_st_48:
    buffer_load_dwordx4 v[104:107], v17, s[28:31], s41 offen sc1
    s_waitcnt vmcnt(18)
    s_barrier
    s_waitcnt lgkmcnt(0)
    ds_read_b128 v[192:195], v5 offset:0
    ds_read_b128 v[196:199], v5 offset:1024
    ds_read_b128 v[200:203], v5 offset:2048
    ds_read_b128 v[204:207], v5 offset:3072
    ds_read_b128 v[208:211], v5 offset:4096
    ds_read_b128 v[212:215], v5 offset:5120
    ds_read_b128 v[216:219], v5 offset:6144
    ds_read_b128 v[220:223], v5 offset:7168
    ds_read_b128 v[224:227], v5 offset:8192
    ds_read_b128 v[228:231], v5 offset:9216
    ds_read_b128 v[232:235], v5 offset:10240
    ds_read_b128 v[236:239], v5 offset:11264
    ds_read_b128 v[240:243], v5 offset:12288
    ds_read_b128 v[244:247], v5 offset:13312
    s_waitcnt lgkmcnt(8)
    v_mfma_f32_16x16x32_bf16 v[56:59], v[192:195], v[112:115], 0
    ds_read_b128 v[248:251], v5 offset:14336
    v_mfma_f32_16x16x32_bf16 v[60:63], v[196:199], v[112:115], 0
    ds_read_b128 v[252:255], v5 offset:15360
    v_mfma_f32_16x16x32_bf16 v[64:67], v[200:203], v[112:115], 0
    ds_read_b128 v[192:195], v5 offset:16384
    v_mfma_f32_16x16x32_bf16 v[68:71], v[204:207], v[112:115], 0
    ds_read_b128 v[196:199], v5 offset:17408
    v_mfma_f32_16x16x32_bf16 v[72:75], v[208:211], v[112:115], 0
    ds_read_b128 v[200:203], v5 offset:18432
    v_mfma_f32_16x16x32_bf16 v[76:79], v[212:215], v[112:115], 0
    ds_read_b128 v[204:207], v5 offset:19456
    s_waitcnt lgkmcnt(8)
    v_mfma_f32_16x16x32_bf16 v[56:59], v[216:219], v[116:119], v[56:59]
    ds_read_b128 v[208:211], v5 offset:20480
    v_mfma_f32_16x16x32_bf16 v[60:63], v[220:223], v[116:119], v[60:63]
    ds_read_b128 v[212:215], v5 offset:21504
    v_mfma_f32_16x16x32_bf16 v[64:67], v[224:227], v[116:119], v[64:67]
    ds_read_b128 v[216:219], v5 offset:22528
    v_mfma_f32_16x16x32_bf16 v[68:71], v[228:231], v[116:119], v[68:71]
    ds_read_b128 v[220:223], v5 offset:23552
    v_mfma_f32_16x16x32_bf16 v[72:75], v[232:235], v[116:119], v[72:75]
    ds_read_b128 v[224:227], v5 offset:24576
    v_mfma_f32_16x16x32_bf16 v[76:79], v[236:239], v[116:119], v[76:79]
    ds_read_b128 v[228:231], v5 offset:25600
    s_waitcnt lgkmcnt(8)
    v_mfma_f32_16x16x32_bf16 v[56:59], v[240:243], v[120:123], v[56:59]
    ds_read_b128 v[232:235], v5 offset:26624
    v_mfma_f32_16x16x32_bf16 v[60:63], v[244:247], v[120:123], v[60:63]
    ds_read_b128 v[236:239], v5 offset:27648
    v_mfma_f32_16x16x32_bf16 v[64:67], v[248:251], v[120:123], v[64:67]
    ds_read_b128 v[240:243], v5 offset:28672
    v_mfma_f32_16x16x32_bf16 v[68:71], v[252:255], v[120:123], v[68:71]
    ds_read_b128 v[244:247], v5 offset:29696
    v_mfma_f32_16x16x32_bf16 v[72:75], v[192:195], v[120:123], v[72:75]
    ds_read_b128 v[248:251], v5 offset:30720
    v_mfma_f32_16x16x32_bf16 v[76:79], v[196:199], v[120:123], v[76:79]
    ds_read_b128 v[252:255], v5 offset:31744
    s_waitcnt lgkmcnt(8)
    v_mfma_f32_16x16x32_bf16 v[56:59], v[200:203], v[124:127], v[56:59]
    ds_read_b128 v[192:195], v5 offset:32768
    v_mfma_f32_16x16x32_bf16 v[60:63], v[204:207], v[124:127], v[60:63]
    ds_read_b128 v[196:199], v5 offset:33792
    v_mfma_f32_16x16x32_bf16 v[64:67], v[208:211], v[124:127], v[64:67]
    ds_read_b128 v[200:203], v5 offset:34816
    s_waitcnt vmcnt(0)
    v_max3_u32 v6, v104, v105, v106
    v_max_u32 v6, v6, v107
    v_cmp_eq_u32 vcc, -1, v6
    s_nop 0
    s_cmp_lg_u64 vcc, 0
    s_cbranch_scc1 L_retry_49
L_ok_50:
    v_cmp_gt_u32 vcc, 8, v2
    v_add_f32_dpp v104, v104, v104 quad_perm:[1,0,3,2] row_mask:0xf bank_mask:0xf
    v_add_f32_dpp v105, v105, v105 quad_perm:[1,0,3,2] row_mask:0xf bank_mask:0xf
    v_add_f32_dpp v106, v106, v106 quad_perm:[1,0,3,2] row_mask:0xf bank_mask:0xf
    v_add_f32_dpp v107, v107, v107 quad_perm:[1,0,3,2] row_mask:0xf bank_mask:0xf
    v_add_f32_dpp v104, v104, v104 quad_perm:[2,3,0,1] row_mask:0xf bank_mask:0xf
    v_add_f32_dpp v105, v105, v105 quad_perm:[2,3,0,1] row_mask:0xf bank_mask:0xf
    v_add_f32_dpp v106, v106, v106 quad_perm:[2,3,0,1] row_mask:0xf bank_mask:0xf
    v_add_f32_dpp v107, v107, v107 quad_perm:[2,3,0,1] row_mask:0xf bank_mask:0xf
    v_add_f32_dpp v104, v104, v104 row_half_mirror row_mask:0xf bank_mask:0xf
    v_add_f32_dpp v105, v105, v105 row_half_mirror row_mask:0xf bank_mask:0xf
    v_add_f32_dpp v106, v106, v106 row_half_mirror row_mask:0xf bank_mask:0xf
    v_add_f32_dpp v107, v107, v107 row_half_mirror row_mask:0xf bank_mask:0xf
    v_mov_b32_dpp v108, v104 row_ror:8 row_mask:0xf bank_mask:0xf
    v_mov_b32_dpp v109, v105 row_ror:8 row_mask:0xf bank_mask:0xf
    v_mov_b32_dpp v110, v106 row_ror:8 row_mask:0xf bank_mask:0xf
    v_mov_b32_dpp v111, v107 row_ror:8 row_mask:0xf bank_mask:0xf
    v_cndmask_b32 v6, v108, v104, vcc
    v_cndmask_b32 v104, v104, v108, vcc
    v_cndmask_b32 v7, v109, v105, vcc
    v_cndmask_b32 v105, v105, v109, vcc
    v_cndmask_b32 v8, v110, v106, vcc
    v_cndmask_b32 v106, v106, v110, vcc
    v_cndmask_b32 v9, v111, v107, vcc
    v_cndmask_b32 v107, v107, v111, vcc
    s_mov_b32 s88, 0x3aaaaaab
    s_mov_b32 s89, 0x3727c5ac
    v_pk_mul_f32 v[6:7], v[6:7], s[88:89] op_sel_hi:[1,0]
    v_pk_fma_f32 v[104:105], v[104:105], s[88:89], s[88:89] op_sel:[0,0,1] op_sel_hi:[1,0,1]
    v_pk_mul_f32 v[8:9], v[8:9], s[88:89] op_sel_hi:[1,0]
    v_pk_fma_f32 v[106:107], v[106:107], s[88:89], s[88:89] op_sel:[0,0,1] op_sel_hi:[1,0,1]
    v_pk_fma_f32 v[104:105], v[6:7], v[6:7], v[104:105] neg_lo:[1,0,0] neg_hi:[1,0,0]
    v_pk_fma_f32 v[106:107], v[8:9], v[8:9], v[106:107] neg_lo:[1,0,0] neg_hi:[1,0,0]
    v_max_f32 v104, s89, v104
    v_max_f32 v105, s89, v105
    v_max_f32 v106, s89, v106
    v_max_f32 v107, s89, v107
    v_rsq_f32 v104, v104
    v_rsq_f32 v105, v105
    v_rsq_f32 v106, v106
    v_rsq_f32 v107, v107
    v_pk_mul_f32 v[108:109], v[6:7], v[104:105] neg_lo:[1,0] neg_hi:[1,0]
    v_pk_mul_f32 v[110:111], v[8:9], v[106:107] neg_lo:[1,0] neg_hi:[1,0]
    v_pk_fma_f32 v[80:81], v[80:81], v[104:105], v[108:109]
    v_pk_fma_f32 v[82:83], v[82:83], v[106:107], v[110:111]
    v_pk_fma_f32 v[84:85], v[84:85], v[104:105], v[108:109]
    v_pk_fma_f32 v[86:87], v[86:87], v[106:107], v[110:111]
    v_pk_fma_f32 v[88:89], v[88:89], v[104:105], v[108:109]
    v_pk_fma_f32 v[90:91], v[90:91], v[106:107], v[110:111]
    v_pk_fma_f32 v[92:93], v[92:93], v[104:105], v[108:109]
    v_pk_fma_f32 v[94:95], v[94:95], v[106:107], v[110:111]
    v_pk_fma_f32 v[96:97], v[96:97], v[104:105], v[108:109]
    v_pk_fma_f32 v[98:99], v[98:99], v[106:107], v[110:111]
    v_pk_fma_f32 v[100:101], v[100:101], v[104:105], v[108:109]
    v_pk_fma_f32 v[102:103], v[102:103], v[106:107], v[110:111]
    v_cvt_pk_bf16_f32 v80, v80, v81
    v_cvt_pk_bf16_f32 v81, v82, v83
    v_cvt_pk_bf16_f32 v82, v84, v85
    v_cvt_pk_bf16_f32 v83, v86, v87
    v_cvt_pk_bf16_f32 v84, v88, v89
    v_cvt_pk_bf16_f32 v85, v90, v91
    v_cvt_pk_bf16_f32 v86, v92, v93
    v_cvt_pk_bf16_f32 v87, v94, v95
    v_cvt_pk_bf16_f32 v88, v96, v97
    v_cvt_pk_bf16_f32 v89, v98, v99
    v_cvt_pk_bf16_f32 v90, v100, v101
    v_cvt_pk_bf16_f32 v91, v102, v103
    v_permlane16_swap_b32 v80, v82
    v_permlane16_swap_b32 v81, v83
    v_permlane16_swap_b32 v84, v86
    v_permlane16_swap_b32 v85, v87
    v_permlane16_swap_b32 v88, v90
    v_permlane16_swap_b32 v89, v91
    buffer_store_dwordx4 v[80:83], v18, s[28:31], s42 offen sc1
    buffer_store_dwordx4 v[84:87], v18, s[28:31], s42 offen offset:2048 sc1
    buffer_store_dwordx4 v[88:91], v18, s[28:31], s43 offen sc1
    buffer_load_dword v32, v33, s[20:23], s64 offen
    v_mfma_f32_16x16x32_bf16 v[68:71], v[212:215], v[124:127], v[68:71]
    ds_read_b128 v[204:207], v5 offset:35840
    v_mfma_f32_16x16x32_bf16 v[72:75], v[216:219], v[124:127], v[72:75]
    ds_read_b128 v[208:211], v5 offset:36864
    v_mfma_f32_16x16x32_bf16 v[76:79], v[220:223], v[124:127], v[76:79]
    ds_read_b128 v[212:215], v5 offset:37888
    s_waitcnt lgkmcnt(8)
    v_mfma_f32_16x16x32_bf16 v[56:59], v[224:227], v[128:131], v[56:59]
    ds_read_b128 v[216:219], v5 offset:38912
    v_mfma_f32_16x16x32_bf16 v[60:63], v[228:231], v[128:131], v[60:63]
    ds_read_b128 v[220:223], v5 offset:39936
    v_mfma_f32_16x16x32_bf16 v[64:67], v[232:235], v[128:131], v[64:67]
    ds_read_b128 v[224:227], v5 offset:40960
    v_mfma_f32_16x16x32_bf16 v[68:71], v[236:239], v[128:131], v[68:71]
    ds_read_b128 v[228:231], v5 offset:41984
    v_mfma_f32_16x16x32_bf16 v[72:75], v[240:243], v[128:131], v[72:75]
    ds_read_b128 v[232:235], v5 offset:43008
    v_mfma_f32_16x16x32_bf16 v[76:79], v[244:247], v[128:131], v[76:79]
    ds_read_b128 v[236:239], v5 offset:44032
    s_waitcnt lgkmcnt(8)
    v_mfma_f32_16x16x32_bf16 v[56:59], v[248:251], v[132:135], v[56:59]
    ds_read_b128 v[240:243], v5 offset:45056
    v_mfma_f32_16x16x32_bf16 v[60:63], v[252:255], v[132:135], v[60:63]
    ds_read_b128 v[244:247], v5 offset:46080
    v_mfma_f32_16x16x32_bf16 v[64:67], v[192:195], v[132:135], v[64:67]
    ds_read_b128 v[248:251], v5 offset:47104
    v_mfma_f32_16x16x32_bf16 v[68:71], v[196:199], v[132:135], v[68:71]
    ds_read_b128 v[252:255], v5 offset:48128
    v_mfma_f32_16x16x32_bf16 v[72:75], v[200:203], v[132:135], v[72:75]
    ds_read_b128 v[192:195], v5 offset:49152
    v_mfma_f32_16x16x32_bf16 v[76:79], v[204:207], v[132:135], v[76:79]
    ds_read_b128 v[196:199], v5 offset:50176
    s_waitcnt lgkmcnt(8)
    v_mfma_f32_16x16x32_bf16 v[56:59], v[208:211], v[136:139], v[56:59]
    ds_read_b128 v[200:203], v5 offset:51200
    v_mfma_f32_16x16x32_bf16 v[60:63], v[212:215], v[136:139], v[60:63]
    ds_read_b128 v[204:207], v5 offset:52224
    v_mfma_f32_16x16x32_bf16 v[64:67], v[216:219], v[136:139], v[64:67]
    ds_read_b128 v[208:211], v5 offset:53248
    v_mfma_f32_16x16x32_bf16 v[68:71], v[220:223], v[136:139], v[68:71]
    ds_read_b128 v[212:215], v5 offset:54272
    v_mfma_f32_16x16x32_bf16 v[72:75], v[224:227], v[136:139], v[72:75]
    ds_read_b128 v[216:219], v5 offset:55296
    v_mfma_f32_16x16x32_bf16 v[76:79], v[228:231], v[136:139], v[76:79]
    ds_read_b128 v[220:223], v5 offset:56320
    s_waitcnt lgkmcnt(8)
    v_mfma_f32_16x16x32_bf16 v[56:59], v[232:235], v[140:143], v[56:59]
    ds_read_b128 v[224:227], v5 offset:57344
    v_mfma_f32_16x16x32_bf16 v[60:63], v[236:239], v[140:143], v[60:63]
    ds_read_b128 v[228:231], v5 offset:58368
    v_mfma_f32_16x16x32_bf16 v[64:67], v[240:243], v[140:143], v[64:67]
    ds_read_b128 v[232:235], v5 offset:59392
    v_mfma_f32_16x16x32_bf16 v[68:71], v[244:247], v[140:143], v[68:71]
    ds_read_b128 v[236:239], v5 offset:60416
    s_barrier
    v_mfma_f32_16x16x32_bf16 v[72:75], v[248:251], v[140:143], v[72:75]
    ds_read_b128 v[240:243], v5 offset:61440
    v_mfma_f32_16x16x32_bf16 v[76:79], v[252:255], v[140:143], v[76:79]
    ds_read_b128 v[244:247], v5 offset:62464
    s_waitcnt lgkmcnt(8)
    v_mfma_f32_16x16x32_bf16 v[56:59], v[192:195], v[144:147], v[56:59]
    ds_read_b128 v[248:251], v5 offset:63488
    v_mfma_f32_16x16x32_bf16 v[60:63], v[196:199], v[144:147], v[60:63]
    ds_read_b128 v[252:255], v5 offset:64512
    v_mfma_f32_16x16x32_bf16 v[64:67], v[200:203], v[144:147], v[64:67]
    ds_read_b128 v[192:195], v12 offset:0
    v_mfma_f32_16x16x32_bf16 v[68:71], v[204:207], v[144:147], v[68:71]
    ds_read_b128 v[196:199], v12 offset:1024
    v_mfma_f32_16x16x32_bf16 v[72:75], v[208:211], v[144:147], v[72:75]
    ds_read_b128 v[200:203], v12 offset:2048
    v_mfma_f32_16x16x32_bf16 v[76:79], v[212:215], v[144:147], v[76:79]
    ds_read_b128 v[204:207], v12 offset:3072
    s_waitcnt lgkmcnt(8)
    v_mfma_f32_16x16x32_bf16 v[56:59], v[216:219], v[148:151], v[56:59]
    ds_read_b128 v[208:211], v12 offset:4096
    v_mfma_f32_16x16x32_bf16 v[60:63], v[220:223], v[148:151], v[60:63]
    ds_read_b128 v[212:215], v12 offset:5120
    v_mfma_f32_16x16x32_bf16 v[64:67], v[224:227], v[148:151], v[64:67]
    ds_read_b128 v[216:219], v12 offset:6144
    v_mfma_f32_16x16x32_bf16 v[68:71], v[228:231], v[148:151], v[68:71]
    ds_read_b128 v[220:223], v12 offset:7168
    v_mfma_f32_16x16x32_bf16 v[72:75], v[232:235], v[148:151], v[72:75]
    ds_read_b128 v[224:227], v12 offset:8192
    v_mfma_f32_16x16x32_bf16 v[76:79], v[236:239], v[148:151], v[76:79]
    ds_read_b128 v[228:231], v12 offset:9216
    s_waitcnt lgkmcnt(8)
    v_mfma_f32_16x16x32_bf16 v[56:59], v[240:243], v[152:155], v[56:59]
    ds_read_b128 v[232:235], v12 offset:10240
    v_mfma_f32_16x16x32_bf16 v[60:63], v[244:247], v[152:155], v[60:63]
    ds_read_b128 v[236:239], v12 offset:11264
    v_mfma_f32_16x16x32_bf16 v[64:67], v[248:251], v[152:155], v[64:67]
    ds_read_b128 v[240:243], v12 offset:12288
    v_mfma_f32_16x16x32_bf16 v[68:71], v[252:255], v[152:155], v[68:71]
    ds_read_b128 v[244:247], v12 offset:13312
    v_mfma_f32_16x16x32_bf16 v[72:75], v[192:195], v[152:155], v[72:75]
    ds_read_b128 v[248:251], v12 offset:14336
    v_mfma_f32_16x16x32_bf16 v[76:79], v[196:199], v[152:155], v[76:79]
    ds_read_b128 v[252:255], v12 offset:15360
    s_waitcnt lgkmcnt(8)
    v_mfma_f32_16x16x32_bf16 v[56:59], v[200:203], v[156:159], v[56:59]
    ds_read_b128 v[192:195], v12 offset:16384
    v_mfma_f32_16x16x32_bf16 v[60:63], v[204:207], v[156:159], v[60:63]
    ds_read_b128 v[196:199], v12 offset:17408
    v_mfma_f32_16x16x32_bf16 v[64:67], v[208:211], v[156:159], v[64:67]
    ds_read_b128 v[200:203], v12 offset:18432
    v_mfma_f32_16x16x32_bf16 v[68:71], v[212:215], v[156:159], v[68:71]
    ds_read_b128 v[204:207], v12 offset:19456
    v_mfma_f32_16x16x32_bf16 v[72:75], v[216:219], v[156:159], v[72:75]
    ds_read_b128 v[208:211], v12 offset:20480
    v_mfma_f32_16x16x32_bf16 v[76:79], v[220:223], v[156:159], v[76:79]
    ds_read_b128 v[212:215], v12 offset:21504
    s_waitcnt lgkmcnt(8)
    v_mfma_f32_16x16x32_bf16 v[56:59], v[224:227], v[160:163], v[56:59]
    ds_read_b128 v[216:219], v12 offset:22528
    v_mfma_f32_16x16x32_bf16 v[60:63], v[228:231], v[160:163], v[60:63]
    ds_read_b128 v[220:223], v12 offset:23552
    v_mfma_f32_16x16x32_bf16 v[64:67], v[232:235], v[160:163], v[64:67]
    ds_read_b128 v[224:227], v12 offset:24576
    v_mfma_f32_16x16x32_bf16 v[68:71], v[236:239], v[160:163], v[68:71]
    ds_read_b128 v[228:231], v12 offset:25600
    v_mfma_f32_16x16x32_bf16 v[72:75], v[240:243], v[160:163], v[72:75]
    ds_read_b128 v[232:235], v12 offset:26624
    v_mfma_f32_16x16x32_bf16 v[76:79], v[244:247], v[160:163], v[76:79]
    ds_read_b128 v[236:239], v12 offset:27648
    s_waitcnt lgkmcnt(8)
    v_mfma_f32_16x16x32_bf16 v[56:59], v[248:251], v[164:167], v[56:59]
    ds_read_b128 v[240:243], v12 offset:28672
    v_mfma_f32_16x16x32_bf16 v[60:63], v[252:255], v[164:167], v[60:63]
    ds_read_b128 v[244:247], v12 offset:29696
    v_mfma_f32_16x16x32_bf16 v[64:67], v[192:195], v[164:167], v[64:67]
    ds_read_b128 v[248:251], v12 offset:30720
    v_mfma_f32_16x16x32_bf16 v[68:71], v[196:199], v[164:167], v[68:71]
    ds_read_b128 v[252:255], v12 offset:31744
    v_mfma_f32_16x16x32_bf16 v[72:75], v[200:203], v[164:167], v[72:75]
    ds_read_b128 v[192:195], v12 offset:32768
    v_mfma_f32_16x16x32_bf16 v[76:79], v[204:207], v[164:167], v[76:79]
    ds_read_b128 v[196:199], v12 offset:33792
    s_waitcnt lgkmcnt(8)
    v_mfma_f32_16x16x32_bf16 v[56:59], v[208:211], v[168:171], v[56:59]
    ds_read_b128 v[200:203], v12 offset:34816
    v_mfma_f32_16x16x32_bf16 v[60:63], v[212:215], v[168:171], v[60:63]
    ds_read_b128 v[204:207], v12 offset:35840
    s_waitcnt vmcnt(1)
    v_mov_b32 v6, s83
    s_mov_b64 exec, 1
    buffer_store_dword v6, off, s[28:31], s44 sc1
    s_mov_b64 exec, -1
    v_mfma_f32_16x16x32_bf16 v[64:67], v[216:219], v[168:171], v[64:67]
    ds_read_b128 v[208:211], v12 offset:36864
    v_mfma_f32_16x16x32_bf16 v[68:71], v[220:223], v[168:171], v[68:71]
    ds_read_b128 v[212:215], v12 offset:37888
    v_mfma_f32_16x16x32_bf16 v[72:75], v[224:227], v[168:171], v[72:75]
    ds_read_b128 v[216:219], v12 offset:38912
    v_mfma_f32_16x16x32_bf16 v[76:79], v[228:231], v[168:171], v[76:79]
    ds_read_b128 v[220:223], v12 offset:39936
    s_waitcnt lgkmcnt(8)
    v_mfma_f32_16x16x32_bf16 v[56:59], v[232:235], v[172:175], v[56:59]
    ds_read_b128 v[224:227], v12 offset:40960
    v_mfma_f32_16x16x32_bf16 v[60:63], v[236:239], v[172:175], v[60:63]
    ds_read_b128 v[228:231], v12 offset:41984
    v_mfma_f32_16x16x32_bf16 v[64:67], v[240:243], v[172:175], v[64:67]
    ds_read_b128 v[232:235], v12 offset:43008
    v_mfma_f32_16x16x32_bf16 v[68:71], v[244:247], v[172:175], v[68:71]
    ds_read_b128 v[236:239], v12 offset:44032
    v_mfma_f32_16x16x32_bf16 v[72:75], v[248:251], v[172:175], v[72:75]
    ds_read_b128 v[240:243], v12 offset:45056
    v_mfma_f32_16x16x32_bf16 v[76:79], v[252:255], v[172:175], v[76:79]
    ds_read_b128 v[244:247], v12 offset:46080
    s_waitcnt lgkmcnt(8)
    v_mfma_f32_16x16x32_bf16 v[56:59], v[192:195], v[176:179], v[56:59]
    ds_read_b128 v[248:251], v12 offset:47104
    v_mfma_f32_16x16x32_bf16 v[60:63], v[196:199], v[176:179], v[60:63]
    ds_read_b128 v[252:255], v12 offset:48128
    v_mfma_f32_16x16x32_bf16 v[64:67], v[200:203], v[176:179], v[64:67]
    ds_read_b128 v[192:195], v12 offset:49152
    v_mfma_f32_16x16x32_bf16 v[68:71], v[204:207], v[176:179], v[68:71]
    ds_read_b128 v[196:199], v12 offset:50176
    v_mfma_f32_16x16x32_bf16 v[72:75], v[208:211], v[176:179], v[72:75]
    ds_read_b128 v[200:203], v12 offset:51200
    v_mfma_f32_16x16x32_bf16 v[76:79], v[212:215], v[176:179], v[76:79]
    ds_read_b128 v[204:207], v12 offset:52224
    s_waitcnt lgkmcnt(8)
    v_mfma_f32_16x16x32_bf16 v[56:59], v[216:219], v[180:183], v[56:59]
    ds_read_b128 v[208:211], v12 offset:53248
    v_mfma_f32_16x16x32_bf16 v[60:63], v[220:223], v[180:183], v[60:63]
    ds_read_b128 v[212:215], v12 offset:54272
    v_mfma_f32_16x16x32_bf16 v[64:67], v[224:227], v[180:183], v[64:67]
    ds_read_b128 v[216:219], v12 offset:55296
    v_mfma_f32_16x16x32_bf16 v[68:71], v[228:231], v[180:183], v[68:71]
    ds_read_b128 v[220:223], v12 offset:56320
    v_mfma_f32_16x16x32_bf16 v[72:75], v[232:235], v[180:183], v[72:75]
    v_mfma_f32_16x16x32_bf16 v[76:79], v[236:239], v[180:183], v[76:79]
    s_waitcnt lgkmcnt(6)
    v_mfma_f32_16x16x32_bf16 v[56:59], v[240:243], v[184:187], v[56:59]
    v_mfma_f32_16x16x32_bf16 v[60:63], v[244:247], v[184:187], v[60:63]
    v_mfma_f32_16x16x32_bf16 v[64:67], v[248:251], v[184:187], v[64:67]
    v_mfma_f32_16x16x32_bf16 v[68:71], v[252:255], v[184:187], v[68:71]
    v_mfma_f32_16x16x32_bf16 v[72:75], v[192:195], v[184:187], v[72:75]
    v_mfma_f32_16x16x32_bf16 v[76:79], v[196:199], v[184:187], v[76:79]
    s_waitcnt lgkmcnt(0)
    v_mfma_f32_16x16x32_bf16 v[56:59], v[200:203], v[188:191], v[56:59]
    v_mfma_f32_16x16x32_bf16 v[60:63], v[204:207], v[188:191], v[60:63]
    v_mfma_f32_16x16x32_bf16 v[64:67], v[208:211], v[188:191], v[64:67]
    v_mfma_f32_16x16x32_bf16 v[68:71], v[212:215], v[188:191], v[68:71]
    v_mfma_f32_16x16x32_bf16 v[72:75], v[216:219], v[188:191], v[72:75]
    v_mfma_f32_16x16x32_bf16 v[76:79], v[220:223], v[188:191], v[76:79]
    ds_read_b128 a[136:139], v26 offset:2048
    ds_read_b128 a[140:143], v27 offset:2048
    s_add_u32 m0, s66, 0
    s_nop 0
    buffer_load_dwordx4 v24, s[20:23], s100 offen lds
    buffer_load_dwordx4 v25, s[20:23], s100 offen offset:1024 lds
    s_add_u32 s100, s100, 128
    ds_read_b128 a[144:147], v26 offset:4096
    ds_read_b128 a[148:151], v27 offset:4096
    s_waitcnt lgkmcnt(2)
    s_add_u32 m0, s66, 2048
    s_nop 0
    buffer_load_dwordx4 v24, s[20:23], s100 offen lds
    buffer_load_dwordx4 v25, s[20:23], s100 offen offset:1024 lds
    s_add_u32 s100, s100, 128
    ds_read_b128 a[152:155], v26 offset:6144
    ds_read_b128 a[156:159], v27 offset:6144
    s_waitcnt lgkmcnt(2)
    s_add_u32 m0, s66, 4096
    s_nop 0
    buffer_load_dwordx4 v24, s[20:23], s100 offen lds
    buffer_load_dwordx4 v25, s[20:23], s100 offen offset:1024 lds
    s_add_u32 s100, s100, 128
    s_waitcnt vmcnt(4)
    ds_read_b128 a[160:163], v26 offset:0
    ds_read_b128 a[164:167], v27 offset:0
    s_waitcnt lgkmcnt(2)
    s_add_u32 m0, s66, 6144
    s_nop 0
    buffer_load_dwordx4 v24, s[20:23], s100 offen lds
    buffer_load_dwordx4 v25, s[20:23], s100 offen offset:1024 lds
    s_waitcnt vmcnt(4)
    ds_read_b128 a[168:171], v26 offset:2048
    ds_read_b128 a[172:175], v27 offset:2048
    s_waitcnt lgkmcnt(2)
    s_mov_b32 s100, s63
    s_add_u32 m0, s66, 0
    s_nop 0
    buffer_load_dwordx4 v24, s[20:23], s100 offen lds
    buffer_load_dwordx4 v25, s[20:23], s100 offen offset:1024 lds
    s_add_u32 s100, s100, 128
    s_waitcnt vmcnt(4)
    ds_read_b128 a[176:179], v26 offset:4096
    ds_read_b128 a[180:183], v27 offset:4096
    s_waitcnt lgkmcnt(2)
    s_add_u32 m0, s66, 2048
    s_nop 0
    buffer_load_dwordx4 v24, s[20:23], s100 offen lds
    buffer_load_dwordx4 v25, s[20:23], s100 offen offset:1024 lds
    s_add_u32 s100, s100, 128
    s_waitcnt vmcnt(4)
    ds_read_b128 a[184:187], v26 offset:6144
    ds_read_b128 a[188:191], v27 offset:6144
    s_waitcnt lgkmcnt(2)
    s_add_u32 m0, s66, 4096
    s_nop 0
    buffer_load_dwordx4 v24, s[20:23], s100 offen lds
    buffer_load_dwordx4 v25, s[20:23], s100 offen offset:1024 lds
    s_add_u32 s100, s100, 128
    s_waitcnt vmcnt(4)
    ds_read_b128 a[64:67], v26 offset:0
    ds_read_b128 a[68:71], v27 offset:0
    s_waitcnt lgkmcnt(2)
    s_add_u32 m0, s66, 6144
    s_nop 0
    buffer_load_dwordx4 v24, s[20:23], s100 offen lds
    buffer_load_dwordx4 v25, s[20:23], s100 offen offset:1024 lds
    s_add_u32 s100, s100, 128
    s_waitcnt vmcnt(4)
    ds_read_b128 a[72:75], v26 offset:2048
    ds_read_b128 a[76:79], v27 offset:2048
    s_waitcnt lgkmcnt(2)
    s_add_u32 m0, s66, 0
    s_nop 0
    buffer_load_dwordx4 v24, s[20:23], s100 offen lds
    buffer_load_dwordx4 v25, s[20:23], s100 offen offset:1024 lds
    s_add_u32 s100, s100, 128
    s_waitcnt vmcnt(4)
    ds_read_b128 a[80:83], v26 offset:4096
    ds_read_b128 a[84:87], v27 offset:4096
    s_waitcnt lgkmcnt(2)
    s_add_u32 m0, s66, 2048
    s_nop 0
    buffer_load_dwordx4 v24, s[20:23], s100 offen lds
    buffer_load_dwordx4 v25, s[20:23], s100 offen offset:1024 lds
    s_add_u32 s100, s100, 128
    s_waitcnt vmcnt(4)
    ds_read_b128 a[88:91], v26 offset:6144
    ds_read_b128 a[92:95], v27 offset:6144
    s_waitcnt lgkmcnt(2)
    s_add_u32 m0, s66, 4096
    s_nop 0
    buffer_load_dwordx4 v24, s[20:23], s100 offen lds
    buffer_load_dwordx4 v25, s[20:23], s100 offen offset:1024 lds
    s_add_u32 s100, s100, 128
    s_waitcnt vmcnt(4)
    ds_read_b128 a[96:99], v26 offset:0
    ds_read_b128 a[100:103], v27 offset:0
    s_waitcnt lgkmcnt(2)
    s_add_u32 m0, s66, 6144
    s_nop 0
    buffer_load_dwordx4 v24, s[20:23], s100 offen lds
    buffer_load_dwordx4 v25, s[20:23], s100 offen offset:1024 lds
    s_waitcnt vmcnt(4)
    ds_read_b128 a[104:107], v26 offset:2048
    ds_read_b128 a[108:111], v27 offset:2048
    s_waitcnt lgkmcnt(2)
    s_mov_b32 s100, s64
    s_add_u32 m0, s66, 0
    s_nop 0
    buffer_load_dwordx4 v24, s[20:23], s100 offen lds
    buffer_load_dwordx4 v25, s[20:23], s100 offen offset:1024 lds
    s_add_u32 s100, s100, 128
    s_waitcnt vmcnt(4)
    ds_read_b128 a[112:115], v26 offset:4096
    ds_read_b128 a[116:119], v27 offset:4096
    s_waitcnt lgkmcnt(2)
    s_add_u32 m0, s66, 2048
    s_nop 0
    buffer_load_dwordx4 v24, s[20:23], s100 offen lds
    buffer_load_dwordx4 v25, s[20:23], s100 offen offset:1024 lds
    s_add_u32 s100, s100, 128
    s_waitcnt vmcnt(4)
    ds_read_b128 a[120:123], v26 offset:6144
    ds_read_b128 a[124:127], v27 offset:6144
    s_waitcnt lgkmcnt(2)
    s_add_u32 m0, s66, 4096
    s_nop 0
    buffer_load_dwordx4 v24, s[20:23], s100 offen lds
    buffer_load_dwordx4 v25, s[20:23], s100 offen offset:1024 lds
    s_add_u32 s100, s100, 128
    s_waitcnt vmcnt(4)
    ds_read_b128 a[0:3], v26 offset:0
    ds_read_b128 a[4:7], v27 offset:0
    s_waitcnt lgkmcnt(2)
    s_add_u32 m0, s66, 6144
    s_nop 0
    buffer_load_dwordx4 v24, s[20:23], s100 offen lds
    buffer_load_dwordx4 v25, s[20:23], s100 offen offset:1024 lds
    s_add_u32 s100, s100, 128
    s_waitcnt vmcnt(4)
    ds_read_b128 a[8:11], v26 offset:2048
    ds_read_b128 a[12:15], v27 offset:2048
    s_waitcnt lgkmcnt(2)
    s_add_u32 m0, s66, 0
    s_nop 0
    buffer_load_dwordx4 v24, s[20:23], s100 offen lds
    buffer_load_dwordx4 v25, s[20:23], s100 offen offset:1024 lds
    s_add_u32 s100, s100, 128
    s_waitcnt vmcnt(4)
    ds_read_b128 a[16:19], v26 offset:4096
    ds_read_b128 a[20:23], v27 offset:4096
    s_waitcnt lgkmcnt(2)
    s_add_u32 m0, s66, 2048
    s_nop 0
    buffer_load_dwordx4 v24, s[20:23], s100 offen lds
    buffer_load_dwordx4 v25, s[20:23], s100 offen offset:1024 lds
    s_add_u32 s100, s100, 128
    s_waitcnt vmcnt(4)
    ds_read_b128 a[24:27], v26 offset:6144
    ds_read_b128 a[28:31], v27 offset:6144
    s_waitcnt lgkmcnt(2)
    s_add_u32 m0, s66, 4096
    s_nop 0
    buffer_load_dwordx4 v24, s[20:23], s100 offen lds
    buffer_load_dwordx4 v25, s[20:23], s100 offen offset:1024 lds
    s_add_u32 s100, s100, 128
    s_waitcnt vmcnt(4)
    ds_read_b128 a[32:35], v26 offset:0
    ds_read_b128 a[36:39], v27 offset:0
    s_waitcnt lgkmcnt(2)
    s_add_u32 m0, s66, 6144
    s_nop 0
    buffer_load_dwordx4 v24, s[20:23], s100 offen lds
    buffer_load_dwordx4 v25, s[20:23], s100 offen offset:1024 lds
    s_waitcnt vmcnt(4)
    ds_read_b128 a[40:43], v26 offset:2048
    ds_read_b128 a[44:47], v27 offset:2048
    s_waitcnt vmcnt(2)
    ds_read_b128 a[48:51], v26 offset:4096
    ds_read_b128 a[52:55], v27 offset:4096
    s_waitcnt vmcnt(0)
    ds_read_b128 a[56:59], v26 offset:6144
    ds_read_b128 a[60:63], v27 offset:6144
    buffer_load_dword v6, v19, s[28:31], s45 offen sc1
    s_waitcnt lgkmcnt(0)
    global_load_dwordx4 v[24:27], v5, s[74:75]
    s_add_u32 s74, s74, 4096
    s_addc_u32 s75, s75, 0
    s_waitcnt lgkmcnt(0)
    s_barrier
    s_waitcnt vmcnt(1)
    v_cmp_ne_u32 vcc, s83, v6
    s_nop 0
    s_cmp_lg_u64 vcc, 0
    s_cbranch_scc1 L_retry_51
L_ok_52:
    s_mov_b32 s88, 0xbdd2d3e8
    v_mov_b32 v10, 0xc0135761
    buffer_load_dwordx4 v[80:83], v5, s[28:31], s46 offen offset:0 sc1
    buffer_load_dwordx4 v[84:87], v5, s[28:31], s46 offen offset:1024 sc1
    buffer_load_dwordx4 v[88:91], v5, s[28:31], s46 offen offset:2048 sc1
    buffer_load_dwordx4 v[92:95], v5, s[28:31], s46 offen offset:3072 sc1
    s_add_u32 s46, s46, 4096
    buffer_load_dwordx4 v[96:99], v5, s[28:31], s46 offen offset:0 sc1
    buffer_load_dwordx4 v[100:103], v5, s[28:31], s46 offen offset:1024 sc1
    buffer_load_dwordx4 v[104:107], v5, s[28:31], s46 offen offset:2048 sc1
    buffer_load_dwordx4 v[108:111], v5, s[28:31], s46 offen offset:3072 sc1
    s_add_u32 s46, s46, 4096
    buffer_load_dwordx4 v[112:115], v5, s[28:31], s46 offen offset:0 sc1
    buffer_load_dwordx4 v[116:119], v5, s[28:31], s46 offen offset:1024 sc1
    buffer_load_dwordx4 v[120:123], v5, s[28:31], s46 offen offset:2048 sc1
    buffer_load_dwordx4 v[124:127], v5, s[28:31], s46 offen offset:3072 sc1
    s_add_u32 s46, s46, 4096
    s_waitcnt vmcnt(11)
    v_mfma_f32_16x16x32_bf16 v[160:163], v[80:83], a[0:3], 0
    buffer_load_dwordx4 v[128:131], v5, s[28:31], s46 offen offset:0 sc1
    v_mfma_f32_16x16x32_bf16 v[164:167], v[80:83], a[64:67], 0
    v_mul_f32 v8, v56, v56
    v_mul_f32 v9, v57, v57
    v_mfma_f32_16x16x32_bf16 v[168:171], v[80:83], a[128:131], 0
    buffer_load_dwordx4 v[132:135], v5, s[28:31], s46 offen offset:1024 sc1
    v_mfma_f32_16x16x32_bf16 v[172:175], v[80:83], a[192:195], 0
    v_fma_f32 v8, v8, s88, v10
    s_waitcnt vmcnt(12)
    v_mfma_f32_16x16x32_bf16 v[176:179], v[84:87], a[0:3], 0
    buffer_load_dwordx4 v[136:139], v5, s[28:31], s46 offen offset:2048 sc1
    v_mfma_f32_16x16x32_bf16 v[180:183], v[84:87], a[64:67], 0
    v_fma_f32 v9, v9, s88, v10
    v_mul_f32 v8, v8, v56
    v_mfma_f32_16x16x32_bf16 v[184:187], v[84:87], a[128:131], 0
    buffer_load_dwordx4 v[140:143], v5, s[28:31], s46 offen offset:3072 sc1
    s_add_u32 s46, s46, 4096
    v_mfma_f32_16x16x32_bf16 v[188:191], v[84:87], a[192:195], 0
    v_mul_f32 v9, v9, v57
    s_waitcnt vmcnt(13)
    v_mfma_f32_16x16x32_bf16 v[192:195], v[88:91], a[0:3], 0
    buffer_load_dwordx4 v[144:147], v5, s[28:31], s46 offen offset:0 sc1
    v_mfma_f32_16x16x32_bf16 v[196:199], v[88:91], a[64:67], 0
    v_exp_f32 v8, v8
    v_mfma_f32_16x16x32_bf16 v[200:203], v[88:91], a[128:131], 0
    buffer_load_dwordx4 v[148:151], v5, s[28:31], s46 offen offset:1024 sc1
    v_mfma_f32_16x16x32_bf16 v[204:207], v[88:91], a[192:195], 0
    s_waitcnt vmcnt(14)
    v_mfma_f32_16x16x32_bf16 v[208:211], v[92:95], a[0:3], 0
    buffer_load_dwordx4 v[152:155], v5, s[28:31], s46 offen offset:2048 sc1
    v_mfma_f32_16x16x32_bf16 v[212:215], v[92:95], a[64:67], 0
    v_exp_f32 v9, v9
    v_mfma_f32_16x16x32_bf16 v[216:219], v[92:95], a[128:131], 0
    buffer_load_dwordx4 v[156:159], v5, s[28:31], s46 offen offset:3072 sc1
    s_add_u32 s46, s46, 4096
    v_mfma_f32_16x16x32_bf16 v[220:223], v[92:95], a[192:195], 0
    v_add_f32 v8, 1.0, v8
    s_waitcnt vmcnt(15)
    v_mfma_f32_16x16x32_bf16 v[224:227], v[96:99], a[0:3], 0
    buffer_load_dwordx4 v[80:83], v5, s[28:31], s46 offen offset:0 sc1
    v_mfma_f32_16x16x32_bf16 v[228:231], v[96:99], a[64:67], 0
    v_add_f32 v9, 1.0, v9
    v_mfma_f32_16x16x32_bf16 v[232:235], v[96:99], a[128:131], 0
    buffer_load_dwordx4 v[84:87], v5, s[28:31], s46 offen offset:1024 sc1
    v_mfma_f32_16x16x32_bf16 v[236:239], v[96:99], a[192:195], 0
    s_waitcnt vmcnt(16)
    v_mfma_f32_16x16x32_bf16 v[240:243], v[100:103], a[0:3], 0
    buffer_load_dwordx4 v[88:91], v5, s[28:31], s46 offen offset:2048 sc1
    v_mfma_f32_16x16x32_bf16 v[244:247], v[100:103], a[64:67], 0
    v_rcp_f32 v8, v8
    v_mfma_f32_16x16x32_bf16 v[248:251], v[100:103], a[128:131], 0
    buffer_load_dwordx4 v[92:95], v5, s[28:31], s46 offen offset:3072 sc1
    s_add_u32 s46, s46, 4096
    v_mfma_f32_16x16x32_bf16 v[252:255], v[100:103], a[192:195], 0
    s_waitcnt vmcnt(17)
    v_mfma_f32_16x16x32_bf16 v[160:163], v[104:107], a[4:7], v[160:163]
    buffer_load_dwordx4 v[96:99], v5, s[28:31], s46 offen offset:0 sc1
    v_mfma_f32_16x16x32_bf16 v[164:167], v[104:107], a[68:71], v[164:167]
    v_rcp_f32 v9, v9
    v_mfma_f32_16x16x32_bf16 v[168:171], v[104:107], a[132:135], v[168:171]
    v_mul_f32 v56, v56, v8
    v_mul_f32 v57, v57, v9
    v_mfma_f32_16x16x32_bf16 v[172:175], v[104:107], a[196:199], v[172:175]
    v_mul_f32 v8, v58, v58
    s_waitcnt vmcnt(17)
    v_mfma_f32_16x16x32_bf16 v[176:179], v[108:111], a[4:7], v[176:179]
    buffer_load_dwordx4 v[100:103], v5, s[28:31], s46 offen offset:1024 sc1
    v_mfma_f32_16x16x32_bf16 v[180:183], v[108:111], a[68:71], v[180:183]
    v_mul_f32 v9, v59, v59
    v_fma_f32 v8, v8, s88, v10
    v_mfma_f32_16x16x32_bf16 v[184:187], v[108:111], a[132:135], v[184:187]
    v_fma_f32 v9, v9, s88, v10
    v_mul_f32 v8, v8, v58
    v_mfma_f32_16x16x32_bf16 v[188:191], v[108:111], a[196:199], v[188:191]
    v_mul_f32 v9, v9, v59
    s_waitcnt vmcnt(17)
    v_mfma_f32_16x16x32_bf16 v[192:195], v[112:115], a[4:7], v[192:195]
    buffer_load_dwordx4 v[104:107], v5, s[28:31], s46 offen offset:2048 sc1
    v_mfma_f32_16x16x32_bf16 v[196:199], v[112:115], a[68:71], v[196:199]
    v_exp_f32 v8, v8
    v_mfma_f32_16x16x32_bf16 v[200:203], v[112:115], a[132:135], v[200:203]
    v_exp_f32 v9, v9
    v_mfma_f32_16x16x32_bf16 v[204:207], v[112:115], a[196:199], v[204:207]
    v_add_f32 v8, 1.0, v8
    s_waitcnt vmcnt(17)
    v_mfma_f32_16x16x32_bf16 v[208:211], v[116:119], a[4:7], v[208:211]
    buffer_load_dwordx4 v[108:111], v5, s[28:31], s46 offen offset:3072 sc1
    s_add_u32 s46, s46, 4096
    v_mfma_f32_16x16x32_bf16 v[212:215], v[116:119], a[68:71], v[212:215]
    v_add_f32 v9, 1.0, v9
    v_mfma_f32_16x16x32_bf16 v[216:219], v[116:119], a[132:135], v[216:219]
    v_rcp_f32 v8, v8
    v_mfma_f32_16x16x32_bf16 v[220:223], v[116:119], a[196:199], v[220:223]
    s_waitcnt vmcnt(17)
    v_mfma_f32_16x16x32_bf16 v[224:227], v[120:123], a[4:7], v[224:227]
    buffer_load_dwordx4 v[112:115], v5, s[28:31], s46 offen offset:0 sc1
    v_mfma_f32_16x16x32_bf16 v[228:231], v[120:123], a[68:71], v[228:231]
    v_rcp_f32 v9, v9
    v_mfma_f32_16x16x32_bf16 v[232:235], v[120:123], a[132:135], v[232:235]
    v_mul_f32 v58, v58, v8
    v_mul_f32 v59, v59, v9
    v_mfma_f32_16x16x32_bf16 v[236:239], v[120:123], a[196:199], v[236:239]
    v_mul_f32 v8, v60, v60
    s_waitcnt vmcnt(17)
    v_mfma_f32_16x16x32_bf16 v[240:243], v[124:127], a[4:7], v[240:243]
    buffer_load_dwordx4 v[116:119], v5, s[28:31], s46 offen offset:1024 sc1
    v_mfma_f32_16x16x32_bf16 v[244:247], v[124:127], a[68:71], v[244:247]
    v_mul_f32 v9, v61, v61
    v_fma_f32 v8, v8, s88, v10
    v_mfma_f32_16x16x32_bf16 v[248:251], v[124:127], a[132:135], v[248:251]
    v_fma_f32 v9, v9, s88, v10
    v_mul_f32 v8, v8, v60
    v_mfma_f32_16x16x32_bf16 v[252:255], v[124:127], a[196:199], v[252:255]
    v_mul_f32 v9, v9, v61
    s_waitcnt vmcnt(17)
    v_mfma_f32_16x16x32_bf16 v[160:163], v[128:131], a[8:11], v[160:163]
    buffer_load_dwordx4 v[120:123], v5, s[28:31], s46 offen offset:2048 sc1
    v_mfma_f32_16x16x32_bf16 v[164:167], v[128:131], a[72:75], v[164:167]
    v_exp_f32 v8, v8
    v_mfma_f32_16x16x32_bf16 v[168:171], v[128:131], a[136:139], v[168:171]
    v_exp_f32 v9, v9
    v_mfma_f32_16x16x32_bf16 v[172:175], v[128:131], a[200:203], v[172:175]
    v_add_f32 v8, 1.0, v8
    s_waitcnt vmcnt(17)
    v_mfma_f32_16x16x32_bf16 v[176:179], v[132:135], a[8:11], v[176:179]
    buffer_load_dwordx4 v[124:127], v5, s[28:31], s46 offen offset:3072 sc1
    s_add_u32 s46, s46, 4096
    v_mfma_f32_16x16x32_bf16 v[180:183], v[132:135], a[72:75], v[180:183]
    v_add_f32 v9, 1.0, v9
    v_mfma_f32_16x16x32_bf16 v[184:187], v[132:135], a[136:139], v[184:187]
    v_rcp_f32 v8, v8
    v_mfma_f32_16x16x32_bf16 v[188:191], v[132:135], a[200:203], v[188:191]
    s_waitcnt vmcnt(17)
    v_mfma_f32_16x16x32_bf16 v[192:195], v[136:139], a[8:11], v[192:195]
    buffer_load_dwordx4 v[128:131], v5, s[28:31], s46 offen offset:0 sc1
    v_mfma_f32_16x16x32_bf16 v[196:199], v[136:139], a[72:75], v[196:199]
    v_rcp_f32 v9, v9
    v_mfma_f32_16x16x32_bf16 v[200:203], v[136:139], a[136:139], v[200:203]
    v_mul_f32 v60, v60, v8
    v_mul_f32 v61, v61, v9
    v_mfma_f32_16x16x32_bf16 v[204:207], v[136:139], a[200:203], v[204:207]
    v_mul_f32 v8, v62, v62
    s_waitcnt vmcnt(17)
    v_mfma_f32_16x16x32_bf16 v[208:211], v[140:143], a[8:11], v[208:211]
    buffer_load_dwordx4 v[132:135], v5, s[28:31], s46 offen offset:1024 sc1
    v_mfma_f32_16x16x32_bf16 v[212:215], v[140:143], a[72:75], v[212:215]
    v_mul_f32 v9, v63, v63
    v_fma_f32 v8, v8, s88, v10
    v_mfma_f32_16x16x32_bf16 v[216:219], v[140:143], a[136:139], v[216:219]
    v_fma_f32 v9, v9, s88, v10
    v_mul_f32 v8, v8, v62
    v_mfma_f32_16x16x32_bf16 v[220:223], v[140:143], a[200:203], v[220:223]
    v_mul_f32 v9, v9, v63
    s_waitcnt vmcnt(17)
    v_mfma_f32_16x16x32_bf16 v[224:227], v[144:147], a[8:11], v[224:227]
    buffer_load_dwordx4 v[136:139], v5, s[28:31], s46 offen offset:2048 sc1
    v_mfma_f32_16x16x32_bf16 v[228:231], v[144:147], a[72:75], v[228:231]
    v_exp_f32 v8, v8
    v_mfma_f32_16x16x32_bf16 v[232:235], v[144:147], a[136:139], v[232:235]
    v_exp_f32 v9, v9
    v_mfma_f32_16x16x32_bf16 v[236:239], v[144:147], a[200:203], v[236:239]
    v_add_f32 v8, 1.0, v8
    s_waitcnt vmcnt(17)
    v_mfma_f32_16x16x32_bf16 v[240:243], v[148:151], a[8:11], v[240:243]
    buffer_load_dwordx4 v[140:143], v5, s[28:31], s46 offen offset:3072 sc1
    s_add_u32 s46, s46, 4096
    v_mfma_f32_16x16x32_bf16 v[244:247], v[148:151], a[72:75], v[244:247]
    v_add_f32 v9, 1.0, v9
    v_mfma_f32_16x16x32_bf16 v[248:251], v[148:151], a[136:139], v[248:251]
    v_rcp_f32 v8, v8
    v_mfma_f32_16x16x32_bf16 v[252:255], v[148:151], a[200:203], v[252:255]
    s_waitcnt vmcnt(17)
    v_mfma_f32_16x16x32_bf16 v[160:163], v[152:155], a[12:15], v[160:163]
    buffer_load_dwordx4 v[144:147], v5, s[28:31], s46 offen offset:0 sc1
    v_mfma_f32_16x16x32_bf16 v[164:167], v[152:155], a[76:79], v[164:167]
    v_rcp_f32 v9, v9
    v_mfma_f32_16x16x32_bf16 v[168:171], v[152:155], a[140:143], v[168:171]
    v_mul_f32 v62, v62, v8
    v_mul_f32 v63, v63, v9
    v_mfma_f32_16x16x32_bf16 v[172:175], v[152:155], a[204:207], v[172:175]
    v_mul_f32 v8, v64, v64
    s_waitcnt vmcnt(17)
    v_mfma_f32_16x16x32_bf16 v[176:179], v[156:159], a[12:15], v[176:179]
    buffer_load_dwordx4 v[148:151], v5, s[28:31], s46 offen offset:1024 sc1
    v_mfma_f32_16x16x32_bf16 v[180:183], v[156:159], a[76:79], v[180:183]
    v_mul_f32 v9, v65, v65
    v_fma_f32 v8, v8, s88, v10
    v_mfma_f32_16x16x32_bf16 v[184:187], v[156:159], a[140:143], v[184:187]
    v_fma_f32 v9, v9, s88, v10
    v_mul_f32 v8, v8, v64
    v_mfma_f32_16x16x32_bf16 v[188:191], v[156:159], a[204:207], v[188:191]
    v_mul_f32 v9, v9, v65
    s_waitcnt vmcnt(17)
    v_mfma_f32_16x16x32_bf16 v[192:195], v[80:83], a[12:15], v[192:195]
    buffer_load_dwordx4 v[152:155], v5, s[28:31], s46 offen offset:2048 sc1
    v_mfma_f32_16x16x32_bf16 v[196:199], v[80:83], a[76:79], v[196:199]
    v_exp_f32 v8, v8
    v_mfma_f32_16x16x32_bf16 v[200:203], v[80:83], a[140:143], v[200:203]
    v_exp_f32 v9, v9
    v_mfma_f32_16x16x32_bf16 v[204:207], v[80:83], a[204:207], v[204:207]
    v_add_f32 v8, 1.0, v8
    s_waitcnt vmcnt(17)
    v_mfma_f32_16x16x32_bf16 v[208:211], v[84:87], a[12:15], v[208:211]
    buffer_load_dwordx4 v[156:159], v5, s[28:31], s46 offen offset:3072 sc1
    s_add_u32 s46, s46, 4096
    v_mfma_f32_16x16x32_bf16 v[212:215], v[84:87], a[76:79], v[212:215]
    v_add_f32 v9, 1.0, v9
    v_mfma_f32_16x16x32_bf16 v[216:219], v[84:87], a[140:143], v[216:219]
    v_rcp_f32 v8, v8
    v_mfma_f32_16x16x32_bf16 v[220:223], v[84:87], a[204:207], v[220:223]
    s_waitcnt vmcnt(17)
    v_mfma_f32_16x16x32_bf16 v[224:227], v[88:91], a[12:15], v[224:227]
    buffer_load_dwordx4 v[80:83], v5, s[28:31], s46 offen offset:0 sc1
    v_mfma_f32_16x16x32_bf16 v[228:231], v[88:91], a[76:79], v[228:231]
    v_rcp_f32 v9, v9
    v_mfma_f32_16x16x32_bf16 v[232:235], v[88:91], a[140:143], v[232:235]
    v_mul_f32 v64, v64, v8
    v_mul_f32 v65, v65, v9
    v_mfma_f32_16x16x32_bf16 v[236:239], v[88:91], a[204:207], v[236:239]
    v_mul_f32 v8, v66, v66
    s_waitcnt vmcnt(17)
    v_mfma_f32_16x16x32_bf16 v[240:243], v[92:95], a[12:15], v[240:243]
    buffer_load_dwordx4 v[84:87], v5, s[28:31], s46 offen offset:1024 sc1
    v_mfma_f32_16x16x32_bf16 v[244:247], v[92:95], a[76:79], v[244:247]
    v_mul_f32 v9, v67, v67
    v_fma_f32 v8, v8, s88, v10
    v_mfma_f32_16x16x32_bf16 v[248:251], v[92:95], a[140:143], v[248:251]
    v_fma_f32 v9, v9, s88, v10
    v_mul_f32 v8, v8, v66
    v_mfma_f32_16x16x32_bf16 v[252:255], v[92:95], a[204:207], v[252:255]
    v_mul_f32 v9, v9, v67
    s_waitcnt vmcnt(17)
    v_mfma_f32_16x16x32_bf16 v[160:163], v[96:99], a[16:19], v[160:163]
    buffer_load_dwordx4 v[88:91], v5, s[28:31], s46 offen offset:2048 sc1
    v_mfma_f32_16x16x32_bf16 v[164:167], v[96:99], a[80:83], v[164:167]
    v_exp_f32 v8, v8
    v_mfma_f32_16x16x32_bf16 v[168:171], v[96:99], a[144:147], v[168:171]
    v_exp_f32 v9, v9
    v_mfma_f32_16x16x32_bf16 v[172:175], v[96:99], a[208:211], v[172:175]
    v_add_f32 v8, 1.0, v8
    s_waitcnt vmcnt(17)
    v_mfma_f32_16x16x32_bf16 v[176:179], v[100:103], a[16:19], v[176:179]
    buffer_load_dwordx4 v[92:95], v5, s[28:31], s46 offen offset:3072 sc1
    s_add_u32 s46, s46, 4096
    v_mfma_f32_16x16x32_bf16 v[180:183], v[100:103], a[80:83], v[180:183]
    v_add_f32 v9, 1.0, v9
    v_mfma_f32_16x16x32_bf16 v[184:187], v[100:103], a[144:147], v[184:187]
    v_rcp_f32 v8, v8
    v_mfma_f32_16x16x32_bf16 v[188:191], v[100:103], a[208:211], v[188:191]
    s_waitcnt vmcnt(17)
    v_mfma_f32_16x16x32_bf16 v[192:195], v[104:107], a[16:19], v[192:195]
    buffer_load_dwordx4 v[96:99], v5, s[28:31], s46 offen offset:0 sc1
    v_mfma_f32_16x16x32_bf16 v[196:199], v[104:107], a[80:83], v[196:199]
    v_rcp_f32 v9, v9
    v_mfma_f32_16x16x32_bf16 v[200:203], v[104:107], a[144:147], v[200:203]
    v_mul_f32 v66, v66, v8
    v_mul_f32 v67, v67, v9
    v_mfma_f32_16x16x32_bf16 v[204:207], v[104:107], a[208:211], v[204:207]
    v_mul_f32 v8, v68, v68
    s_waitcnt vmcnt(17)
    v_mfma_f32_16x16x32_bf16 v[208:211], v[108:111], a[16:19], v[208:211]
    buffer_load_dwordx4 v[100:103], v5, s[28:31], s46 offen offset:1024 sc1
    v_mfma_f32_16x16x32_bf16 v[212:215], v[108:111], a[80:83], v[212:215]
    v_mul_f32 v9, v69, v69
    v_fma_f32 v8, v8, s88, v10
    v_mfma_f32_16x16x32_bf16 v[216:219], v[108:111], a[144:147], v[216:219]
    v_fma_f32 v9, v9, s88, v10
    v_mul_f32 v8, v8, v68
    v_mfma_f32_16x16x32_bf16 v[220:223], v[108:111], a[208:211], v[220:223]
    v_mul_f32 v9, v9, v69
    s_waitcnt vmcnt(17)
    v_mfma_f32_16x16x32_bf16 v[224:227], v[112:115], a[16:19], v[224:227]
    buffer_load_dwordx4 v[104:107], v5, s[28:31], s46 offen offset:2048 sc1
    v_mfma_f32_16x16x32_bf16 v[228:231], v[112:115], a[80:83], v[228:231]
    v_exp_f32 v8, v8
    v_mfma_f32_16x16x32_bf16 v[232:235], v[112:115], a[144:147], v[232:235]
    v_exp_f32 v9, v9
    v_mfma_f32_16x16x32_bf16 v[236:239], v[112:115], a[208:211], v[236:239]
    v_add_f32 v8, 1.0, v8
    s_waitcnt vmcnt(17)
    v_mfma_f32_16x16x32_bf16 v[240:243], v[116:119], a[16:19], v[240:243]
    buffer_load_dwordx4 v[108:111], v5, s[28:31], s46 offen offset:3072 sc1
    s_add_u32 s46, s46, 4096
    v_mfma_f32_16x16x32_bf16 v[244:247], v[116:119], a[80:83], v[244:247]
    v_add_f32 v9, 1.0, v9
    v_mfma_f32_16x16x32_bf16 v[248:251], v[116:119], a[144:147], v[248:251]
    v_rcp_f32 v8, v8
    v_mfma_f32_16x16x32_bf16 v[252:255], v[116:119], a[208:211], v[252:255]
    s_waitcnt vmcnt(17)
    v_mfma_f32_16x16x32_bf16 v[160:163], v[120:123], a[20:23], v[160:163]
    buffer_load_dwordx4 v[112:115], v5, s[28:31], s46 offen offset:0 sc1
    v_mfma_f32_16x16x32_bf16 v[164:167], v[120:123], a[84:87], v[164:167]
    v_rcp_f32 v9, v9
    v_mfma_f32_16x16x32_bf16 v[168:171], v[120:123], a[148:151], v[168:171]
    v_mul_f32 v68, v68, v8
    v_mul_f32 v69, v69, v9
    v_mfma_f32_16x16x32_bf16 v[172:175], v[120:123], a[212:215], v[172:175]
    v_mul_f32 v8, v70, v70
    s_waitcnt vmcnt(17)
    v_mfma_f32_16x16x32_bf16 v[176:179], v[124:127], a[20:23], v[176:179]
    buffer_load_dwordx4 v[116:119], v5, s[28:31], s46 offen offset:1024 sc1
    v_mfma_f32_16x16x32_bf16 v[180:183], v[124:127], a[84:87], v[180:183]
    v_mul_f32 v9, v71, v71
    v_fma_f32 v8, v8, s88, v10
    v_mfma_f32_16x16x32_bf16 v[184:187], v[124:127], a[148:151], v[184:187]
    v_fma_f32 v9, v9, s88, v10
    v_mul_f32 v8, v8, v70
    v_mfma_f32_16x16x32_bf16 v[188:191], v[124:127], a[212:215], v[188:191]
    v_mul_f32 v9, v9, v71
    s_waitcnt vmcnt(17)
    v_mfma_f32_16x16x32_bf16 v[192:195], v[128:131], a[20:23], v[192:195]
    buffer_load_dwordx4 v[120:123], v5, s[28:31], s46 offen offset:2048 sc1
    v_mfma_f32_16x16x32_bf16 v[196:199], v[128:131], a[84:87], v[196:199]
    v_exp_f32 v8, v8
    v_mfma_f32_16x16x32_bf16 v[200:203], v[128:131], a[148:151], v[200:203]
    v_exp_f32 v9, v9
    v_mfma_f32_16x16x32_bf16 v[204:207], v[128:131], a[212:215], v[204:207]
    v_add_f32 v8, 1.0, v8
    s_waitcnt vmcnt(17)
    v_mfma_f32_16x16x32_bf16 v[208:211], v[132:135], a[20:23], v[208:211]
    buffer_load_dwordx4 v[124:127], v5, s[28:31], s46 offen offset:3072 sc1
    s_add_u32 s46, s46, 4096
    v_mfma_f32_16x16x32_bf16 v[212:215], v[132:135], a[84:87], v[212:215]
    v_add_f32 v9, 1.0, v9
    v_mfma_f32_16x16x32_bf16 v[216:219], v[132:135], a[148:151], v[216:219]
    v_rcp_f32 v8, v8
    v_mfma_f32_16x16x32_bf16 v[220:223], v[132:135], a[212:215], v[220:223]
    s_waitcnt vmcnt(17)
    v_mfma_f32_16x16x32_bf16 v[224:227], v[136:139], a[20:23], v[224:227]
    buffer_load_dwordx4 v[128:131], v5, s[28:31], s46 offen offset:0 sc1
    v_mfma_f32_16x16x32_bf16 v[228:231], v[136:139], a[84:87], v[228:231]
    v_rcp_f32 v9, v9
    v_mfma_f32_16x16x32_bf16 v[232:235], v[136:139], a[148:151], v[232:235]
    v_mul_f32 v70, v70, v8
    v_mul_f32 v71, v71, v9
    v_mfma_f32_16x16x32_bf16 v[236:239], v[136:139], a[212:215], v[236:239]
    v_mul_f32 v8, v72, v72
    s_waitcnt vmcnt(17)
    v_mfma_f32_16x16x32_bf16 v[240:243], v[140:143], a[20:23], v[240:243]
    buffer_load_dwordx4 v[132:135], v5, s[28:31], s46 offen offset:1024 sc1
    v_mfma_f32_16x16x32_bf16 v[244:247], v[140:143], a[84:87], v[244:247]
    v_mul_f32 v9, v73, v73
    v_fma_f32 v8, v8, s88, v10
    v_mfma_f32_16x16x32_bf16 v[248:251], v[140:143], a[148:151], v[248:251]
    v_fma_f32 v9, v9, s88, v10
    v_mul_f32 v8, v8, v72
    v_mfma_f32_16x16x32_bf16 v[252:255], v[140:143], a[212:215], v[252:255]
    v_mul_f32 v9, v9, v73
    s_waitcnt vmcnt(17)
    v_mfma_f32_16x16x32_bf16 v[160:163], v[144:147], a[24:27], v[160:163]
    buffer_load_dwordx4 v[136:139], v5, s[28:31], s46 offen offset:2048 sc1
    v_mfma_f32_16x16x32_bf16 v[164:167], v[144:147], a[88:91], v[164:167]
    v_exp_f32 v8, v8
    v_mfma_f32_16x16x32_bf16 v[168:171], v[144:147], a[152:155], v[168:171]
    v_exp_f32 v9, v9
    v_mfma_f32_16x16x32_bf16 v[172:175], v[144:147], a[216:219], v[172:175]
    v_add_f32 v8, 1.0, v8
    s_waitcnt vmcnt(17)
    v_mfma_f32_16x16x32_bf16 v[176:179], v[148:151], a[24:27], v[176:179]
    buffer_load_dwordx4 v[140:143], v5, s[28:31], s46 offen offset:3072 sc1
    s_add_u32 s46, s46, 4096
    v_mfma_f32_16x16x32_bf16 v[180:183], v[148:151], a[88:91], v[180:183]
    v_add_f32 v9, 1.0, v9
    v_mfma_f32_16x16x32_bf16 v[184:187], v[148:151], a[152:155], v[184:187]
    v_rcp_f32 v8, v8
    v_mfma_f32_16x16x32_bf16 v[188:191], v[148:151], a[216:219], v[188:191]
    s_waitcnt vmcnt(17)
    v_mfma_f32_16x16x32_bf16 v[192:195], v[152:155], a[24:27], v[192:195]
    buffer_load_dwordx4 v[144:147], v5, s[28:31], s46 offen offset:0 sc1
    v_mfma_f32_16x16x32_bf16 v[196:199], v[152:155], a[88:91], v[196:199]
    v_rcp_f32 v9, v9
    v_mfma_f32_16x16x32_bf16 v[200:203], v[152:155], a[152:155], v[200:203]
    v_mul_f32 v72, v72, v8
    v_mul_f32 v73, v73, v9
    v_mfma_f32_16x16x32_bf16 v[204:207], v[152:155], a[216:219], v[204:207]
    v_mul_f32 v8, v74, v74
    s_waitcnt vmcnt(17)
    v_mfma_f32_16x16x32_bf16 v[208:211], v[156:159], a[24:27], v[208:211]
    buffer_load_dwordx4 v[148:151], v5, s[28:31], s46 offen offset:1024 sc1
    v_mfma_f32_16x16x32_bf16 v[212:215], v[156:159], a[88:91], v[212:215]
    v_mul_f32 v9, v75, v75
    v_fma_f32 v8, v8, s88, v10
    v_mfma_f32_16x16x32_bf16 v[216:219], v[156:159], a[152:155], v[216:219]
    v_fma_f32 v9, v9, s88, v10
    v_mul_f32 v8, v8, v74
    v_mfma_f32_16x16x32_bf16 v[220:223], v[156:159], a[216:219], v[220:223]
    v_mul_f32 v9, v9, v75
    s_waitcnt vmcnt(17)
    v_mfma_f32_16x16x32_bf16 v[224:227], v[80:83], a[24:27], v[224:227]
    buffer_load_dwordx4 v[152:155], v5, s[28:31], s46 offen offset:2048 sc1
    v_mfma_f32_16x16x32_bf16 v[228:231], v[80:83], a[88:91], v[228:231]
    v_exp_f32 v8, v8
    v_mfma_f32_16x16x32_bf16 v[232:235], v[80:83], a[152:155], v[232:235]
    v_exp_f32 v9, v9
    v_mfma_f32_16x16x32_bf16 v[236:239], v[80:83], a[216:219], v[236:239]
    v_add_f32 v8, 1.0, v8
    s_waitcnt vmcnt(17)
    v_mfma_f32_16x16x32_bf16 v[240:243], v[84:87], a[24:27], v[240:243]
    buffer_load_dwordx4 v[156:159], v5, s[28:31], s46 offen offset:3072 sc1
    s_add_u32 s46, s46, 4096
    v_mfma_f32_16x16x32_bf16 v[244:247], v[84:87], a[88:91], v[244:247]
    v_add_f32 v9, 1.0, v9
    v_mfma_f32_16x16x32_bf16 v[248:251], v[84:87], a[152:155], v[248:251]
    v_rcp_f32 v8, v8
    v_mfma_f32_16x16x32_bf16 v[252:255], v[84:87], a[216:219], v[252:255]
    s_waitcnt vmcnt(17)
    v_mfma_f32_16x16x32_bf16 v[160:163], v[88:91], a[28:31], v[160:163]
    buffer_load_dwordx4 v[80:83], v5, s[28:31], s46 offen offset:0 sc1
    v_mfma_f32_16x16x32_bf16 v[164:167], v[88:91], a[92:95], v[164:167]
    v_rcp_f32 v9, v9
    v_mfma_f32_16x16x32_bf16 v[168:171], v[88:91], a[156:159], v[168:171]
    v_mul_f32 v74, v74, v8
    v_mul_f32 v75, v75, v9
    v_mfma_f32_16x16x32_bf16 v[172:175], v[88:91], a[220:223], v[172:175]
    v_mul_f32 v8, v76, v76
    s_waitcnt vmcnt(17)
    v_mfma_f32_16x16x32_bf16 v[176:179], v[92:95], a[28:31], v[176:179]
    buffer_load_dwordx4 v[84:87], v5, s[28:31], s46 offen offset:1024 sc1
    v_mfma_f32_16x16x32_bf16 v[180:183], v[92:95], a[92:95], v[180:183]
    v_mul_f32 v9, v77, v77
    v_fma_f32 v8, v8, s88, v10
    v_mfma_f32_16x16x32_bf16 v[184:187], v[92:95], a[156:159], v[184:187]
    v_fma_f32 v9, v9, s88, v10
    v_mul_f32 v8, v8, v76
    v_mfma_f32_16x16x32_bf16 v[188:191], v[92:95], a[220:223], v[188:191]
    v_mul_f32 v9, v9, v77
    s_waitcnt vmcnt(17)
    v_mfma_f32_16x16x32_bf16 v[192:195], v[96:99], a[28:31], v[192:195]
    buffer_load_dwordx4 v[88:91], v5, s[28:31], s46 offen offset:2048 sc1
    v_mfma_f32_16x16x32_bf16 v[196:199], v[96:99], a[92:95], v[196:199]
    v_exp_f32 v8, v8
    v_mfma_f32_16x16x32_bf16 v[200:203], v[96:99], a[156:159], v[200:203]
    v_exp_f32 v9, v9
    v_mfma_f32_16x16x32_bf16 v[204:207], v[96:99], a[220:223], v[204:207]
    v_add_f32 v8, 1.0, v8
    s_waitcnt vmcnt(17)
    v_mfma_f32_16x16x32_bf16 v[208:211], v[100:103], a[28:31], v[208:211]
    buffer_load_dwordx4 v[92:95], v5, s[28:31], s46 offen offset:3072 sc1
    s_add_u32 s46, s46, 4096
    v_mfma_f32_16x16x32_bf16 v[212:215], v[100:103], a[92:95], v[212:215]
    v_add_f32 v9, 1.0, v9
    v_mfma_f32_16x16x32_bf16 v[216:219], v[100:103], a[156:159], v[216:219]
    v_rcp_f32 v8, v8
    v_mfma_f32_16x16x32_bf16 v[220:223], v[100:103], a[220:223], v[220:223]
    s_waitcnt vmcnt(17)
    v_mfma_f32_16x16x32_bf16 v[224:227], v[104:107], a[28:31], v[224:227]
    buffer_load_dwordx4 v[96:99], v5, s[28:31], s46 offen offset:0 sc1
    v_mfma_f32_16x16x32_bf16 v[228:231], v[104:107], a[92:95], v[228:231]
    v_rcp_f32 v9, v9
    v_mfma_f32_16x16x32_bf16 v[232:235], v[104:107], a[156:159], v[232:235]
    v_mul_f32 v76, v76, v8
    v_mul_f32 v77, v77, v9
    v_mfma_f32_16x16x32_bf16 v[236:239], v[104:107], a[220:223], v[236:239]
    v_mul_f32 v8, v78, v78
    s_waitcnt vmcnt(17)
    v_mfma_f32_16x16x32_bf16 v[240:243], v[108:111], a[28:31], v[240:243]
    buffer_load_dwordx4 v[100:103], v5, s[28:31], s46 offen offset:1024 sc1
    v_mfma_f32_16x16x32_bf16 v[244:247], v[108:111], a[92:95], v[244:247]
    v_mul_f32 v9, v79, v79
    v_fma_f32 v8, v8, s88, v10
    v_mfma_f32_16x16x32_bf16 v[248:251], v[108:111], a[156:159], v[248:251]
    v_fma_f32 v9, v9, s88, v10
    v_mul_f32 v8, v8, v78
    v_mfma_f32_16x16x32_bf16 v[252:255], v[108:111], a[220:223], v[252:255]
    v_mul_f32 v9, v9, v79
    s_waitcnt vmcnt(17)
    v_mfma_f32_16x16x32_bf16 v[160:163], v[112:115], a[32:35], v[160:163]
    buffer_load_dwordx4 v[104:107], v5, s[28:31], s46 offen offset:2048 sc1
    v_mfma_f32_16x16x32_bf16 v[164:167], v[112:115], a[96:99], v[164:167]
    v_exp_f32 v8, v8
    v_mfma_f32_16x16x32_bf16 v[168:171], v[112:115], a[160:163], v[168:171]
    v_exp_f32 v9, v9
    v_mfma_f32_16x16x32_bf16 v[172:175], v[112:115], a[224:227], v[172:175]
    v_add_f32 v8, 1.0, v8
    s_waitcnt vmcnt(17)
    v_mfma_f32_16x16x32_bf16 v[176:179], v[116:119], a[32:35], v[176:179]
    buffer_load_dwordx4 v[108:111], v5, s[28:31], s46 offen offset:3072 sc1
    s_add_u32 s46, s46, 4096
    v_mfma_f32_16x16x32_bf16 v[180:183], v[116:119], a[96:99], v[180:183]
    v_add_f32 v9, 1.0, v9
    v_mfma_f32_16x16x32_bf16 v[184:187], v[116:119], a[160:163], v[184:187]
    v_rcp_f32 v8, v8
    v_mfma_f32_16x16x32_bf16 v[188:191], v[116:119], a[224:227], v[188:191]
    s_waitcnt vmcnt(17)
    v_mfma_f32_16x16x32_bf16 v[192:195], v[120:123], a[32:35], v[192:195]
    buffer_load_dwordx4 v[112:115], v5, s[28:31], s46 offen offset:0 sc1
    v_mfma_f32_16x16x32_bf16 v[196:199], v[120:123], a[96:99], v[196:199]
    v_rcp_f32 v9, v9
    v_mfma_f32_16x16x32_bf16 v[200:203], v[120:123], a[160:163], v[200:203]
    v_mul_f32 v78, v78, v8
    v_mul_f32 v79, v79, v9
    v_mfma_f32_16x16x32_bf16 v[204:207], v[120:123], a[224:227], v[204:207]
    s_waitcnt vmcnt(17)
    v_mfma_f32_16x16x32_bf16 v[208:211], v[124:127], a[32:35], v[208:211]
    buffer_load_dwordx4 v[116:119], v5, s[28:31], s46 offen offset:1024 sc1
    v_mfma_f32_16x16x32_bf16 v[212:215], v[124:127], a[96:99], v[212:215]
    v_mfma_f32_16x16x32_bf16 v[216:219], v[124:127], a[160:163], v[216:219]
    v_mfma_f32_16x16x32_bf16 v[220:223], v[124:127], a[224:227], v[220:223]
    s_waitcnt vmcnt(17)
    v_mfma_f32_16x16x32_bf16 v[224:227], v[128:131], a[32:35], v[224:227]
    buffer_load_dwordx4 v[120:123], v5, s[28:31], s46 offen offset:2048 sc1
    v_mfma_f32_16x16x32_bf16 v[228:231], v[128:131], a[96:99], v[228:231]
    v_mfma_f32_16x16x32_bf16 v[232:235], v[128:131], a[160:163], v[232:235]
    v_mfma_f32_16x16x32_bf16 v[236:239], v[128:131], a[224:227], v[236:239]
    s_waitcnt vmcnt(17)
    v_mfma_f32_16x16x32_bf16 v[240:243], v[132:135], a[32:35], v[240:243]
    buffer_load_dwordx4 v[124:127], v5, s[28:31], s46 offen offset:3072 sc1
    s_add_u32 s46, s46, 4096
    v_mfma_f32_16x16x32_bf16 v[244:247], v[132:135], a[96:99], v[244:247]
    v_mfma_f32_16x16x32_bf16 v[248:251], v[132:135], a[160:163], v[248:251]
    v_mfma_f32_16x16x32_bf16 v[252:255], v[132:135], a[224:227], v[252:255]
    s_waitcnt vmcnt(17)
    v_mfma_f32_16x16x32_bf16 v[160:163], v[136:139], a[36:39], v[160:163]
    buffer_load_dwordx4 v[128:131], v5, s[28:31], s46 offen offset:0 sc1
    v_mfma_f32_16x16x32_bf16 v[164:167], v[136:139], a[100:103], v[164:167]
    v_mfma_f32_16x16x32_bf16 v[168:171], v[136:139], a[164:167], v[168:171]
    v_mfma_f32_16x16x32_bf16 v[172:175], v[136:139], a[228:231], v[172:175]
    s_waitcnt vmcnt(17)
    v_mfma_f32_16x16x32_bf16 v[176:179], v[140:143], a[36:39], v[176:179]
    buffer_load_dwordx4 v[132:135], v5, s[28:31], s46 offen offset:1024 sc1
    v_mfma_f32_16x16x32_bf16 v[180:183], v[140:143], a[100:103], v[180:183]
    v_mfma_f32_16x16x32_bf16 v[184:187], v[140:143], a[164:167], v[184:187]
    v_mfma_f32_16x16x32_bf16 v[188:191], v[140:143], a[228:231], v[188:191]
    s_waitcnt vmcnt(17)
    v_mfma_f32_16x16x32_bf16 v[192:195], v[144:147], a[36:39], v[192:195]
    buffer_load_dwordx4 v[136:139], v5, s[28:31], s46 offen offset:2048 sc1
    v_mfma_f32_16x16x32_bf16 v[196:199], v[144:147], a[100:103], v[196:199]
    v_mfma_f32_16x16x32_bf16 v[200:203], v[144:147], a[164:167], v[200:203]
    v_mfma_f32_16x16x32_bf16 v[204:207], v[144:147], a[228:231], v[204:207]
    s_waitcnt vmcnt(17)
    v_mfma_f32_16x16x32_bf16 v[208:211], v[148:151], a[36:39], v[208:211]
    buffer_load_dwordx4 v[140:143], v5, s[28:31], s46 offen offset:3072 sc1
    s_add_u32 s46, s46, 4096
    v_mfma_f32_16x16x32_bf16 v[212:215], v[148:151], a[100:103], v[212:215]
    v_mfma_f32_16x16x32_bf16 v[216:219], v[148:151], a[164:167], v[216:219]
    v_mfma_f32_16x16x32_bf16 v[220:223], v[148:151], a[228:231], v[220:223]
    s_waitcnt vmcnt(17)
    v_mfma_f32_16x16x32_bf16 v[224:227], v[152:155], a[36:39], v[224:227]
    buffer_load_dwordx4 v[144:147], v5, s[28:31], s46 offen offset:0 sc1
    v_mfma_f32_16x16x32_bf16 v[228:231], v[152:155], a[100:103], v[228:231]
    v_mfma_f32_16x16x32_bf16 v[232:235], v[152:155], a[164:167], v[232:235]
    v_mfma_f32_16x16x32_bf16 v[236:239], v[152:155], a[228:231], v[236:239]
    s_waitcnt vmcnt(17)
    v_mfma_f32_16x16x32_bf16 v[240:243], v[156:159], a[36:39], v[240:243]
    buffer_load_dwordx4 v[148:151], v5, s[28:31], s46 offen offset:1024 sc1
    v_mfma_f32_16x16x32_bf16 v[244:247], v[156:159], a[100:103], v[244:247]
    v_mfma_f32_16x16x32_bf16 v[248:251], v[156:159], a[164:167], v[248:251]
    v_mfma_f32_16x16x32_bf16 v[252:255], v[156:159], a[228:231], v[252:255]
    s_waitcnt vmcnt(17)
    v_mfma_f32_16x16x32_bf16 v[160:163], v[80:83], a[40:43], v[160:163]
    s_add_u32 s91, s46, 0
    buffer_load_dwordx4 v[152:155], v5, s[28:31], s91 offen offset:2048 sc1
    v_mfma_f32_16x16x32_bf16 v[164:167], v[80:83], a[104:107], v[164:167]
    v_mfma_f32_16x16x32_bf16 v[168:171], v[80:83], a[168:171], v[168:171]
    v_mfma_f32_16x16x32_bf16 v[172:175], v[80:83], a[232:235], v[172:175]
    s_waitcnt vmcnt(17)
    v_mfma_f32_16x16x32_bf16 v[176:179], v[84:87], a[40:43], v[176:179]
    s_add_u32 s91, s46, 8192
    buffer_load_dwordx4 v[156:159], v5, s[28:31], s91 offen offset:0 sc1
    v_mfma_f32_16x16x32_bf16 v[180:183], v[84:87], a[104:107], v[180:183]
    v_mfma_f32_16x16x32_bf16 v[184:187], v[84:87], a[168:171], v[184:187]
    v_mfma_f32_16x16x32_bf16 v[188:191], v[84:87], a[232:235], v[188:191]
    s_waitcnt vmcnt(17)
    v_mfma_f32_16x16x32_bf16 v[192:195], v[88:91], a[40:43], v[192:195]
    s_add_u32 s91, s46, 12288
    buffer_load_dwordx4 v[80:83], v5, s[28:31], s91 offen offset:2048 sc1
    v_mfma_f32_16x16x32_bf16 v[196:199], v[88:91], a[104:107], v[196:199]
    v_mfma_f32_16x16x32_bf16 v[200:203], v[88:91], a[168:171], v[200:203]
    v_mfma_f32_16x16x32_bf16 v[204:207], v[88:91], a[232:235], v[204:207]
    s_waitcnt vmcnt(17)
    v_mfma_f32_16x16x32_bf16 v[208:211], v[92:95], a[40:43], v[208:211]
    s_add_u32 s91, s46, 0
    buffer_load_dwordx4 v[84:87], v5, s[28:31], s91 offen offset:3072 sc1
    v_mfma_f32_16x16x32_bf16 v[212:215], v[92:95], a[104:107], v[212:215]
    v_mfma_f32_16x16x32_bf16 v[216:219], v[92:95], a[168:171], v[216:219]
    v_mfma_f32_16x16x32_bf16 v[220:223], v[92:95], a[232:235], v[220:223]
    s_waitcnt vmcnt(17)
    v_mfma_f32_16x16x32_bf16 v[224:227], v[96:99], a[40:43], v[224:227]
    s_add_u32 s91, s46, 8192
    buffer_load_dwordx4 v[88:91], v5, s[28:31], s91 offen offset:1024 sc1
    v_mfma_f32_16x16x32_bf16 v[228:231], v[96:99], a[104:107], v[228:231]
    v_mfma_f32_16x16x32_bf16 v[232:235], v[96:99], a[168:171], v[232:235]
    v_mfma_f32_16x16x32_bf16 v[236:239], v[96:99], a[232:235], v[236:239]
    s_waitcnt vmcnt(17)
    v_mfma_f32_16x16x32_bf16 v[240:243], v[100:103], a[40:43], v[240:243]
    s_add_u32 s91, s46, 12288
    buffer_load_dwordx4 v[92:95], v5, s[28:31], s91 offen offset:3072 sc1
    v_mfma_f32_16x16x32_bf16 v[244:247], v[100:103], a[104:107], v[244:247]
    v_mfma_f32_16x16x32_bf16 v[248:251], v[100:103], a[168:171], v[248:251]
    v_mfma_f32_16x16x32_bf16 v[252:255], v[100:103], a[232:235], v[252:255]
    s_waitcnt vmcnt(17)
    v_mfma_f32_16x16x32_bf16 v[160:163], v[104:107], a[44:47], v[160:163]
    s_add_u32 s91, s46, 4096
    buffer_load_dwordx4 v[96:99], v5, s[28:31], s91 offen offset:0 sc1
    v_mfma_f32_16x16x32_bf16 v[164:167], v[104:107], a[108:111], v[164:167]
    v_mfma_f32_16x16x32_bf16 v[168:171], v[104:107], a[172:175], v[168:171]
    v_mfma_f32_16x16x32_bf16 v[172:175], v[104:107], a[236:239], v[172:175]
    s_waitcnt vmcnt(17)
    v_mfma_f32_16x16x32_bf16 v[176:179], v[108:111], a[44:47], v[176:179]
    s_add_u32 s91, s46, 8192
    buffer_load_dwordx4 v[100:103], v5, s[28:31], s91 offen offset:2048 sc1
    v_mfma_f32_16x16x32_bf16 v[180:183], v[108:111], a[108:111], v[180:183]
    v_mfma_f32_16x16x32_bf16 v[184:187], v[108:111], a[172:175], v[184:187]
    v_mfma_f32_16x16x32_bf16 v[188:191], v[108:111], a[236:239], v[188:191]
    s_waitcnt vmcnt(17)
    v_mfma_f32_16x16x32_bf16 v[192:195], v[112:115], a[44:47], v[192:195]
    s_add_u32 s91, s46, 16384
    buffer_load_dwordx4 v[104:107], v5, s[28:31], s91 offen offset:0 sc1
    v_mfma_f32_16x16x32_bf16 v[196:199], v[112:115], a[108:111], v[196:199]
    v_mfma_f32_16x16x32_bf16 v[200:203], v[112:115], a[172:175], v[200:203]
    v_mfma_f32_16x16x32_bf16 v[204:207], v[112:115], a[236:239], v[204:207]
    s_waitcnt vmcnt(17)
    v_mfma_f32_16x16x32_bf16 v[208:211], v[116:119], a[44:47], v[208:211]
    s_add_u32 s91, s46, 4096
    buffer_load_dwordx4 v[108:111], v5, s[28:31], s91 offen offset:1024 sc1
    v_mfma_f32_16x16x32_bf16 v[212:215], v[116:119], a[108:111], v[212:215]
    v_mfma_f32_16x16x32_bf16 v[216:219], v[116:119], a[172:175], v[216:219]
    v_mfma_f32_16x16x32_bf16 v[220:223], v[116:119], a[236:239], v[220:223]
    s_waitcnt vmcnt(17)
    v_mfma_f32_16x16x32_bf16 v[224:227], v[120:123], a[44:47], v[224:227]
    s_add_u32 s91, s46, 8192
    buffer_load_dwordx4 v[112:115], v5, s[28:31], s91 offen offset:3072 sc1
    v_mfma_f32_16x16x32_bf16 v[228:231], v[120:123], a[108:111], v[228:231]
    v_mfma_f32_16x16x32_bf16 v[232:235], v[120:123], a[172:175], v[232:235]
    v_mfma_f32_16x16x32_bf16 v[236:239], v[120:123], a[236:239], v[236:239]
    s_waitcnt vmcnt(17)
    v_mfma_f32_16x16x32_bf16 v[240:243], v[124:127], a[44:47], v[240:243]
    s_add_u32 s91, s46, 16384
    buffer_load_dwordx4 v[116:119], v5, s[28:31], s91 offen offset:1024 sc1
    v_mfma_f32_16x16x32_bf16 v[244:247], v[124:127], a[108:111], v[244:247]
    v_mfma_f32_16x16x32_bf16 v[248:251], v[124:127], a[172:175], v[248:251]
    v_mfma_f32_16x16x32_bf16 v[252:255], v[124:127], a[236:239], v[252:255]
    s_waitcnt vmcnt(17)
    v_mfma_f32_16x16x32_bf16 v[160:163], v[128:131], a[48:51], v[160:163]
    s_add_u32 s91, s46, 4096
    buffer_load_dwordx4 v[120:123], v5, s[28:31], s91 offen offset:2048 sc1
    v_mfma_f32_16x16x32_bf16 v[164:167], v[128:131], a[112:115], v[164:167]
    v_mfma_f32_16x16x32_bf16 v[168:171], v[128:131], a[176:179], v[168:171]
    v_mfma_f32_16x16x32_bf16 v[172:175], v[128:131], a[240:243], v[172:175]
    s_waitcnt vmcnt(17)
    v_mfma_f32_16x16x32_bf16 v[176:179], v[132:135], a[48:51], v[176:179]
    s_add_u32 s91, s46, 12288
    buffer_load_dwordx4 v[124:127], v5, s[28:31], s91 offen offset:0 sc1
    v_mfma_f32_16x16x32_bf16 v[180:183], v[132:135], a[112:115], v[180:183]
    v_mfma_f32_16x16x32_bf16 v[184:187], v[132:135], a[176:179], v[184:187]
    v_mfma_f32_16x16x32_bf16 v[188:191], v[132:135], a[240:243], v[188:191]
    s_waitcnt vmcnt(17)
    v_mfma_f32_16x16x32_bf16 v[192:195], v[136:139], a[48:51], v[192:195]
    s_add_u32 s91, s46, 16384
    buffer_load_dwordx4 v[128:131], v5, s[28:31], s91 offen offset:2048 sc1
    v_mfma_f32_16x16x32_bf16 v[196:199], v[136:139], a[112:115], v[196:199]
    v_mfma_f32_16x16x32_bf16 v[200:203], v[136:139], a[176:179], v[200:203]
    v_mfma_f32_16x16x32_bf16 v[204:207], v[136:139], a[240:243], v[204:207]
    s_waitcnt vmcnt(17)
    v_mfma_f32_16x16x32_bf16 v[208:211], v[140:143], a[48:51], v[208:211]
    s_add_u32 s91, s46, 4096
    buffer_load_dwordx4 v[132:135], v5, s[28:31], s91 offen offset:3072 sc1
    v_mfma_f32_16x16x32_bf16 v[212:215], v[140:143], a[112:115], v[212:215]
    v_mfma_f32_16x16x32_bf16 v[216:219], v[140:143], a[176:179], v[216:219]
    v_mfma_f32_16x16x32_bf16 v[220:223], v[140:143], a[240:243], v[220:223]
    s_waitcnt vmcnt(17)
    v_mfma_f32_16x16x32_bf16 v[224:227], v[144:147], a[48:51], v[224:227]
    s_add_u32 s91, s46, 12288
    buffer_load_dwordx4 v[136:139], v5, s[28:31], s91 offen offset:1024 sc1
    v_mfma_f32_16x16x32_bf16 v[228:231], v[144:147], a[112:115], v[228:231]
    v_mfma_f32_16x16x32_bf16 v[232:235], v[144:147], a[176:179], v[232:235]
    v_mfma_f32_16x16x32_bf16 v[236:239], v[144:147], a[240:243], v[236:239]
    s_waitcnt vmcnt(17)
    v_mfma_f32_16x16x32_bf16 v[240:243], v[148:151], a[48:51], v[240:243]
    s_add_u32 s91, s46, 16384
    buffer_load_dwordx4 v[140:143], v5, s[28:31], s91 offen offset:3072 sc1
    v_min_u32 v6, 23, v1
    v_lshlrev_b32 v6, 7, v6
    buffer_load_dword v32, v6, s[28:31], s14 offen sc1
    v_mfma_f32_16x16x32_bf16 v[244:247], v[148:151], a[112:115], v[244:247]
    v_mfma_f32_16x16x32_bf16 v[248:251], v[148:151], a[176:179], v[248:251]
    v_mfma_f32_16x16x32_bf16 v[252:255], v[148:151], a[240:243], v[252:255]
    s_waitcnt vmcnt(18)
    v_mfma_f32_16x16x32_bf16 v[160:163], v[152:155], a[52:55], v[160:163]
    v_mfma_f32_16x16x32_bf16 v[164:167], v[152:155], a[116:119], v[164:167]
    v_mfma_f32_16x16x32_bf16 v[168:171], v[152:155], a[180:183], v[168:171]
    v_mfma_f32_16x16x32_bf16 v[172:175], v[152:155], a[244:247], v[172:175]
    s_waitcnt vmcnt(17)
    v_mfma_f32_16x16x32_bf16 v[160:163], v[156:159], a[56:59], v[160:163]
    v_mfma_f32_16x16x32_bf16 v[164:167], v[156:159], a[120:123], v[164:167]
    v_mfma_f32_16x16x32_bf16 v[168:171], v[156:159], a[184:187], v[168:171]
    v_mfma_f32_16x16x32_bf16 v[172:175], v[156:159], a[248:251], v[172:175]
    s_waitcnt vmcnt(16)
    v_mfma_f32_16x16x32_bf16 v[160:163], v[80:83], a[60:63], v[160:163]
    v_mfma_f32_16x16x32_bf16 v[164:167], v[80:83], a[124:127], v[164:167]
    v_mfma_f32_16x16x32_bf16 v[168:171], v[80:83], a[188:191], v[168:171]
    v_mfma_f32_16x16x32_bf16 v[172:175], v[80:83], a[252:255], v[172:175]
    s_waitcnt vmcnt(15)
    v_mfma_f32_16x16x32_bf16 v[176:179], v[84:87], a[52:55], v[176:179]
    v_mfma_f32_16x16x32_bf16 v[180:183], v[84:87], a[116:119], v[180:183]
    v_mfma_f32_16x16x32_bf16 v[184:187], v[84:87], a[180:183], v[184:187]
    v_mfma_f32_16x16x32_bf16 v[188:191], v[84:87], a[244:247], v[188:191]
    s_nop 0
    ds_write_b128 v25, v[164:167] offset:0
    s_waitcnt vmcnt(14)
    v_mfma_f32_16x16x32_bf16 v[176:179], v[88:91], a[56:59], v[176:179]
    v_mfma_f32_16x16x32_bf16 v[180:183], v[88:91], a[120:123], v[180:183]
    ds_write_b128 v26, v[168:171] offset:0
    v_mfma_f32_16x16x32_bf16 v[184:187], v[88:91], a[184:187], v[184:187]
    v_mfma_f32_16x16x32_bf16 v[188:191], v[88:91], a[248:251], v[188:191]
    ds_write_b128 v27, v[172:175] offset:0
    s_waitcnt vmcnt(13)
    v_mfma_f32_16x16x32_bf16 v[176:179], v[92:95], a[60:63], v[176:179]
    v_mfma_f32_16x16x32_bf16 v[180:183], v[92:95], a[124:127], v[180:183]
    v_mfma_f32_16x16x32_bf16 v[184:187], v[92:95], a[188:191], v[184:187]
    v_mfma_f32_16x16x32_bf16 v[188:191], v[92:95], a[252:255], v[188:191]
    s_waitcnt vmcnt(12)
    v_mfma_f32_16x16x32_bf16 v[192:195], v[96:99], a[52:55], v[192:195]
    v_mfma_f32_16x16x32_bf16 v[196:199], v[96:99], a[116:119], v[196:199]
    v_mfma_f32_16x16x32_bf16 v[200:203], v[96:99], a[180:183], v[200:203]
    v_mfma_f32_16x16x32_bf16 v[204:207], v[96:99], a[244:247], v[204:207]
    s_nop 0
    ds_write_b128 v25, v[180:183] offset:1024
    s_waitcnt vmcnt(11)
    v_mfma_f32_16x16x32_bf16 v[192:195], v[100:103], a[56:59], v[192:195]
    v_mfma_f32_16x16x32_bf16 v[196:199], v[100:103], a[120:123], v[196:199]
    ds_write_b128 v26, v[184:187] offset:1024
    v_mfma_f32_16x16x32_bf16 v[200:203], v[100:103], a[184:187], v[200:203]
    v_mfma_f32_16x16x32_bf16 v[204:207], v[100:103], a[248:251], v[204:207]
    ds_write_b128 v27, v[188:191] offset:1024
    s_waitcnt vmcnt(10)
    v_mfma_f32_16x16x32_bf16 v[192:195], v[104:107], a[60:63], v[192:195]
    v_mfma_f32_16x16x32_bf16 v[196:199], v[104:107], a[124:127], v[196:199]
    v_mfma_f32_16x16x32_bf16 v[200:203], v[104:107], a[188:191], v[200:203]
    v_mfma_f32_16x16x32_bf16 v[204:207], v[104:107], a[252:255], v[204:207]
    s_waitcnt vmcnt(9)
    v_mfma_f32_16x16x32_bf16 v[208:211], v[108:111], a[52:55], v[208:211]
    v_mfma_f32_16x16x32_bf16 v[212:215], v[108:111], a[116:119], v[212:215]
    v_mfma_f32_16x16x32_bf16 v[216:219], v[108:111], a[180:183], v[216:219]
    v_mfma_f32_16x16x32_bf16 v[220:223], v[108:111], a[244:247], v[220:223]
    s_nop 0
    ds_write_b128 v25, v[196:199] offset:2048
    s_waitcnt vmcnt(8)
    v_mfma_f32_16x16x32_bf16 v[208:211], v[112:115], a[56:59], v[208:211]
    v_mfma_f32_16x16x32_bf16 v[212:215], v[112:115], a[120:123], v[212:215]
    ds_write_b128 v26, v[200:203] offset:2048
    v_mfma_f32_16x16x32_bf16 v[216:219], v[112:115], a[184:187], v[216:219]
    v_mfma_f32_16x16x32_bf16 v[220:223], v[112:115], a[248:251], v[220:223]
    ds_write_b128 v27, v[204:207] offset:2048
    s_waitcnt vmcnt(7)
    v_mfma_f32_16x16x32_bf16 v[208:211], v[116:119], a[60:63], v[208:211]
    v_mfma_f32_16x16x32_bf16 v[212:215], v[116:119], a[124:127], v[212:215]
    v_mfma_f32_16x16x32_bf16 v[216:219], v[116:119], a[188:191], v[216:219]
    v_mfma_f32_16x16x32_bf16 v[220:223], v[116:119], a[252:255], v[220:223]
    s_waitcnt vmcnt(6)
    v_mfma_f32_16x16x32_bf16 v[224:227], v[120:123], a[52:55], v[224:227]
    v_mfma_f32_16x16x32_bf16 v[228:231], v[120:123], a[116:119], v[228:231]
    v_mfma_f32_16x16x32_bf16 v[232:235], v[120:123], a[180:183], v[232:235]
    v_mfma_f32_16x16x32_bf16 v[236:239], v[120:123], a[244:247], v[236:239]
    s_nop 0
    ds_write_b128 v25, v[212:215] offset:3072
    s_waitcnt vmcnt(5)
    v_mfma_f32_16x16x32_bf16 v[224:227], v[124:127], a[56:59], v[224:227]
    v_mfma_f32_16x16x32_bf16 v[228:231], v[124:127], a[120:123], v[228:231]
    ds_write_b128 v26, v[216:219] offset:3072
    v_mfma_f32_16x16x32_bf16 v[232:235], v[124:127], a[184:187], v[232:235]
    v_mfma_f32_16x16x32_bf16 v[236:239], v[124:127], a[248:251], v[236:239]
    ds_write_b128 v27, v[220:223] offset:3072
    s_waitcnt vmcnt(4)
    v_mfma_f32_16x16x32_bf16 v[224:227], v[128:131], a[60:63], v[224:227]
    v_mfma_f32_16x16x32_bf16 v[228:231], v[128:131], a[124:127], v[228:231]
    v_mfma_f32_16x16x32_bf16 v[232:235], v[128:131], a[188:191], v[232:235]
    v_mfma_f32_16x16x32_bf16 v[236:239], v[128:131], a[252:255], v[236:239]
    s_waitcnt vmcnt(3)
    v_mfma_f32_16x16x32_bf16 v[240:243], v[132:135], a[52:55], v[240:243]
    v_mfma_f32_16x16x32_bf16 v[244:247], v[132:135], a[116:119], v[244:247]
    v_mfma_f32_16x16x32_bf16 v[248:251], v[132:135], a[180:183], v[248:251]
    v_mfma_f32_16x16x32_bf16 v[252:255], v[132:135], a[244:247], v[252:255]
    s_nop 0
    ds_write_b128 v25, v[228:231] offset:4096
    s_waitcnt vmcnt(2)
    v_mfma_f32_16x16x32_bf16 v[240:243], v[136:139], a[56:59], v[240:243]
    v_mfma_f32_16x16x32_bf16 v[244:247], v[136:139], a[120:123], v[244:247]
    ds_write_b128 v26, v[232:235] offset:4096
    v_mfma_f32_16x16x32_bf16 v[248:251], v[136:139], a[184:187], v[248:251]
    v_mfma_f32_16x16x32_bf16 v[252:255], v[136:139], a[248:251], v[252:255]
    ds_write_b128 v27, v[236:239] offset:4096
    s_waitcnt vmcnt(1)
    v_mfma_f32_16x16x32_bf16 v[240:243], v[140:143], a[60:63], v[240:243]
    v_mfma_f32_16x16x32_bf16 v[244:247], v[140:143], a[124:127], v[244:247]
    v_mfma_f32_16x16x32_bf16 v[248:251], v[140:143], a[188:191], v[248:251]
    v_mfma_f32_16x16x32_bf16 v[252:255], v[140:143], a[252:255], v[252:255]
    s_add_u32 s98, s55, 0
    s_add_u32 m0, s65, 0
    s_nop 0
    buffer_load_dwordx4 v5, s[28:31], s98 offen offset:0 sc1 lds
    buffer_load_dwordx4 v5, s[28:31], s98 offen offset:1024 sc1 lds
    s_nop 0
    ds_write_b128 v25, v[244:247] offset:5120
    ds_write_b128 v26, v[248:251] offset:5120
    ds_write_b128 v27, v[252:255] offset:5120
    buffer_load_dwordx4 v5, s[28:31], s98 offen offset:2048 sc1 lds
    buffer_load_dwordx4 v5, s[28:31], s98 offen offset:3072 sc1 lds
    s_add_u32 s98, s98, 16384
    s_add_u32 m0, s65, 16384
    s_nop 0
    buffer_load_dwordx4 v5, s[28:31], s98 offen offset:0 sc1 lds
    buffer_load_dwordx4 v5, s[28:31], s98 offen offset:1024 sc1 lds
    buffer_load_dwordx4 v5, s[28:31], s98 offen offset:2048 sc1 lds
    buffer_load_dwordx4 v5, s[28:31], s98 offen offset:3072 sc1 lds
    s_add_u32 s98, s98, 16384
    s_add_u32 m0, s65, 32768
    s_nop 0
    buffer_load_dwordx4 v5, s[28:31], s98 offen offset:0 sc1 lds
    buffer_load_dwordx4 v5, s[28:31], s98 offen offset:1024 sc1 lds
    buffer_load_dwordx4 v5, s[28:31], s98 offen offset:2048 sc1 lds
    buffer_load_dwordx4 v5, s[28:31], s98 offen offset:3072 sc1 lds
    s_add_u32 s98, s98, 16384
    s_add_u32 m0, s65, 49152
    s_nop 0
    buffer_load_dwordx4 v5, s[28:31], s98 offen offset:0 sc1 lds
    buffer_load_dwordx4 v5, s[28:31], s98 offen offset:1024 sc1 lds
    buffer_load_dwordx4 v5, s[28:31], s98 offen offset:2048 sc1 lds
    buffer_load_dwordx4 v5, s[28:31], s98 offen offset:3072 sc1 lds
    s_add_u32 s98, s98, 16384
    s_add_u32 m0, s65, 65536
    s_nop 0
    buffer_load_dwordx4 v5, s[28:31], s98 offen offset:0 sc1 lds
    buffer_load_dwordx4 v5, s[28:31], s98 offen offset:1024 sc1 lds
    buffer_load_dwordx4 v5, s[28:31], s98 offen offset:2048 sc1 lds
    buffer_load_dwordx4 v5, s[28:31], s98 offen offset:3072 sc1 lds
    s_add_u32 s98, s98, 16384
    s_add_u32 m0, s65, 81920
    v_mov_b32 v6, v13
    v_pk_add_f32 v[160:161], v[160:161], v[6:7] op_sel_hi:[1,0]
    v_pk_add_f32 v[162:163], v[162:163], v[6:7] op_sel_hi:[1,0]
    v_pk_add_f32 v[176:177], v[176:177], v[6:7] op_sel_hi:[1,0]
    v_pk_add_f32 v[178:179], v[178:179], v[6:7] op_sel_hi:[1,0]
    v_pk_add_f32 v[192:193], v[192:193], v[6:7] op_sel_hi:[1,0]
    v_pk_add_f32 v[194:195], v[194:195], v[6:7] op_sel_hi:[1,0]
    v_pk_add_f32 v[208:209], v[208:209], v[6:7] op_sel_hi:[1,0]
    v_pk_add_f32 v[210:211], v[210:211], v[6:7] op_sel_hi:[1,0]
    v_pk_add_f32 v[224:225], v[224:225], v[6:7] op_sel_hi:[1,0]
    v_pk_add_f32 v[226:227], v[226:227], v[6:7] op_sel_hi:[1,0]
    v_pk_add_f32 v[240:241], v[240:241], v[6:7] op_sel_hi:[1,0]
    v_pk_add_f32 v[242:243], v[242:243], v[6:7] op_sel_hi:[1,0]
    s_waitcnt lgkmcnt(0)
    s_barrier
    ds_read_b128 v[164:167], v24 offset:0
    ds_read_b128 v[168:171], v24 offset:6144
    ds_read_b128 v[172:175], v24 offset:12288
    ds_read_b128 v[180:183], v24 offset:1024
    ds_read_b128 v[184:187], v24 offset:7168
    ds_read_b128 v[188:191], v24 offset:13312
    ds_read_b128 v[196:199], v24 offset:2048
    ds_read_b128 v[200:203], v24 offset:8192
    ds_read_b128 v[204:207], v24 offset:14336
    ds_read_b128 v[212:215], v24 offset:3072
    ds_read_b128 v[216:219], v24 offset:9216
    ds_read_b128 v[220:223], v24 offset:15360
    s_waitcnt lgkmcnt(9)
    ds_read_b128 v[228:231], v24 offset:4096
    ds_read_b128 v[232:235], v24 offset:10240
    ds_read_b128 v[236:239], v24 offset:16384
    ds_read_b128 v[244:247], v24 offset:5120
    ds_read_b128 v[248:251], v24 offset:11264
    ds_read_b128 v[252:255], v24 offset:17408
    v_pk_add_f32 v[164:165], v[164:165], v[168:169]
    v_pk_add_f32 v[160:161], v[160:161], v[172:173]
    v_pk_add_f32 v[166:167], v[166:167], v[170:171]
    v_pk_add_f32 v[162:163], v[162:163], v[174:175]
    v_pk_add_f32 v[160:161], v[160:161], v[164:165]
    v_pk_add_f32 v[162:163], v[162:163], v[166:167]
    v_pk_mul_f32 v[160:161], v[160:161], v[56:57]
    v_pk_mul_f32 v[162:163], v[162:163], v[58:59]
    v_cvt_pk_bf16_f32 v148, v160, v161
    v_cvt_pk_bf16_f32 v149, v162, v163
    s_waitcnt lgkmcnt(12)
    v_pk_add_f32 v[180:181], v[180:181], v[184:185]
    v_pk_add_f32 v[176:177], v[176:177], v[188:189]
    v_pk_add_f32 v[182:183], v[182:183], v[186:187]
    v_pk_add_f32 v[178:179], v[178:179], v[190:191]
    v_pk_add_f32 v[176:177], v[176:177], v[180:181]
    v_pk_add_f32 v[178:179], v[178:179], v[182:183]
    v_pk_mul_f32 v[176:177], v[176:177], v[60:61]
    v_pk_mul_f32 v[178:179], v[178:179], v[62:63]
    v_cvt_pk_bf16_f32 v150, v176, v177
    v_cvt_pk_bf16_f32 v151, v178, v179
    s_waitcnt lgkmcnt(9)
    v_pk_add_f32 v[196:197], v[196:197], v[200:201]
    v_pk_add_f32 v[192:193], v[192:193], v[204:205]
    v_pk_add_f32 v[198:199], v[198:199], v[202:203]
    v_pk_add_f32 v[194:195], v[194:195], v[206:207]
    v_pk_add_f32 v[192:193], v[192:193], v[196:197]
    v_pk_add_f32 v[194:195], v[194:195], v[198:199]
    v_pk_mul_f32 v[192:193], v[192:193], v[64:65]
    v_pk_mul_f32 v[194:195], v[194:195], v[66:67]
    v_cvt_pk_bf16_f32 v152, v192, v193
    v_cvt_pk_bf16_f32 v153, v194, v195
    s_waitcnt lgkmcnt(6)
    v_pk_add_f32 v[212:213], v[212:213], v[216:217]
    v_pk_add_f32 v[208:209], v[208:209], v[220:221]
    v_pk_add_f32 v[214:215], v[214:215], v[218:219]
    v_pk_add_f32 v[210:211], v[210:211], v[222:223]
    v_pk_add_f32 v[208:209], v[208:209], v[212:213]
    v_pk_add_f32 v[210:211], v[210:211], v[214:215]
    v_pk_mul_f32 v[208:209], v[208:209], v[68:69]
    v_pk_mul_f32 v[210:211], v[210:211], v[70:71]
    v_cvt_pk_bf16_f32 v154, v208, v209
    v_cvt_pk_bf16_f32 v155, v210, v211
    s_waitcnt lgkmcnt(3)
    v_pk_add_f32 v[228:229], v[228:229], v[232:233]
    v_pk_add_f32 v[224:225], v[224:225], v[236:237]
    v_pk_add_f32 v[230:231], v[230:231], v[234:235]
    v_pk_add_f32 v[226:227], v[226:227], v[238:239]
    v_pk_add_f32 v[224:225], v[224:225], v[228:229]
    v_pk_add_f32 v[226:227], v[226:227], v[230:231]
    v_pk_mul_f32 v[224:225], v[224:225], v[72:73]
    v_pk_mul_f32 v[226:227], v[226:227], v[74:75]
    v_cvt_pk_bf16_f32 v156, v224, v225
    v_cvt_pk_bf16_f32 v157, v226, v227
    s_waitcnt lgkmcnt(0)
    v_pk_add_f32 v[244:245], v[244:245], v[248:249]
    v_pk_add_f32 v[240:241], v[240:241], v[252:253]
    v_pk_add_f32 v[246:247], v[246:247], v[250:251]
    v_pk_add_f32 v[242:243], v[242:243], v[254:255]
    v_pk_add_f32 v[240:241], v[240:241], v[244:245]
    v_pk_add_f32 v[242:243], v[242:243], v[246:247]
    v_pk_mul_f32 v[240:241], v[240:241], v[76:77]
    v_pk_mul_f32 v[242:243], v[242:243], v[78:79]
    v_cvt_pk_bf16_f32 v158, v240, v241
    v_cvt_pk_bf16_f32 v159, v242, v243
    s_cmp_eq_u32 s3, 0
    s_cbranch_scc1 L_far_53
    buffer_store_dwordx4 v[148:151], v5, s[28:31], s14 offen offset:0
    buffer_store_dwordx4 v[152:155], v5, s[28:31], s14 offen offset:1024
    buffer_store_dwordx4 v[156:159], v5, s[28:31], s14 offen offset:2048
L_st_54:
    s_waitcnt vmcnt(0)
    v_mov_b32 v6, s83
    s_mov_b64 exec, 1
    s_cmp_eq_u32 s3, 0
    s_cbranch_scc1 L_far_55
    buffer_store_dword v6, off, s[28:31], s16
L_st_56:
    s_mov_b64 exec, -1
    s_barrier
    buffer_load_dwordx4 v5, s[28:31], s98 offen offset:0 sc1 lds
    buffer_load_dwordx4 v5, s[28:31], s98 offen offset:1024 sc1 lds
    buffer_load_dwordx4 v5, s[28:31], s98 offen offset:2048 sc1 lds
    buffer_load_dwordx4 v5, s[28:31], s98 offen offset:3072 sc1 lds
    s_add_u32 s98, s98, 16384
    s_add_u32 m0, s65, 98304
    s_nop 0
    buffer_load_dwordx4 v5, s[28:31], s98 offen offset:0 sc1 lds
    buffer_load_dwordx4 v5, s[28:31], s98 offen offset:1024 sc1 lds
    buffer_load_dwordx4 v5, s[28:31], s98 offen offset:2048 sc1 lds
    buffer_load_dwordx4 v5, s[28:31], s98 offen offset:3072 sc1 lds
    s_add_u32 s98, s98, 16384
    s_lshr_b32 s99, s65, 1
    s_sub_u32 s98, s98, s99
    s_add_u32 m0, s99, 114688
    s_nop 0
    buffer_load_dwordx4 v5, s[28:31], s98 offen offset:0 sc1 lds
    buffer_load_dwordx4 v5, s[28:31], s98 offen offset:1024 sc1 lds
    global_load_dwordx4 v[24:27], v5, s[74:75]
    s_add_u32 s74, s74, 4096
    s_addc_u32 s75, s75, 0
    global_load_dwordx4 v[16:19], v5, s[74:75]
    s_add_u32 s74, s74, 4096
    s_addc_u32 s75, s75, 0
    ds_read_b128 v[56:59], v29 offset:960
    ds_read_b128 v[60:63], v29 offset:1024
    ds_read_b128 v[64:67], v29 offset:1088
    ds_read_b128 v[68:71], v29 offset:1152
    ds_read_b128 v[72:75], v29 offset:1216
    s_mov_b32 s85, s13
    buffer_load_dword v6, v28, s[28:31], s15 offen sc1
    s_waitcnt vmcnt(3)
    s_barrier
    s_waitcnt lgkmcnt(0)
    ds_read_b128 v[96:99], v5 offset:0
    ds_read_b128 v[100:103], v5 offset:1024
    ds_read_b128 v[104:107], v5 offset:2048
    ds_read_b128 v[108:111], v5 offset:3072
    ds_read_b128 v[112:115], v5 offset:4096
    ds_read_b128 v[116:119], v5 offset:5120
    ds_read_b128 v[120:123], v5 offset:6144
    ds_read_b128 v[124:127], v5 offset:7168
    ds_read_b128 v[128:131], v5 offset:8192
    ds_read_b128 v[132:135], v5 offset:9216
    ds_read_b128 v[136:139], v5 offset:10240
    ds_read_b128 v[140:143], v5 offset:11264
    ds_read_b128 v[144:147], v5 offset:12288
    ds_read_b128 v[148:151], v5 offset:13312
    s_waitcnt vmcnt(0)
    v_cmp_ne_u32 vcc, s83, v6
    s_nop 0
    s_cmp_lg_u64 vcc, 0
    s_cbranch_scc1 L_retry_57
L_ok_58:
    buffer_load_dwordx4 v[160:163], v5, s[28:31], s85 offen offset:0 sc1
    buffer_load_dwordx4 v[164:167], v5, s[28:31], s85 offen offset:1024 sc1
    buffer_load_dwordx4 v[168:171], v5, s[28:31], s85 offen offset:2048 sc1
    buffer_load_dwordx4 v[172:175], v5, s[28:31], s85 offen offset:3072 sc1
    s_add_u32 s85, s85, 4096
    buffer_load_dwordx4 v[176:179], v5, s[28:31], s85 offen offset:0 sc1
    buffer_load_dwordx4 v[180:183], v5, s[28:31], s85 offen offset:1024 sc1
    s_waitcnt vmcnt(5) lgkmcnt(9)
    v_mfma_f32_16x16x32_bf16 v[76:79], v[96:99], v[160:163], 0
    ds_read_b128 v[152:155], v5 offset:14336
    v_mfma_f32_16x16x32_bf16 v[80:83], v[100:103], v[160:163], 0
    ds_read_b128 v[156:159], v5 offset:15360
    buffer_load_dwordx4 v[184:187], v5, s[28:31], s85 offen offset:2048 sc1
    v_mfma_f32_16x16x32_bf16 v[84:87], v[104:107], v[160:163], 0
    ds_read_b128 v[96:99], v5 offset:16384
    v_mfma_f32_16x16x32_bf16 v[88:91], v[108:111], v[160:163], 0
    ds_read_b128 v[100:103], v5 offset:17408
    v_mfma_f32_16x16x32_bf16 v[92:95], v[112:115], v[160:163], 0
    ds_read_b128 v[104:107], v5 offset:18432
    buffer_load_dwordx4 v[188:191], v5, s[28:31], s85 offen offset:3072 sc1
    s_add_u32 s85, s85, 4096
    s_waitcnt vmcnt(6) lgkmcnt(9)
    v_mfma_f32_16x16x32_bf16 v[76:79], v[116:119], v[164:167], v[76:79]
    ds_read_b128 v[108:111], v5 offset:19456
    v_mfma_f32_16x16x32_bf16 v[80:83], v[120:123], v[164:167], v[80:83]
    ds_read_b128 v[112:115], v5 offset:20480
    v_mfma_f32_16x16x32_bf16 v[84:87], v[124:127], v[164:167], v[84:87]
    ds_read_b128 v[116:119], v5 offset:21504
    buffer_load_dwordx4 v[192:195], v5, s[28:31], s85 offen offset:0 sc1
    v_mfma_f32_16x16x32_bf16 v[88:91], v[128:131], v[164:167], v[88:91]
    ds_read_b128 v[120:123], v5 offset:22528
    v_mfma_f32_16x16x32_bf16 v[92:95], v[132:135], v[164:167], v[92:95]
    ds_read_b128 v[124:127], v5 offset:23552
    s_waitcnt vmcnt(6) lgkmcnt(9)
    v_mfma_f32_16x16x32_bf16 v[76:79], v[136:139], v[168:171], v[76:79]
    ds_read_b128 v[128:131], v5 offset:24576
    buffer_load_dwordx4 v[196:199], v5, s[28:31], s85 offen offset:1024 sc1
    v_mfma_f32_16x16x32_bf16 v[80:83], v[140:143], v[168:171], v[80:83]
    ds_read_b128 v[132:135], v5 offset:25600
    v_mfma_f32_16x16x32_bf16 v[84:87], v[144:147], v[168:171], v[84:87]
    ds_read_b128 v[136:139], v5 offset:26624
    v_mfma_f32_16x16x32_bf16 v[88:91], v[148:151], v[168:171], v[88:91]
    ds_read_b128 v[140:143], v5 offset:27648
    buffer_load_dwordx4 v[200:203], v5, s[28:31], s85 offen offset:2048 sc1
    v_mfma_f32_16x16x32_bf16 v[92:95], v[152:155], v[168:171], v[92:95]
    ds_read_b128 v[144:147], v5 offset:28672
    s_waitcnt vmcnt(7) lgkmcnt(9)
    v_mfma_f32_16x16x32_bf16 v[76:79], v[156:159], v[172:175], v[76:79]
    ds_read_b128 v[148:151], v5 offset:29696
    v_mfma_f32_16x16x32_bf16 v[80:83], v[96:99], v[172:175], v[80:83]
    ds_read_b128 v[152:155], v5 offset:30720
    buffer_load_dwordx4 v[204:207], v5, s[28:31], s85 offen offset:3072 sc1
    s_add_u32 s85, s85, 4096
    v_mfma_f32_16x16x32_bf16 v[84:87], v[100:103], v[172:175], v[84:87]
    ds_read_b128 v[156:159], v5 offset:31744
    v_mfma_f32_16x16x32_bf16 v[88:91], v[104:107], v[172:175], v[88:91]
    ds_read_b128 v[96:99], v5 offset:32768
    v_mfma_f32_16x16x32_bf16 v[92:95], v[108:111], v[172:175], v[92:95]
    ds_read_b128 v[100:103], v5 offset:33792
    buffer_load_dwordx4 v[208:211], v5, s[28:31], s85 offen offset:0 sc1
    s_waitcnt vmcnt(8) lgkmcnt(9)
    v_mfma_f32_16x16x32_bf16 v[76:79], v[112:115], v[176:179], v[76:79]
    ds_read_b128 v[104:107], v5 offset:34816
    v_mfma_f32_16x16x32_bf16 v[80:83], v[116:119], v[176:179], v[80:83]
    ds_read_b128 v[108:111], v5 offset:35840
    v_mfma_f32_16x16x32_bf16 v[84:87], v[120:123], v[176:179], v[84:87]
    ds_read_b128 v[112:115], v5 offset:36864
    buffer_load_dwordx4 v[212:215], v5, s[28:31], s85 offen offset:1024 sc1
    v_mfma_f32_16x16x32_bf16 v[88:91], v[124:127], v[176:179], v[88:91]
    ds_read_b128 v[116:119], v5 offset:37888
    v_mfma_f32_16x16x32_bf16 v[92:95], v[128:131], v[176:179], v[92:95]
    ds_read_b128 v[120:123], v5 offset:38912
    s_waitcnt vmcnt(8) lgkmcnt(9)
    v_mfma_f32_16x16x32_bf16 v[76:79], v[132:135], v[180:183], v[76:79]
    ds_read_b128 v[124:127], v5 offset:39936
    buffer_load_dwordx4 v[216:219], v5, s[28:31], s85 offen offset:2048 sc1
    v_mfma_f32_16x16x32_bf16 v[80:83], v[136:139], v[180:183], v[80:83]
    ds_read_b128 v[128:131], v5 offset:40960
    v_mfma_f32_16x16x32_bf16 v[84:87], v[140:143], v[180:183], v[84:87]
    ds_read_b128 v[132:135], v5 offset:41984
    v_mfma_f32_16x16x32_bf16 v[88:91], v[144:147], v[180:183], v[88:91]
    ds_read_b128 v[136:139], v5 offset:43008
    buffer_load_dwordx4 v[220:223], v5, s[28:31], s85 offen offset:3072 sc1
    s_add_u32 s85, s85, 4096
    v_mfma_f32_16x16x32_bf16 v[92:95], v[148:151], v[180:183], v[92:95]
    ds_read_b128 v[140:143], v5 offset:44032
    s_waitcnt vmcnt(9) lgkmcnt(9)
    v_mfma_f32_16x16x32_bf16 v[76:79], v[152:155], v[184:187], v[76:79]
    ds_read_b128 v[144:147], v5 offset:45056
    v_mfma_f32_16x16x32_bf16 v[80:83], v[156:159], v[184:187], v[80:83]
    ds_read_b128 v[148:151], v5 offset:46080
    buffer_load_dwordx4 v[224:227], v5, s[28:31], s85 offen offset:0 sc1
    v_mfma_f32_16x16x32_bf16 v[84:87], v[96:99], v[184:187], v[84:87]
    ds_read_b128 v[152:155], v5 offset:47104
    v_mfma_f32_16x16x32_bf16 v[88:91], v[100:103], v[184:187], v[88:91]
    ds_read_b128 v[156:159], v5 offset:48128
    v_mfma_f32_16x16x32_bf16 v[92:95], v[104:107], v[184:187], v[92:95]
    ds_read_b128 v[96:99], v5 offset:49152
    buffer_load_dwordx4 v[228:231], v5, s[28:31], s85 offen offset:1024 sc1
    s_waitcnt vmcnt(10) lgkmcnt(9)
    v_mfma_f32_16x16x32_bf16 v[76:79], v[108:111], v[188:191], v[76:79]
    ds_read_b128 v[100:103], v5 offset:50176
    v_mfma_f32_16x16x32_bf16 v[80:83], v[112:115], v[188:191], v[80:83]
    ds_read_b128 v[104:107], v5 offset:51200
    v_mfma_f32_16x16x32_bf16 v[84:87], v[116:119], v[188:191], v[84:87]
    ds_read_b128 v[108:111], v5 offset:52224
    buffer_load_dwordx4 v[232:235], v5, s[28:31], s85 offen offset:2048 sc1
    v_mfma_f32_16x16x32_bf16 v[88:91], v[120:123], v[188:191], v[88:91]
    ds_read_b128 v[112:115], v5 offset:53248
    v_mfma_f32_16x16x32_bf16 v[92:95], v[124:127], v[188:191], v[92:95]
    ds_read_b128 v[116:119], v5 offset:54272
    s_waitcnt vmcnt(10) lgkmcnt(9)
    v_mfma_f32_16x16x32_bf16 v[76:79], v[128:131], v[192:195], v[76:79]
    ds_read_b128 v[120:123], v5 offset:55296
    buffer_load_dwordx4 v[236:239], v5, s[28:31], s85 offen offset:3072 sc1
    s_add_u32 s85, s85, 4096
    v_mfma_f32_16x16x32_bf16 v[80:83], v[132:135], v[192:195], v[80:83]
    ds_read_b128 v[124:127], v5 offset:56320
    v_mfma_f32_16x16x32_bf16 v[84:87], v[136:139], v[192:195], v[84:87]
    ds_read_b128 v[128:131], v5 offset:57344
    v_mfma_f32_16x16x32_bf16 v[88:91], v[140:143], v[192:195], v[88:91]
    ds_read_b128 v[132:135], v5 offset:58368
    buffer_load_dwordx4 v[240:243], v5, s[28:31], s85 offen offset:0 sc1
    v_mfma_f32_16x16x32_bf16 v[92:95], v[144:147], v[192:195], v[92:95]
    ds_read_b128 v[136:139], v5 offset:59392
    s_waitcnt vmcnt(11) lgkmcnt(9)
    v_mfma_f32_16x16x32_bf16 v[76:79], v[148:151], v[196:199], v[76:79]
    ds_read_b128 v[140:143], v5 offset:60416
    v_mfma_f32_16x16x32_bf16 v[80:83], v[152:155], v[196:199], v[80:83]
    ds_read_b128 v[144:147], v5 offset:61440
    buffer_load_dwordx4 v[244:247], v5, s[28:31], s85 offen offset:1024 sc1
    v_mfma_f32_16x16x32_bf16 v[84:87], v[156:159], v[196:199], v[84:87]
    ds_read_b128 v[148:151], v5 offset:62464
    v_mfma_f32_16x16x32_bf16 v[88:91], v[96:99], v[196:199], v[88:91]
    ds_read_b128 v[152:155], v5 offset:63488
    v_mfma_f32_16x16x32_bf16 v[92:95], v[100:103], v[196:199], v[92:95]
    ds_read_b128 v[156:159], v5 offset:64512
    buffer_load_dwordx4 v[248:251], v5, s[28:31], s85 offen offset:2048 sc1
    s_waitcnt vmcnt(12) lgkmcnt(9)
    v_mfma_f32_16x16x32_bf16 v[76:79], v[104:107], v[200:203], v[76:79]
    ds_read_b128 v[96:99], v12 offset:0
    v_mfma_f32_16x16x32_bf16 v[80:83], v[108:111], v[200:203], v[80:83]
    ds_read_b128 v[100:103], v12 offset:1024
    v_mfma_f32_16x16x32_bf16 v[84:87], v[112:115], v[200:203], v[84:87]
    ds_read_b128 v[104:107], v12 offset:2048
    buffer_load_dwordx4 v[252:255], v5, s[28:31], s85 offen offset:3072 sc1
    v_mfma_f32_16x16x32_bf16 v[88:91], v[116:119], v[200:203], v[88:91]
    ds_read_b128 v[108:111], v12 offset:3072
    v_mfma_f32_16x16x32_bf16 v[92:95], v[120:123], v[200:203], v[92:95]
    ds_read_b128 v[112:115], v12 offset:4096
    s_waitcnt vmcnt(12) lgkmcnt(9)
    v_mfma_f32_16x16x32_bf16 v[76:79], v[124:127], v[204:207], v[76:79]
    ds_read_b128 v[116:119], v12 offset:5120
    v_mfma_f32_16x16x32_bf16 v[80:83], v[128:131], v[204:207], v[80:83]
    ds_read_b128 v[120:123], v12 offset:6144
    v_mfma_f32_16x16x32_bf16 v[84:87], v[132:135], v[204:207], v[84:87]
    ds_read_b128 v[124:127], v12 offset:7168
    v_mfma_f32_16x16x32_bf16 v[88:91], v[136:139], v[204:207], v[88:91]
    ds_read_b128 v[128:131], v12 offset:8192
    v_mfma_f32_16x16x32_bf16 v[92:95], v[140:143], v[204:207], v[92:95]
    ds_read_b128 v[132:135], v12 offset:9216
    s_waitcnt vmcnt(11) lgkmcnt(9)
    v_mfma_f32_16x16x32_bf16 v[76:79], v[144:147], v[208:211], v[76:79]
    ds_read_b128 v[136:139], v12 offset:10240
    v_mfma_f32_16x16x32_bf16 v[80:83], v[148:151], v[208:211], v[80:83]
    ds_read_b128 v[140:143], v12 offset:11264
    v_mfma_f32_16x16x32_bf16 v[84:87], v[152:155], v[208:211], v[84:87]
    ds_read_b128 v[144:147], v12 offset:12288
    v_mfma_f32_16x16x32_bf16 v[88:91], v[156:159], v[208:211], v[88:91]
    ds_read_b128 v[148:151], v12 offset:13312
    v_mfma_f32_16x16x32_bf16 v[92:95], v[96:99], v[208:211], v[92:95]
    ds_read_b128 v[152:155], v12 offset:14336
    s_waitcnt vmcnt(10) lgkmcnt(9)
    v_mfma_f32_16x16x32_bf16 v[76:79], v[100:103], v[212:215], v[76:79]
    ds_read_b128 v[156:159], v12 offset:15360
    v_mfma_f32_16x16x32_bf16 v[80:83], v[104:107], v[212:215], v[80:83]
    ds_read_b128 v[96:99], v12 offset:16384
    v_mfma_f32_16x16x32_bf16 v[84:87], v[108:111], v[212:215], v[84:87]
    ds_read_b128 v[100:103], v12 offset:17408
    v_mfma_f32_16x16x32_bf16 v[88:91], v[112:115], v[212:215], v[88:91]
    ds_read_b128 v[104:107], v12 offset:18432
    v_mfma_f32_16x16x32_bf16 v[92:95], v[116:119], v[212:215], v[92:95]
    ds_read_b128 v[108:111], v12 offset:19456
    s_waitcnt vmcnt(9) lgkmcnt(9)
    v_mfma_f32_16x16x32_bf16 v[76:79], v[120:123], v[216:219], v[76:79]
    ds_read_b128 v[112:115], v12 offset:20480
    v_mfma_f32_16x16x32_bf16 v[80:83], v[124:127], v[216:219], v[80:83]
    ds_read_b128 v[116:119], v12 offset:21504
    v_mfma_f32_16x16x32_bf16 v[84:87], v[128:131], v[216:219], v[84:87]
    ds_read_b128 v[120:123], v12 offset:22528
    v_mfma_f32_16x16x32_bf16 v[88:91], v[132:135], v[216:219], v[88:91]
    ds_read_b128 v[124:127], v12 offset:23552
    v_mfma_f32_16x16x32_bf16 v[92:95], v[136:139], v[216:219], v[92:95]
    ds_read_b128 v[128:131], v12 offset:24576
    s_waitcnt vmcnt(8) lgkmcnt(9)
    v_mfma_f32_16x16x32_bf16 v[76:79], v[140:143], v[220:223], v[76:79]
    ds_read_b128 v[132:135], v12 offset:25600
    v_mfma_f32_16x16x32_bf16 v[80:83], v[144:147], v[220:223], v[80:83]
    ds_read_b128 v[136:139], v12 offset:26624
    v_mfma_f32_16x16x32_bf16 v[84:87], v[148:151], v[220:223], v[84:87]
    ds_read_b128 v[140:143], v12 offset:27648
    v_mfma_f32_16x16x32_bf16 v[88:91], v[152:155], v[220:223], v[88:91]
    ds_read_b128 v[144:147], v12 offset:28672
    v_mfma_f32_16x16x32_bf16 v[92:95], v[156:159], v[220:223], v[92:95]
    ds_read_b128 v[148:151], v12 offset:29696
    s_waitcnt vmcnt(7) lgkmcnt(9)
    v_mfma_f32_16x16x32_bf16 v[76:79], v[96:99], v[224:227], v[76:79]
    ds_read_b128 v[152:155], v12 offset:30720
    v_mfma_f32_16x16x32_bf16 v[80:83], v[100:103], v[224:227], v[80:83]
    ds_read_b128 v[156:159], v12 offset:31744
    v_mfma_f32_16x16x32_bf16 v[84:87], v[104:107], v[224:227], v[84:87]
    ds_read_b128 v[96:99], v12 offset:32768
    v_mfma_f32_16x16x32_bf16 v[88:91], v[108:111], v[224:227], v[88:91]
    ds_read_b128 v[100:103], v12 offset:33792
    v_mfma_f32_16x16x32_bf16 v[92:95], v[112:115], v[224:227], v[92:95]
    ds_read_b128 v[104:107], v12 offset:34816
    s_waitcnt vmcnt(6) lgkmcnt(9)
    v_mfma_f32_16x16x32_bf16 v[76:79], v[116:119], v[228:231], v[76:79]
    ds_read_b128 v[108:111], v12 offset:35840
    v_mfma_f32_16x16x32_bf16 v[80:83], v[120:123], v[228:231], v[80:83]
    ds_read_b128 v[112:115], v12 offset:36864
    v_mfma_f32_16x16x32_bf16 v[84:87], v[124:127], v[228:231], v[84:87]
    ds_read_b128 v[116:119], v12 offset:37888
    v_mfma_f32_16x16x32_bf16 v[88:91], v[128:131], v[228:231], v[88:91]
    ds_read_b128 v[120:123], v12 offset:38912
    v_mfma_f32_16x16x32_bf16 v[92:95], v[132:135], v[228:231], v[92:95]
    ds_read_b128 v[124:127], v12 offset:39936
    s_waitcnt vmcnt(5) lgkmcnt(9)
    v_mfma_f32_16x16x32_bf16 v[76:79], v[136:139], v[232:235], v[76:79]
    ds_read_b128 v[128:131], v12 offset:40960
    v_mfma_f32_16x16x32_bf16 v[80:83], v[140:143], v[232:235], v[80:83]
    ds_read_b128 v[132:135], v12 offset:41984
    v_mfma_f32_16x16x32_bf16 v[84:87], v[144:147], v[232:235], v[84:87]
    ds_read_b128 v[136:139], v12 offset:43008
    v_mfma_f32_16x16x32_bf16 v[88:91], v[148:151], v[232:235], v[88:91]
    ds_read_b128 v[140:143], v12 offset:44032
    v_mfma_f32_16x16x32_bf16 v[92:95], v[152:155], v[232:235], v[92:95]
    ds_read_b128 v[144:147], v12 offset:45056
    s_waitcnt vmcnt(4) lgkmcnt(9)
    v_mfma_f32_16x16x32_bf16 v[76:79], v[156:159], v[236:239], v[76:79]
    ds_read_b128 v[148:151], v12 offset:46080
    v_mfma_f32_16x16x32_bf16 v[80:83], v[96:99], v[236:239], v[80:83]
    ds_read_b128 v[152:155], v12 offset:47104
    v_mfma_f32_16x16x32_bf16 v[84:87], v[100:103], v[236:239], v[84:87]
    ds_read_b128 v[156:159], v12 offset:48128
    v_mfma_f32_16x16x32_bf16 v[88:91], v[104:107], v[236:239], v[88:91]
    ds_read_b128 v[96:99], v12 offset:49152
    v_mfma_f32_16x16x32_bf16 v[92:95], v[108:111], v[236:239], v[92:95]
    ds_read_b128 v[100:103], v12 offset:50176
    s_waitcnt vmcnt(3) lgkmcnt(9)
    v_mfma_f32_16x16x32_bf16 v[76:79], v[112:115], v[240:243], v[76:79]
    ds_read_b128 v[104:107], v12 offset:51200
    v_mfma_f32_16x16x32_bf16 v[80:83], v[116:119], v[240:243], v[80:83]
    ds_read_b128 v[108:111], v12 offset:52224
    v_mfma_f32_16x16x32_bf16 v[84:87], v[120:123], v[240:243], v[84:87]
    ds_read_b128 v[112:115], v12 offset:53248
    v_mfma_f32_16x16x32_bf16 v[88:91], v[124:127], v[240:243], v[88:91]
    ds_read_b128 v[116:119], v12 offset:54272
    v_mfma_f32_16x16x32_bf16 v[92:95], v[128:131], v[240:243], v[92:95]
    ds_read_b128 v[120:123], v12 offset:55296
    s_waitcnt vmcnt(2) lgkmcnt(9)
    v_mfma_f32_16x16x32_bf16 v[76:79], v[132:135], v[244:247], v[76:79]
    ds_read_b128 v[124:127], v12 offset:56320
    v_mfma_f32_16x16x32_bf16 v[80:83], v[136:139], v[244:247], v[80:83]
    v_mfma_f32_16x16x32_bf16 v[84:87], v[140:143], v[244:247], v[84:87]
    v_mfma_f32_16x16x32_bf16 v[88:91], v[144:147], v[244:247], v[88:91]
    v_mfma_f32_16x16x32_bf16 v[92:95], v[148:151], v[244:247], v[92:95]
    s_waitcnt vmcnt(1) lgkmcnt(5)
    v_mfma_f32_16x16x32_bf16 v[76:79], v[152:155], v[248:251], v[76:79]
    v_mfma_f32_16x16x32_bf16 v[80:83], v[156:159], v[248:251], v[80:83]
    v_mfma_f32_16x16x32_bf16 v[84:87], v[96:99], v[248:251], v[84:87]
    v_mfma_f32_16x16x32_bf16 v[88:91], v[100:103], v[248:251], v[88:91]
    v_mfma_f32_16x16x32_bf16 v[92:95], v[104:107], v[248:251], v[92:95]
    s_waitcnt vmcnt(0) lgkmcnt(0)
    v_mfma_f32_16x16x32_bf16 v[76:79], v[108:111], v[252:255], v[76:79]
    v_mfma_f32_16x16x32_bf16 v[80:83], v[112:115], v[252:255], v[80:83]
    v_mfma_f32_16x16x32_bf16 v[84:87], v[116:119], v[252:255], v[84:87]
    v_mfma_f32_16x16x32_bf16 v[88:91], v[120:123], v[252:255], v[88:91]
    v_mfma_f32_16x16x32_bf16 v[92:95], v[124:127], v[252:255], v[92:95]
    s_nop 3
    v_pk_fma_f32 v[76:77], v[76:77], v[56:57], v[36:37]
    v_pk_fma_f32 v[78:79], v[78:79], v[58:59], v[38:39]
    v_pk_fma_f32 v[80:81], v[80:81], v[60:61], v[40:41]
    v_pk_fma_f32 v[82:83], v[82:83], v[62:63], v[42:43]
    v_pk_fma_f32 v[84:85], v[84:85], v[64:65], v[44:45]
    v_pk_fma_f32 v[86:87], v[86:87], v[66:67], v[46:47]
    v_pk_fma_f32 v[88:89], v[88:89], v[68:69], v[48:49]
    v_pk_fma_f32 v[90:91], v[90:91], v[70:71], v[50:51]
    v_pk_fma_f32 v[92:93], v[92:93], v[72:73], v[52:53]
    v_pk_fma_f32 v[94:95], v[94:95], v[74:75], v[54:55]
    v_cvt_pk_bf16_f32 v96, v76, v77
    v_cvt_pk_bf16_f32 v97, v78, v79
    v_cvt_pk_bf16_f32 v98, v80, v81
    v_cvt_pk_bf16_f32 v99, v82, v83
    v_cvt_pk_bf16_f32 v100, v84, v85
    v_cvt_pk_bf16_f32 v101, v86, v87
    v_cvt_pk_bf16_f32 v102, v88, v89
    v_cvt_pk_bf16_f32 v103, v90, v91
    v_cvt_pk_bf16_f32 v104, v92, v93
    v_cvt_pk_bf16_f32 v105, v94, v95
    ds_write_b64 v24, v[96:97] offset:0
    ds_write_b64 v24, v[98:99] offset:32
    ds_write_b64 v24, v[100:101] offset:64
    ds_write_b64 v24, v[102:103] offset:96
    ds_write_b64 v24, v[104:105] offset:128
    s_waitcnt lgkmcnt(0)
    ds_read_b128 v[108:111], v16
    ds_read_b128 v[112:115], v17
    ds_read_b128 v[116:119], v18
    s_waitcnt lgkmcnt(2)
    buffer_store_dwordx4 v[108:111], v25, s[32:35], s47 offen
    s_waitcnt lgkmcnt(1)
    buffer_store_dwordx4 v[112:115], v26, s[32:35], s47 offen
    s_waitcnt lgkmcnt(0)
    buffer_store_dwordx4 v[116:119], v27, s[32:35], s47 offen
L_fin:
L_end:
    s_endpgm
L_wm_1:
    buffer_load_dwordx4 v[216:219], v35, s[36:39], s70 offen
    s_add_u32 s70, s70, 7680
    buffer_load_dwordx4 v[220:223], v35, s[36:39], s70 offen
    s_add_u32 s70, s70, 7680
    buffer_load_dwordx4 v[224:227], v35, s[36:39], s70 offen
    s_add_u32 s70, s70, 7680
    buffer_load_dwordx4 v[228:231], v35, s[36:39], s70 offen
    s_add_u32 s70, s70, 7680
    buffer_load_dwordx4 v[232:235], v35, s[36:39], s70 offen
    s_add_u32 s70, s70, 7680
    buffer_load_dwordx4 v[236:239], v35, s[36:39], s70 offen
    s_add_u32 s70, s70, 7680
    buffer_load_dwordx4 v[240:243], v35, s[36:39], s70 offen
    s_add_u32 s70, s70, 7680
    buffer_load_dwordx4 v[244:247], v35, s[36:39], s70 offen
    s_add_u32 s70, s70, 7680
    buffer_load_dwordx4 v[248:251], v35, s[36:39], s70 offen
    s_add_u32 s70, s70, 7680
    buffer_load_dwordx4 v[252:255], v35, s[36:39], s70 offen
    s_branch L_wmb_2
L_roleA_3:
    s_waitcnt vmcnt(13)
    v_lshlrev_b32 v190, 16, v208
    v_and_b32 v191, 0xffff0000, v208
    v_lshlrev_b32 v192, 16, v209
    v_and_b32 v193, 0xffff0000, v209
    v_lshlrev_b32 v194, 16, v210
    v_and_b32 v195, 0xffff0000, v210
    v_lshlrev_b32 v196, 16, v211
    v_and_b32 v197, 0xffff0000, v211
    v_lshlrev_b32 v198, 16, v212
    v_and_b32 v199, 0xffff0000, v212
    v_mul_f32 v180, 0xbfb8aa3b, v190
    v_mul_f32 v181, 0xbfb8aa3b, v191
    v_mul_f32 v182, 0xbfb8aa3b, v192
    v_mul_f32 v183, 0xbfb8aa3b, v193
    v_mul_f32 v184, 0xbfb8aa3b, v194
    v_mul_f32 v185, 0xbfb8aa3b, v195
    v_mul_f32 v186, 0xbfb8aa3b, v196
    v_mul_f32 v187, 0xbfb8aa3b, v197
    v_mul_f32 v188, 0xbfb8aa3b, v198
    v_mul_f32 v189, 0xbfb8aa3b, v199
    v_exp_f32 v180, v180
    v_exp_f32 v181, v181
    v_exp_f32 v182, v182
    v_exp_f32 v183, v183
    v_exp_f32 v184, v184
    v_exp_f32 v185, v185
    v_exp_f32 v186, v186
    v_exp_f32 v187, v187
    v_exp_f32 v188, v188
    v_exp_f32 v189, v189
    v_add_f32 v180, 1.0, v180
    v_add_f32 v181, 1.0, v181
    v_add_f32 v182, 1.0, v182
    v_add_f32 v183, 1.0, v183
    v_add_f32 v184, 1.0, v184
    v_add_f32 v185, 1.0, v185
    v_add_f32 v186, 1.0, v186
    v_add_f32 v187, 1.0, v187
    v_add_f32 v188, 1.0, v188
    v_add_f32 v189, 1.0, v189
    v_rcp_f32 v180, v180
    v_rcp_f32 v181, v181
    v_rcp_f32 v182, v182
    v_rcp_f32 v183, v183
    v_rcp_f32 v184, v184
    v_rcp_f32 v185, v185
    v_rcp_f32 v186, v186
    v_rcp_f32 v187, v187
    v_rcp_f32 v188, v188
    v_rcp_f32 v189, v189
    v_mul_f32 v190, v190, v180
    v_mul_f32 v191, v191, v181
    v_mul_f32 v192, v192, v182
    v_mul_f32 v193, v193, v183
    v_mul_f32 v194, v194, v184
    v_mul_f32 v195, v195, v185
    v_mul_f32 v196, v196, v186
    v_mul_f32 v197, v197, v187
    v_mul_f32 v198, v198, v188
    v_mul_f32 v199, v199, v189
    v_cvt_pk_bf16_f32 v180, v190, v191
    v_cvt_pk_bf16_f32 v181, v192, v193
    v_cvt_pk_bf16_f32 v182, v194, v195
    v_cvt_pk_bf16_f32 v183, v196, v197
    v_cvt_pk_bf16_f32 v184, v198, v199
    s_mov_b32 s88, 0x05040100
    s_mov_b32 s89, 0x07060302
    s_waitcnt vmcnt(11)
    v_perm_b32 v6, v220, v216, s88
    v_perm_b32 v7, v220, v216, s89
    v_dot2_f32_bf16 v190, v6, v180, 0
    v_dot2_f32_bf16 v191, v7, v180, 0
    v_perm_b32 v8, v221, v217, s88
    v_perm_b32 v9, v221, v217, s89
    s_add_u32 m0, s52, 0
    s_nop 0
    buffer_load_dwordx4 v205, s[4:7], s55 offen lds
    v_dot2_f32_bf16 v192, v8, v180, 0
    v_dot2_f32_bf16 v193, v9, v180, 0
    v_perm_b32 v6, v222, v218, s88
    v_perm_b32 v7, v222, v218, s89
    v_dot2_f32_bf16 v194, v6, v180, 0
    v_dot2_f32_bf16 v195, v7, v180, 0
    buffer_load_dwordx4 v206, s[4:7], s55 offen offset:1024 lds
    v_perm_b32 v8, v223, v219, s88
    v_perm_b32 v9, v223, v219, s89
    v_dot2_f32_bf16 v196, v8, v180, 0
    v_dot2_f32_bf16 v197, v9, v180, 0
    s_waitcnt vmcnt(11)
    v_perm_b32 v6, v228, v224, s88
    v_perm_b32 v7, v228, v224, s89
    s_add_u32 m0, s52, 2048
    s_add_u32 s55, s55, 128
    buffer_load_dwordx4 v205, s[4:7], s55 offen lds
    v_dot2_f32_bf16 v190, v6, v181, v190
    v_dot2_f32_bf16 v191, v7, v181, v191
    v_perm_b32 v8, v229, v225, s88
    v_perm_b32 v9, v229, v225, s89
    v_dot2_f32_bf16 v192, v8, v181, v192
    v_dot2_f32_bf16 v193, v9, v181, v193
    buffer_load_dwordx4 v206, s[4:7], s55 offen offset:1024 lds
    v_perm_b32 v6, v230, v226, s88
    v_perm_b32 v7, v230, v226, s89
    v_dot2_f32_bf16 v194, v6, v181, v194
    v_dot2_f32_bf16 v195, v7, v181, v195
    v_perm_b32 v8, v231, v227, s88
    v_perm_b32 v9, v231, v227, s89
    s_add_u32 m0, s52, 4096
    s_add_u32 s55, s55, 128
    buffer_load_dwordx4 v205, s[4:7], s55 offen lds
    v_dot2_f32_bf16 v196, v8, v181, v196
    v_dot2_f32_bf16 v197, v9, v181, v197
    s_waitcnt vmcnt(12)
    v_perm_b32 v6, v236, v232, s88
    v_perm_b32 v7, v236, v232, s89
    v_dot2_f32_bf16 v190, v6, v182, v190
    v_dot2_f32_bf16 v191, v7, v182, v191
    buffer_load_dwordx4 v206, s[4:7], s55 offen offset:1024 lds
    v_perm_b32 v8, v237, v233, s88
    v_perm_b32 v9, v237, v233, s89
    v_dot2_f32_bf16 v192, v8, v182, v192
    v_dot2_f32_bf16 v193, v9, v182, v193
    v_perm_b32 v6, v238, v234, s88
    v_perm_b32 v7, v238, v234, s89
    s_add_u32 m0, s52, 6144
    s_add_u32 s55, s55, 128
    buffer_load_dwordx4 v205, s[4:7], s55 offen lds
    v_dot2_f32_bf16 v194, v6, v182, v194
    v_dot2_f32_bf16 v195, v7, v182, v195
    v_perm_b32 v8, v239, v235, s88
    v_perm_b32 v9, v239, v235, s89
    v_dot2_f32_bf16 v196, v8, v182, v196
    v_dot2_f32_bf16 v197, v9, v182, v197
    buffer_load_dwordx4 v206, s[4:7], s55 offen offset:1024 lds
    s_waitcnt vmcnt(13)
    v_perm_b32 v6, v244, v240, s88
    v_perm_b32 v7, v244, v240, s89
    v_dot2_f32_bf16 v190, v6, v183, v190
    v_dot2_f32_bf16 v191, v7, v183, v191
    v_perm_b32 v8, v245, v241, s88
    v_perm_b32 v9, v245, v241, s89
    s_add_u32 m0, s52, 8192
    s_add_u32 s55, s55, 128
    buffer_load_dwordx4 v205, s[4:7], s55 offen lds
    v_dot2_f32_bf16 v192, v8, v183, v192
    v_dot2_f32_bf16 v193, v9, v183, v193
    v_perm_b32 v6, v246, v242, s88
    v_perm_b32 v7, v246, v242, s89
    v_dot2_f32_bf16 v194, v6, v183, v194
    v_dot2_f32_bf16 v195, v7, v183, v195
    buffer_load_dwordx4 v206, s[4:7], s55 offen offset:1024 lds
    v_perm_b32 v8, v247, v243, s88
    v_perm_b32 v9, v247, v243, s89
    v_dot2_f32_bf16 v196, v8, v183, v196
    v_dot2_f32_bf16 v197, v9, v183, v197
    s_waitcnt vmcnt(13)
    v_perm_b32 v6, v252, v248, s88
    v_perm_b32 v7, v252, v248, s89
    s_add_u32 m0, s52, 10240
    s_add_u32 s55, s55, 128
    buffer_load_dwordx4 v205, s[4:7], s55 offen lds
    v_dot2_f32_bf16 v190, v6, v184, v190
    v_dot2_f32_bf16 v191, v7, v184, v191
    v_perm_b32 v8, v253, v249, s88
    v_perm_b32 v9, v253, v249, s89
    v_dot2_f32_bf16 v192, v8, v184, v192
    v_dot2_f32_bf16 v193, v9, v184, v193
    buffer_load_dwordx4 v206, s[4:7], s55 offen offset:1024 lds
    v_perm_b32 v6, v254, v250, s88
    v_perm_b32 v7, v254, v250, s89
    v_dot2_f32_bf16 v194, v6, v184, v194
    v_dot2_f32_bf16 v195, v7, v184, v195
    v_perm_b32 v8, v255, v251, s88
    v_perm_b32 v9, v255, v251, s89
    s_add_u32 m0, s52, 12288
    s_add_u32 s55, s55, 128
    buffer_load_dwordx4 v205, s[4:7], s55 offen lds
    v_dot2_f32_bf16 v196, v8, v184, v196
    v_dot2_f32_bf16 v197, v9, v184, v197
    v_and_b32 v6, 8, v1
    v_cmp_ne_u32 vcc, 0, v6
    v_lshlrev_b32 v6, 2, v0
    v_add_u32 v6, 160896, v6
    buffer_load_dwordx4 v206, s[4:7], s55 offen offset:1024 lds
    v_permlane32_swap_b32 v190, v191
    v_permlane32_swap_b32 v192, v193
    v_permlane32_swap_b32 v194, v195
    v_permlane32_swap_b32 v196, v197
    v_add_f32 v190, v190, v191
    v_add_f32 v192, v192, v193
    s_add_u32 m0, s52, 14336
    s_add_u32 s55, s55, 128
    buffer_load_dwordx4 v205, s[4:7], s55 offen lds
    v_add_f32 v194, v194, v195
    v_add_f32 v196, v196, v197
    v_permlane16_swap_b32 v190, v192
    s_nop 0
    v_permlane16_swap_b32 v194, v196
    v_add_f32 v190, v190, v192
    v_add_f32 v194, v194, v196
    buffer_load_dwordx4 v206, s[4:7], s55 offen offset:1024 lds
    v_cndmask_b32 v7, v194, v190, vcc
    v_cndmask_b32 v8, v190, v194, vcc
    s_nop 1
    v_add_f32_dpp v8, v7, v8 row_ror:8 row_mask:0xf bank_mask:0xf
    ds_write_b32 v6, v8
    s_waitcnt vmcnt(17)
    v_readfirstlane_b32 s88, v207
    s_nop 0
    s_mul_i32 s83, s88, 0x9E3779B1
    s_add_u32 s83, s83, 0x7F4A7C15
    s_waitcnt lgkmcnt(0)
    s_barrier
    s_cmp_lg_u32 s82, 0
    s_cbranch_scc1 L_roleA2_5
    v_lshlrev_b32 v194, 2, v1
    v_add_u32 v194, 160896, v194
    ds_read_b32 v190, v194 offset:0
    ds_read_b32 v191, v194 offset:256
    ds_read_b32 v192, v194 offset:512
    ds_read_b32 v193, v194 offset:768
    v_and_b32 v195, 7, v1
    v_lshlrev_b32 v195, 3, v195
    v_bfe_u32 v196, v1, 5, 1
    v_or_b32 v195, v195, v196
    v_bfe_u32 v196, v1, 4, 1
    v_lshl_or_b32 v195, v196, 1, v195
    v_bfe_u32 v196, v1, 3, 1
    v_lshl_or_b32 v195, v196, 2, v195
    v_lshlrev_b32 v195, 4, v195
    v_mov_b32 v197, s83
    s_lshl_b32 s88, s61, 10
    s_mul_i32 s89, s60, 8
    s_add_u32 s88, s88, s89
    s_add_u32 s88, s88, 8192
    s_waitcnt lgkmcnt(0)
    v_add_f32 v190, v190, v191
    v_add_f32 v192, v192, v193
    v_add_f32 v196, v190, v192
    buffer_store_dwordx2 v[196:197], v195, s[28:31], s88 offen sc1
    v_mov_b32 v8, s3
    v_mov_b32 v9, s83
    s_lshl_b32 s88, s2, 3
    s_add_u32 s88, s88, 4096
    s_mov_b64 exec, 1
    buffer_store_dwordx2 v[8:9], off, s[28:31], s88 sc1
    s_mov_b64 exec, -1
L_roleA2_5:
    s_add_u32 m0, s52, 16384
    s_add_u32 s55, s55, 128
    buffer_load_dwordx4 v205, s[4:7], s55 offen lds
    buffer_load_dwordx4 v206, s[4:7], s55 offen offset:1024 lds
    s_add_u32 m0, s52, 18432
    s_add_u32 s55, s55, 128
    buffer_load_dwordx4 v205, s[4:7], s55 offen lds
    buffer_load_dwordx4 v206, s[4:7], s55 offen offset:1024 lds
    buffer_load_dword v80, v56, s[44:47], s59 offen offset:0
    buffer_load_dword v81, v56, s[44:47], s59 offen offset:1024
    buffer_load_dword v82, v56, s[44:47], s59 offen offset:2048
    buffer_load_dword v83, v57, s[44:47], s59 offen offset:3072
    buffer_load_ushort v13, v58, s[48:51], s56 offen
    s_mov_b32 s95, 3840
    v_add_u32 v6, 0, v1
    v_mul_u32_u24 v7, 6554, v6
    v_lshrrev_b32 v7, 16, v7
    v_mul_u32_u24 v8, 160, v7
    v_lshlrev_b32 v6, 4, v6
    v_sub_u32 v6, v6, v8
    v_and_b32 v8, 12, v7
    v_add_u32 v8, v8, v7
    v_lshrrev_b32 v7, 4, v7
    v_mul_u32_u24 v7, 12, v7
    v_sub_u32 v7, v8, v7
    v_mad_u32_u24 v24, v7, s95, v6
    v_add_u32 v6, 64, v1
    v_mul_u32_u24 v7, 6554, v6
    v_lshrrev_b32 v7, 16, v7
    v_mul_u32_u24 v8, 160, v7
    v_lshlrev_b32 v6, 4, v6
    v_sub_u32 v6, v6, v8
    v_and_b32 v8, 12, v7
    v_add_u32 v8, v8, v7
    v_lshrrev_b32 v7, 4, v7
    v_mul_u32_u24 v7, 12, v7
    v_sub_u32 v7, v8, v7
    v_mad_u32_u24 v25, v7, s95, v6
    v_subrev_u32 v25, 1024, v25
    v_add_u32 v6, 128, v1
    v_mul_u32_u24 v7, 6554, v6
    v_lshrrev_b32 v7, 16, v7
    v_mul_u32_u24 v8, 160, v7
    v_lshlrev_b32 v6, 4, v6
    v_sub_u32 v6, v6, v8
    v_and_b32 v8, 12, v7
    v_add_u32 v8, v8, v7
    v_lshrrev_b32 v7, 4, v7
    v_mul_u32_u24 v7, 12, v7
    v_sub_u32 v7, v8, v7
    v_mad_u32_u24 v26, v7, s95, v6
    v_subrev_u32 v26, 2048, v26
    v_add_u32 v6, 192, v1
    v_mul_u32_u24 v7, 6554, v6
    v_lshrrev_b32 v7, 16, v7
    v_mul_u32_u24 v8, 160, v7
    v_lshlrev_b32 v6, 4, v6
    v_sub_u32 v6, v6, v8
    v_and_b32 v8, 12, v7
    v_add_u32 v8, v8, v7
    v_lshrrev_b32 v7, 4, v7
    v_mul_u32_u24 v7, 12, v7
    v_sub_u32 v7, v8, v7
    v_mad_u32_u24 v27, v7, s95, v6
    v_subrev_u32 v27, 3072, v27
    v_add_u32 v6, 256, v1
    v_mul_u32_u24 v7, 6554, v6
    v_lshrrev_b32 v7, 16, v7
    v_mul_u32_u24 v8, 160, v7
    v_lshlrev_b32 v6, 4, v6
    v_sub_u32 v6, v6, v8
    v_and_b32 v8, 12, v7
    v_add_u32 v8, v8, v7
    v_lshrrev_b32 v7, 4, v7
    v_mul_u32_u24 v7, 12, v7
    v_sub_u32 v7, v8, v7
    v_mad_u32_u24 v28, v7, s95, v6
    s_lshr_b32 s88, s82, 1
    s_mul_i32 s88, s88, 122880
    s_and_b32 s89, s82, 1
    s_add_u32 s89, s89, 1
    s_mul_i32 s89, s89, 1280
    s_add_u32 s88, s88, s89
    s_mul_i32 s89, s81, 160
    s_add_u32 s53, s88, s89
    s_add_u32 s57, s53, 737280
    v_add_u32 v6, 0, v0
    v_mul_u32_u24 v7, 6554, v6
    v_lshrrev_b32 v7, 16, v7
    v_mul_u32_u24 v8, 10, v7
    v_sub_u32 v8, v6, v8
    v_mul_u32_u24 v9, 205, v7
    v_lshrrev_b32 v9, 12, v9
    v_mul_u32_u24 v10, 20, v9
    v_sub_u32 v7, v7, v10
    v_lshl_add_u32 v10, v8, 1, v10
    v_mul_u32_u24 v10, 48, v10
    v_lshl_add_u32 v10, v7, 1, v10
    v_add_u32 v84, 155648, v10
    v_add_u32 v6, 256, v0
    v_mul_u32_u24 v7, 6554, v6
    v_lshrrev_b32 v7, 16, v7
    v_mul_u32_u24 v8, 10, v7
    v_sub_u32 v8, v6, v8
    v_mul_u32_u24 v9, 205, v7
    v_lshrrev_b32 v9, 12, v9
    v_mul_u32_u24 v10, 20, v9
    v_sub_u32 v7, v7, v10
    v_lshl_add_u32 v10, v8, 1, v10
    v_mul_u32_u24 v10, 48, v10
    v_lshl_add_u32 v10, v7, 1, v10
    v_add_u32 v85, 155648, v10
    v_add_u32 v6, 512, v0
    v_mul_u32_u24 v7, 6554, v6
    v_lshrrev_b32 v7, 16, v7
    v_mul_u32_u24 v8, 10, v7
    v_sub_u32 v8, v6, v8
    v_mul_u32_u24 v9, 205, v7
    v_lshrrev_b32 v9, 12, v9
    v_mul_u32_u24 v10, 20, v9
    v_sub_u32 v7, v7, v10
    v_lshl_add_u32 v10, v8, 1, v10
    v_mul_u32_u24 v10, 48, v10
    v_lshl_add_u32 v10, v7, 1, v10
    v_add_u32 v86, 155648, v10
    v_min_u32 v6, 31, v0
    v_add_u32 v6, 768, v6
    v_mul_u32_u24 v7, 6554, v6
    v_lshrrev_b32 v7, 16, v7
    v_mul_u32_u24 v8, 10, v7
    v_sub_u32 v8, v6, v8
    v_mul_u32_u24 v9, 205, v7
    v_lshrrev_b32 v9, 12, v9
    v_mul_u32_u24 v10, 20, v9
    v_sub_u32 v7, v7, v10
    v_lshl_add_u32 v10, v8, 1, v10
    v_mul_u32_u24 v10, 48, v10
    v_lshl_add_u32 v10, v7, 1, v10
    v_add_u32 v87, 155648, v10
    v_lshrrev_b32 v6, 1, v2
    v_and_b32 v7, 7, v2
    v_lshl_add_u32 v6, v7, 3, v6
    v_lshlrev_b32 v6, 4, v6
    v_lshrrev_b32 v7, 3, v2
    v_lshl_add_u32 v6, v7, 10, v6
    v_add_u32 v6, s52, v6
    v_lshlrev_b32 v7, 4, v3
    v_xor_b32 v93, v6, v7
    v_xor_b32 v94, 64, v93
    v_lshrrev_b32 v7, 1, v3
    v_lshlrev_b32 v7, 4, v7
    v_xor_b32 v6, v6, v7
    v_and_b32 v7, 1, v3
    v_lshl_add_u32 v92, v7, 3, v6
    s_mul_i32 s88, s81, 160
    s_and_b32 s89, s88, 0x60
    s_lshr_b32 s90, s88, 7
    s_lshl_b32 s90, s90, 11
    v_xor_b32 v72, s89, v92
    s_add_u32 s88, s88, 32
    v_add_u32 v72, s90, v72
    s_and_b32 s89, s88, 0x60
    s_lshr_b32 s90, s88, 7
    s_lshl_b32 s90, s90, 11
    v_xor_b32 v73, s89, v92
    s_add_u32 s88, s88, 32
    v_add_u32 v73, s90, v73
    s_and_b32 s89, s88, 0x60
    s_lshr_b32 s90, s88, 7
    s_lshl_b32 s90, s90, 11
    v_xor_b32 v74, s89, v92
    s_add_u32 s88, s88, 32
    v_add_u32 v74, s90, v74
    s_and_b32 s89, s88, 0x60
    s_lshr_b32 s90, s88, 7
    s_lshl_b32 s90, s90, 11
    v_xor_b32 v75, s89, v92
    s_add_u32 s88, s88, 32
    v_add_u32 v75, s90, v75
    s_and_b32 s89, s88, 0x60
    s_lshr_b32 s90, s88, 7
    s_lshl_b32 s90, s90, 11
    v_xor_b32 v76, s89, v92
    s_add_u32 s88, s88, 32
    v_add_u32 v76, s90, v76
    v_bfe_u32 v6, v1, 2, 2
    v_lshl_add_u32 v6, v3, 2, v6
    v_mul_u32_u24 v6, 160, v6
    v_and_b32 v7, 3, v1
    v_mul_u32_u24 v7, 40, v7
    v_add_u32 v29, v6, v7
    v_add_u32 v30, 0x10000, v29
    v_add_u32 v31, 0x20000, v29
    v_lshlrev_b32 v34, 5, v3
    v_add_u32 v34, 143360, v34
    s_lshl_b32 s89, s82, 3
    s_add_u32 s89, s89, s81
    s_lshl_b32 s89, s89, 7
    v_lshl_add_u32 v6, v2, 12, s89
    v_cmp_gt_u32 vcc, 16, v1
    v_mov_b32 v7, 1073741824
    s_nop 0
    v_cndmask_b32 v33, v7, v6, vcc
    v_lshlrev_b32 v88, 4, v0
    v_and_b32 v89, 127, v0
    v_lshlrev_b32 v89, 4, v89
    v_and_b32 v6, 7, v1
    s_and_b32 s88, s80, 3
    s_lshl_b32 s88, s88, 6
    s_lshr_b32 s89, s80, 2
    s_add_u32 s88, s88, s89
    v_lshl_add_u32 v6, v6, 3, s88
    v_lshlrev_b32 v90, 3, v6
    v_lshlrev_b32 v91, 2, v0
    v_add_u32 v91, 143360, v91
    s_branch L_nb0_4
L_uq_10:
    s_sub_u32 s88, s88, 672
    s_mul_i32 s89, s88, 3277
    s_lshr_b32 s89, s89, 16
    s_mul_i32 s91, s89, 20
    s_sub_u32 s91, s88, s91
    s_mul_i32 s67, s88, 5120
    s_add_u32 s67, s67, 21594112
    s_mul_i32 s68, s91, 122880
    s_mul_i32 s89, s89, 160
    s_add_u32 s68, s68, s89
    s_mov_b32 s64, 10
    s_mov_b32 s65, 6554
    s_mov_b32 s66, 0
    s_mov_b32 s63, 3
    s_mov_b32 s69, 3840
    s_mov_b32 s58, 1
    s_mov_b64 s[40:41], s[8:9]
    s_mov_b32 s42, 2457600
    s_branch L_udec_9
L_u0_11:
    s_waitcnt vmcnt(0)
    s_branch L_u1_12
L_qrd_13:
    ds_read_b64_tr_b16 a[120:121], v78 offset:0
    ds_read_b64_tr_b16 a[122:123], v79 offset:0
    ds_read_b64_tr_b16 a[124:125], v78 offset:8
    ds_read_b64_tr_b16 a[126:127], v79 offset:8
    ds_read_b64_tr_b16 a[128:129], v78 offset:16
    ds_read_b64_tr_b16 a[130:131], v79 offset:16
    ds_read_b64_tr_b16 a[132:133], v78 offset:24
    ds_read_b64_tr_b16 a[134:135], v79 offset:24
    ds_read_b64_tr_b16 a[136:137], v78 offset:32
    ds_read_b64_tr_b16 a[138:139], v79 offset:32
    ds_read_b64_tr_b16 a[140:141], v78 offset:40
    ds_read_b64_tr_b16 a[142:143], v79 offset:40
    s_branch L_qrdb_14
L_retry_15:
    s_add_u32 s84, s84, 1
    s_cmp_ge_u32 s84, 524288
    s_cbranch_scc1 L_end
    buffer_load_dwordx4 v[40:43], v88, s[28:31], s90 offen sc1
    buffer_load_dwordx4 v[44:47], v88, s[28:31], s91 offen sc1
    buffer_load_dwordx4 v[48:51], v88, s[28:31], s92 offen sc1
    buffer_load_dwordx4 v[52:55], v88, s[28:31], s93 offen sc1
    buffer_load_dwordx4 v[56:59], v88, s[28:31], s94 offen sc1
    buffer_load_dwordx4 v[60:63], v89, s[28:31], s95 offen sc1
    buffer_load_dwordx2 v[64:65], v90, s[28:31], s95 offen sc1
    s_waitcnt vmcnt(0)
    v_min3_u32 v6, v41, v43, v45
    v_min3_u32 v6, v6, v47, v49
    v_min3_u32 v6, v6, v51, v53
    v_min3_u32 v6, v6, v55, v57
    v_min3_u32 v6, v6, v59, v61
    v_min3_u32 v6, v6, v63, v65
    v_max3_u32 v7, v41, v43, v45
    v_max3_u32 v7, v7, v47, v49
    v_max3_u32 v7, v7, v51, v53
    v_max3_u32 v7, v7, v55, v57
    v_max3_u32 v7, v7, v59, v61
    v_max3_u32 v7, v7, v63, v65
    v_cmp_ne_u32 vcc, s83, v6
    v_cmp_ne_u32 s[88:89], s83, v7
    s_nop 0
    s_or_b64 vcc, vcc, s[88:89]
    s_cmp_lg_u64 vcc, 0
    s_cbranch_scc1 L_retry_15
    s_branch L_ok_16
L_ep_17:
    v_mov_b32 v6, s83
    s_mov_b64 exec, 1
    buffer_store_dword v6, off, s[28:31], 0 sc1
    s_mov_b64 exec, -1
    s_branch L_epb_18
L_r2_19:
    v_mov_b32 v6, s83
    v_mov_b32 v7, s83
    s_lshl_b32 s88, s2, 3
    s_add_u32 s88, s88, 6144
    s_mov_b64 exec, 1
    buffer_store_dwordx2 v[6:7], off, s[28:31], s88 sc1
    s_mov_b64 exec, -1
    s_branch L_r2b_20
L_retry_21:
    s_add_u32 s84, s84, 1
    s_cmp_ge_u32 s84, 524288
    s_cbranch_scc1 L_end
    buffer_load_dwordx4 v[176:179], v5, s[28:31], s73 offen offset:0 sc1
    buffer_load_dwordx4 v[180:183], v5, s[28:31], s73 offen offset:1024 sc1
    s_waitcnt vmcnt(0)
    v_min3_u32 v6, v176, v178, v180
    v_min_u32 v6, v6, v182
    v_max3_u32 v7, v176, v178, v180
    v_max_u32 v7, v7, v182
    v_cmp_ne_u32 vcc, s83, v6
    v_cmp_ne_u32 s[92:93], s83, v7
    s_nop 0
    s_or_b64 vcc, vcc, s[92:93]
    s_cmp_lg_u64 vcc, 0
    s_cbranch_scc1 L_retry_21
    s_branch L_ok_22
L_retry_23:
    s_add_u32 s84, s84, 1
    s_cmp_ge_u32 s84, 524288
    s_cbranch_scc1 L_end
    buffer_load_dwordx4 v[204:207], v184, s[28:31], s69 offen offset:0 sc1
    buffer_load_dwordx4 v[208:211], v184, s[28:31], s69 offen offset:512 sc1
    buffer_load_dwordx4 v[212:215], v184, s[28:31], s69 offen offset:1024 sc1
    buffer_load_dwordx4 v[216:219], v184, s[28:31], s69 offen offset:1536 sc1
    s_waitcnt vmcnt(0)
    v_xor_b32 v6, v204, v244
    v_bitop3_b32 v6, v205, v245, v6 bitop3:0xbe
    v_bitop3_b32 v6, v206, v246, v6 bitop3:0xbe
    v_bitop3_b32 v6, v207, v247, v6 bitop3:0xbe
    v_bitop3_b32 v6, v208, v244, v6 bitop3:0xbe
    v_bitop3_b32 v6, v209, v245, v6 bitop3:0xbe
    v_bitop3_b32 v6, v210, v246, v6 bitop3:0xbe
    v_bitop3_b32 v6, v211, v247, v6 bitop3:0xbe
    v_bitop3_b32 v6, v212, v244, v6 bitop3:0xbe
    v_bitop3_b32 v6, v213, v245, v6 bitop3:0xbe
    v_bitop3_b32 v6, v214, v246, v6 bitop3:0xbe
    v_bitop3_b32 v6, v215, v247, v6 bitop3:0xbe
    v_bitop3_b32 v6, v216, v244, v6 bitop3:0xbe
    v_bitop3_b32 v6, v217, v245, v6 bitop3:0xbe
    v_bitop3_b32 v6, v218, v246, v6 bitop3:0xbe
    v_bitop3_b32 v6, v219, v247, v6 bitop3:0xbe
    v_and_b32 v6, 0xff, v6
    v_cmp_ne_u32 vcc, 0, v6
    s_nop 0
    s_cmp_lg_u64 vcc, 0
    s_cbranch_scc1 L_retry_23
    s_branch L_ok_24
L_bpub_25:
    v_lshlrev_b32 v180, 2, v1
    v_add_u32 v180, 160896, v180
    ds_read_b32 v176, v180 offset:0
    ds_read_b32 v177, v180 offset:256
    ds_read_b32 v178, v180 offset:512
    ds_read_b32 v179, v180 offset:768
    v_and_b32 v181, 7, v1
    v_lshlrev_b32 v181, 3, v181
    v_bfe_u32 v182, v1, 5, 1
    v_or_b32 v181, v181, v182
    v_bfe_u32 v182, v1, 4, 1
    v_lshl_or_b32 v181, v182, 1, v181
    v_bfe_u32 v182, v1, 3, 1
    v_lshl_or_b32 v181, v182, 2, v181
    v_lshlrev_b32 v181, 3, v181
    v_mov_b32 v183, s83
    s_lshl_b32 s88, s61, 9
    s_mul_i32 s89, s60, 20480
    s_add_u32 s88, s88, s89
    s_add_u32 s88, s88, 514048
    s_waitcnt lgkmcnt(0)
    v_add_f32 v176, v176, v177
    v_add_f32 v178, v178, v179
    v_add_f32 v182, v176, v178
    buffer_store_dwordx2 v[182:183], v181, s[28:31], s88 offen sc1
    s_branch L_bpubb_26
L_retry_27:
    s_add_u32 s84, s84, 1
    s_cmp_ge_u32 s84, 524288
    s_cbranch_scc1 L_end
    buffer_load_dwordx2 v[148:149], v92, s[28:31], s6 offen sc1
    buffer_load_dwordx2 v[150:151], v93, s[28:31], s6 offen sc1
    buffer_load_dwordx2 v[152:153], v94, s[28:31], s6 offen sc1
    buffer_load_dwordx2 v[154:155], v95, s[28:31], s6 offen sc1
    s_waitcnt vmcnt(0)
    v_max3_u32 v6, v148, v149, v150
    v_max3_u32 v6, v6, v151, v152
    v_max3_u32 v6, v6, v153, v154
    v_max_u32 v6, v6, v155
    v_cmp_eq_u32 vcc, -1, v6
    s_nop 0
    s_cmp_lg_u64 vcc, 0
    s_cbranch_scc1 L_retry_27
    s_branch L_ok_28
L_far_29:
    buffer_store_dwordx4 v[244:247], v5, s[28:31], s7 offen sc1
    buffer_store_dwordx4 v[248:251], v5, s[28:31], s7 offen offset:1024 sc1
    buffer_store_dwordx2 v[252:253], v5, s[28:31], s12 offen sc1
    s_branch L_st_30
L_far_31:
    buffer_store_dword v6, off, s[28:31], s16 sc1
    s_branch L_st_32
L_retry_33:
    s_add_u32 s84, s84, 1
    s_cmp_ge_u32 s84, 524288
    s_cbranch_scc1 L_end
    buffer_load_dword v6, v28, s[28:31], s15 offen sc1
    s_waitcnt vmcnt(0)
    v_cmp_ne_u32 vcc, s83, v6
    s_nop 0
    s_cmp_lg_u64 vcc, 0
    s_cbranch_scc1 L_retry_33
    s_branch L_ok_34
L_retry_35:
    s_add_u32 s84, s84, 1
    s_cmp_ge_u32 s84, 524288
    s_cbranch_scc1 L_end
    buffer_load_dwordx4 v[16:19], v88, s[28:31], s17 offen sc1
    buffer_load_dwordx4 v[20:23], v88, s[28:31], s18 offen sc1
    buffer_load_dwordx4 v[80:83], v88, s[28:31], s19 offen sc1
    buffer_load_dwordx4 v[84:87], v88, s[28:31], s24 offen sc1
    buffer_load_dwordx4 v[96:99], v88, s[28:31], s25 offen sc1
    s_waitcnt vmcnt(0)
    v_min3_u32 v6, v17, v19, v21
    v_min3_u32 v6, v6, v23, v81
    v_min3_u32 v6, v6, v83, v85
    v_min3_u32 v6, v6, v87, v97
    v_min_u32 v6, v6, v99
    v_max3_u32 v7, v17, v19, v21
    v_max3_u32 v7, v7, v23, v81
    v_max3_u32 v7, v7, v83, v85
    v_max3_u32 v7, v7, v87, v97
    v_max_u32 v7, v7, v99
    v_cmp_ne_u32 vcc, s83, v6
    v_cmp_ne_u32 s[70:71], s83, v7
    s_nop 0
    s_or_b64 vcc, vcc, s[70:71]
    s_cmp_lg_u64 vcc, 0
    s_cbranch_scc1 L_retry_35
    s_branch L_ok_36
L_far_37:
    buffer_store_dword v6, v93, s[28:31], s26 offen sc1
    s_branch L_st_38
L_retry_39:
    s_add_u32 s84, s84, 1
    s_cmp_ge_u32 s84, 524288
    s_cbranch_scc1 L_end
    buffer_load_dword v76, v94, s[28:31], s27 offen offset:0 sc1
    buffer_load_dword v77, v94, s[28:31], s27 offen offset:64 sc1
    buffer_load_dword v78, v94, s[28:31], s27 offen offset:128 sc1
    buffer_load_dword v79, v94, s[28:31], s27 offen offset:192 sc1
    s_waitcnt vmcnt(0)
    v_max3_u32 v6, v76, v77, v78
    v_max_u32 v6, v6, v79
    v_cmp_eq_u32 vcc, -1, v6
    s_nop 0
    s_cmp_lg_u64 vcc, 0
    s_cbranch_scc1 L_retry_39
    s_branch L_ok_40
L_far_41:
    buffer_store_dwordx4 v[132:135], v5, s[28:31], s7 offen sc1
    buffer_store_dwordx4 v[136:139], v5, s[28:31], s7 offen offset:1024 sc1
    buffer_store_dwordx2 v[140:141], v5, s[28:31], s12 offen sc1
    s_branch L_st_42
L_far_43:
    buffer_store_dword v6, off, s[28:31], s16 sc1
    s_branch L_st_44
L_retry_45:
    s_add_u32 s84, s84, 1
    s_cmp_ge_u32 s84, 524288
    s_cbranch_scc1 L_end
    buffer_load_dword v6, v28, s[28:31], s15 offen sc1
    s_waitcnt vmcnt(0)
    v_cmp_ne_u32 vcc, s83, v6
    s_nop 0
    s_cmp_lg_u64 vcc, 0
    s_cbranch_scc1 L_retry_45
    s_branch L_ok_46
L_far_47:
    buffer_store_dwordx4 v[192:195], v16, s[28:31], s40 offen sc1
    buffer_store_dwordx4 v[196:199], v16, s[28:31], s40 offen offset:64 sc1
    s_branch L_st_48
L_retry_49:
    s_add_u32 s84, s84, 1
    s_cmp_ge_u32 s84, 524288
    s_cbranch_scc1 L_end
    buffer_load_dwordx4 v[104:107], v17, s[28:31], s41 offen sc1
    s_waitcnt vmcnt(0)
    v_max3_u32 v6, v104, v105, v106
    v_max_u32 v6, v6, v107
    v_cmp_eq_u32 vcc, -1, v6
    s_nop 0
    s_cmp_lg_u64 vcc, 0
    s_cbranch_scc1 L_retry_49
    s_branch L_ok_50
L_retry_51:
    s_add_u32 s84, s84, 1
    s_cmp_ge_u32 s84, 524288
    s_cbranch_scc1 L_end
    buffer_load_dword v6, v19, s[28:31], s45 offen sc1
    s_waitcnt vmcnt(0)
    v_cmp_ne_u32 vcc, s83, v6
    s_nop 0
    s_cmp_lg_u64 vcc, 0
    s_cbranch_scc1 L_retry_51
    s_branch L_ok_52
L_far_53:
    buffer_store_dwordx4 v[148:151], v5, s[28:31], s14 offen offset:0 sc1
    buffer_store_dwordx4 v[152:155], v5, s[28:31], s14 offen offset:1024 sc1
    buffer_store_dwordx4 v[156:159], v5, s[28:31], s14 offen offset:2048 sc1
    s_branch L_st_54
L_far_55:
    buffer_store_dword v6, off, s[28:31], s16 sc1
    s_branch L_st_56
L_retry_57:
    s_add_u32 s84, s84, 1
    s_cmp_ge_u32 s84, 524288
    s_cbranch_scc1 L_end
    buffer_load_dword v6, v28, s[28:31], s15 offen sc1
    s_waitcnt vmcnt(0)
    v_cmp_ne_u32 vcc, s83, v6
    s_nop 0
    s_cmp_lg_u64 vcc, 0
    s_cbranch_scc1 L_retry_57
    s_branch L_ok_58
    s_endpgm
    .p2align 8
    .type L_ctab,@object
L_ctab:
    .long 1048576,512,917504,458752
    .long 458752,256,16384,8192
    .long 458752,0,16384,8192
    .long 5242880,98304,5120,2048
    .long 5246976,98304,5120,8
    .long 5242880,98304,0,0
    .long 5242880,98304,6144,3072
    .long 73728,512,0,0
    .long 73728,512,8,4
    .long 524288,0,1280,640
    .long 544768,0,1280,640
    .long 565248,0,1280,640
    .long 585728,0,1280,640
    .long 606208,0,1280,640
    .long 163840,4096,256,128
    .long 163840,4096,0,0
    .long 294912,4096,256,128
    .long 294912,4096,0,0
    .long 11534336,12288,786432,393216
    .long 11538432,12288,786432,393216
    .long 425984,16,1024,512
    .long 425984,0,1024,512
    .long 11534336,0,786432,393216
    .long 0,81920,320,160
    .long 19628032,0,491520,245760
    .long 17825792,0,204800,102400
    .long 17866752,0,204800,102400
    .long 21594112,0,204800,102400
    .long 18644992,0,245760,122880
    .long 196608,262144,0,0
    .long 131072,262144,0,0
    .long 65536,262144,0,0
    .long 0,262144,0,0
    .long 0,0,0,0
    .long 122880,0,0,0
    .long 0,0,0,0
    .long 0,0,0,0
    .long 0,0,0,0
    .long 0,0,0,0
    .long 0,0,0,0
    .long 0,0,0,0
    .long 0,0,0,0
    .long 0,0,0,0
    .long 0,0,0,0
    .long 0,0,0,0
    .long 0,0,0,0
    .long 0,0,0,0
    .long 0,0,0,0
    .long 0,0,0,0
    .long 0,0,0,0
    .long 0,0,0,0
    .long 0,0,0,0
    .long 0,0,0,0
    .long 0,0,0,0
    .long 0,0,0,0
    .long 0,0,0,0
    .long 0,0,0,0
    .long 0,0,0,0
    .long 0,0,0,0
    .long 0,0,0,0
    .long 0,0,0,0
    .long 0,0,0,0
    .long 0,0,0,0
    .long 0,0,0,0
    .long 1048576,512,917504,458752
    .long 458752,256,16384,8192
    .long 458752,0,16384,8192
    .long 5267456,98304,5120,2048
    .long 5271552,98304,5120,8
    .long 5267456,98304,0,0
    .long 5267456,98304,6144,3072
    .long 73856,512,0,0
    .long 73856,512,8,4
    .long 524288,0,1280,640
    .long 544768,0,1280,640
    .long 565248,0,1280,640
    .long 585728,0,1280,640
    .long 606208,0,1280,640
    .long 164864,4096,256,128
    .long 164864,4096,0,0
    .long 295936,4096,256,128
    .long 295936,4096,0,0
    .long 11534848,12288,786432,393216
    .long 11538944,12288,786432,393216
    .long 425988,16,1024,512
    .long 426112,0,1024,512
    .long 11632640,0,786432,393216
    .long 20480,81920,320,160
    .long 19643392,0,491520,245760
    .long 17836032,0,204800,102400
    .long 17882112,0,204800,102400
    .long 21599232,0,204800,102400
    .long 18649088,0,245760,122880
    .long 0,262144,0,0
    .long 196608,262144,0,0
    .long 131072,262144,0,0
    .long 65536,262144,0,0
    .long 4096,0,0,0
    .long 131072,0,0,0
    .long 0,0,0,0
    .long 0,0,0,0
    .long 0,0,0,0
    .long 0,0,0,0
    .long 0,0,0,0
    .long 0,0,0,0
    .long 0,0,0,0
    .long 0,0,0,0
    .long 0,0,0,0
    .long 0,0,0,0
    .long 0,0,0,0
    .long 0,0,0,0
    .long 0,0,0,0
    .long 0,0,0,0
    .long 0,0,0,0
    .long 0,0,0,0
    .long 0,0,0,0
    .long 0,0,0,0
    .long 0,0,0,0
    .long 0,0,0,0
    .long 0,0,0,0
    .long 0,0,0,0
    .long 0,0,0,0
    .long 0,0,0,0
    .long 0,0,0,0
    .long 0,0,0,0
    .long 0,0,0,0
    .long 0,0,0,0
    .long 0,0,0,0
    .long 1048576,512,917504,458752
    .long 458752,256,16384,8192
    .long 458752,0,16384,8192
    .long 5292032,98304,5120,2048
    .long 5296128,98304,5120,8
    .long 5292032,98304,0,0
    .long 5292032,98304,6144,3072
    .long 73984,512,0,0
    .long 73984,512,8,4
    .long 524288,0,1280,640
    .long 544768,0,1280,640
    .long 565248,0,1280,640
    .long 585728,0,1280,640
    .long 606208,0,1280,640
    .long 165888,4096,256,128
    .long 165888,4096,0,0
    .long 296960,4096,256,128
    .long 296960,4096,0,0
    .long 11540480,12288,786432,393216
    .long 11544576,12288,786432,393216
    .long 425992,16,1024,512
    .long 426240,0,1024,512
    .long 11730944,0,786432,393216
    .long 40960,81920,320,160
    .long 19658752,0,491520,245760
    .long 17846272,0,204800,102400
    .long 17897472,0,204800,102400
    .long 21604352,0,204800,102400
    .long 18653184,0,245760,122880
    .long 65536,262144,0,0
    .long 0,262144,0,0
    .long 196608,262144,0,0
    .long 131072,262144,0,0
    .long 8192,0,0,0
    .long 139264,0,0,0
    .long 0,0,0,0
    .long 0,0,0,0
    .long 0,0,0,0
    .long 0,0,0,0
    .long 0,0,0,0
    .long 0,0,0,0
    .long 0,0,0,0
    .long 0,0,0,0
    .long 0,0,0,0
    .long 0,0,0,0
    .long 0,0,0,0
    .long 0,0,0,0
    .long 0,0,0,0
    .long 0,0,0,0
    .long 0,0,0,0
    .long 0,0,0,0
    .long 0,0,0,0
    .long 0,0,0,0
    .long 0,0,0,0
    .long 0,0,0,0
    .long 0,0,0,0
    .long 0,0,0,0
    .long 0,0,0,0
    .long 0,0,0,0
    .long 0,0,0,0
    .long 0,0,0,0
    .long 0,0,0,0
    .long 0,0,0,0
    .long 0,0,0,0
    .long 1048576,512,917504,458752
    .long 458752,256,16384,8192
    .long 458752,0,16384,8192
    .long 5316608,98304,5120,2048
    .long 5320704,98304,5120,8
    .long 5316608,98304,0,0
    .long 5316608,98304,6144,3072
    .long 74112,512,0,0
    .long 74112,512,8,4
    .long 524288,0,1280,640
    .long 544768,0,1280,640
    .long 565248,0,1280,640
    .long 585728,0,1280,640
    .long 606208,0,1280,640
    .long 166912,4096,256,128
    .long 166912,4096,0,0
    .long 297984,4096,256,128
    .long 297984,4096,0,0
    .long 11540992,12288,786432,393216
    .long 11545088,12288,786432,393216
    .long 425996,16,1024,512
    .long 426368,0,1024,512
    .long 11829248,0,786432,393216
    .long 61440,81920,320,160
    .long 19674112,0,491520,245760
    .long 17856512,0,204800,102400
    .long 17912832,0,204800,102400
    .long 21609472,0,204800,102400
    .long 18657280,0,245760,122880
    .long 131072,262144,0,0
    .long 65536,262144,0,0
    .long 0,262144,0,0
    .long 196608,262144,0,0
    .long 12288,0,0,0
    .long 147456,0,0,0
    .long 0,0,0,0
    .long 0,0,0,0
    .long 0,0,0,0
    .long 0,0,0,0
    .long 0,0,0,0
    .long 0,0,0,0
    .long 0,0,0,0
    .long 0,0,0,0
    .long 0,0,0,0
    .long 0,0,0,0
    .long 0,0,0,0
    .long 0,0,0,0
    .long 0,0,0,0
    .long 0,0,0,0
    .long 0,0,0,0
    .long 0,0,0,0
    .long 0,0,0,0
    .long 0,0,0,0
    .long 0,0,0,0
    .long 0,0,0,0
    .long 0,0,0,0
    .long 0,0,0,0
    .long 0,0,0,0
    .long 0,0,0,0
    .long 0,0,0,0
    .long 0,0,0,0
    .long 0,0,0,0
    .long 0,0,0,0
    .long 0,0,0,0
    .long 155648,0,0,0
    .long 155696,80,48,8
    .long 155744,160,96,16
    .long 155792,240,144,24
    .long 159488,320,192,80
    .long 159488,400,240,88
    .long 159488,480,288,96
    .long 159488,560,336,104
    .long 159488,640,384,160
    .long 159488,720,432,168
    .long 159488,800,480,176
    .long 159488,880,528,184
    .long 159488,960,576,240
    .long 159488,1040,624,248
    .long 159488,1120,672,256
    .long 159488,1200,720,264
    .long 159488,15360,15360,320
    .long 159488,15440,15408,328
    .long 159488,15520,15456,336
    .long 159488,15600,15504,344
    .long 156608,15680,15552,400
    .long 156656,15760,15600,408
    .long 156704,15840,15648,416
    .long 156752,15920,15696,424
    .long 159488,16000,15744,480
    .long 159488,16080,15792,488
    .long 159488,16160,15840,496
    .long 159488,16240,15888,504
    .long 159488,16320,15936,560
    .long 159488,16400,15984,568
    .long 159488,16480,16032,576
    .long 159488,16560,16080,584
    .long 159488,30720,30720,640
    .long 159488,30800,30768,648
    .long 159488,30880,30816,656
    .long 159488,30960,30864,664
    .long 159488,31040,30912,720
    .long 159488,31120,30960,728
    .long 159488,31200,31008,736
    .long 159488,31280,31056,744
    .long 157568,31360,31104,800
    .long 157616,31440,31152,808
    .long 157664,31520,31200,816
    .long 157712,31600,31248,824
    .long 159488,31680,31296,880
    .long 159488,31760,31344,888
    .long 159488,31840,31392,896
    .long 159488,31920,31440,904
    .long 159488,46080,46080,960
    .long 159488,46160,46128,968
    .long 159488,46240,46176,976
    .long 159488,46320,46224,984
    .long 159488,46400,46272,1040
    .long 159488,46480,46320,1048
    .long 159488,46560,46368,1056
    .long 159488,46640,46416,1064
    .long 159488,46720,46464,1120
    .long 159488,46800,46512,1128
    .long 159488,46880,46560,1136
    .long 159488,46960,46608,1144
    .long 158528,47040,46656,1200
    .long 158576,47120,46704,1208
    .long 158624,47200,46752,1216
    .long 158672,47280,46800,1224
    .long 155648,1280,768,15360
    .long 155696,1360,816,15368
    .long 155744,1440,864,15376
    .long 155792,1520,912,15384
    .long 159488,1600,960,15440
    .long 159488,1680,1008,15448
    .long 159488,1760,1056,15456
    .long 159488,1840,1104,15464
    .long 159488,1920,1152,15520
    .long 159488,2000,1200,15528
    .long 159488,2080,1248,15536
    .long 159488,2160,1296,15544
    .long 159488,2240,1344,15600
    .long 159488,2320,1392,15608
    .long 159488,2400,1440,15616
    .long 159488,2480,1488,15624
    .long 159488,16640,16128,15680
    .long 159488,16720,16176,15688
    .long 159488,16800,16224,15696
    .long 159488,16880,16272,15704
    .long 156608,16960,16320,15760
    .long 156656,17040,16368,15768
    .long 156704,17120,16416,15776
    .long 156752,17200,16464,15784
    .long 159488,17280,16512,15840
    .long 159488,17360,16560,15848
    .long 159488,17440,16608,15856
    .long 159488,17520,16656,15864
    .long 159488,17600,16704,15920
    .long 159488,17680,16752,15928
    .long 159488,17760,16800,15936
    .long 159488,17840,16848,15944
    .long 159488,32000,31488,16000
    .long 159488,32080,31536,16008
    .long 159488,32160,31584,16016
    .long 159488,32240,31632,16024
    .long 159488,32320,31680,16080
    .long 159488,32400,31728,16088
    .long 159488,32480,31776,16096
    .long 159488,32560,31824,16104
    .long 157568,32640,31872,16160
    .long 157616,32720,31920,16168
    .long 157664,32800,31968,16176
    .long 157712,32880,32016,16184
    .long 159488,32960,32064,16240
    .long 159488,33040,32112,16248
    .long 159488,33120,32160,16256
    .long 159488,33200,32208,16264
    .long 159488,47360,46848,16320
    .long 159488,47440,46896,16328
    .long 159488,47520,46944,16336
    .long 159488,47600,46992,16344
    .long 159488,47680,47040,16400
    .long 159488,47760,47088,16408
    .long 159488,47840,47136,16416
    .long 159488,47920,47184,16424
    .long 159488,48000,47232,16480
    .long 159488,48080,47280,16488
    .long 159488,48160,47328,16496
    .long 159488,48240,47376,16504
    .long 158528,48320,47424,16560
    .long 158576,48400,47472,16568
    .long 158624,48480,47520,16576
    .long 158672,48560,47568,16584
    .long 155648,2560,1536,30720
    .long 155696,2640,1584,30728
    .long 155744,2720,1632,30736
    .long 155792,2800,1680,30744
    .long 159488,2880,1728,30800
    .long 159488,2960,1776,30808
    .long 159488,3040,1824,30816
    .long 159488,3120,1872,30824
    .long 159488,3200,1920,30880
    .long 159488,3280,1968,30888
    .long 159488,3360,2016,30896
    .long 159488,3440,2064,30904
    .long 159488,3520,2112,30960
    .long 159488,3600,2160,30968
    .long 159488,3680,2208,30976
    .long 159488,3760,2256,30984
    .long 159488,17920,16896,31040
    .long 159488,18000,16944,31048
    .long 159488,18080,16992,31056
    .long 159488,18160,17040,31064
    .long 156608,18240,17088,31120
    .long 156656,18320,17136,31128
    .long 156704,18400,17184,31136
    .long 156752,18480,17232,31144
    .long 159488,18560,17280,31200
    .long 159488,18640,17328,31208
    .long 159488,18720,17376,31216
    .long 159488,18800,17424,31224
    .long 159488,18880,17472,31280
    .long 159488,18960,17520,31288
    .long 159488,19040,17568,31296
    .long 159488,19120,17616,31304
    .long 159488,33280,32256,31360
    .long 159488,33360,32304,31368
    .long 159488,33440,32352,31376
    .long 159488,33520,32400,31384
    .long 159488,33600,32448,31440
    .long 159488,33680,32496,31448
    .long 159488,33760,32544,31456
    .long 159488,33840,32592,31464
    .long 157568,33920,32640,31520
    .long 157616,34000,32688,31528
    .long 157664,34080,32736,31536
    .long 157712,34160,32784,31544
    .long 159488,34240,32832,31600
    .long 159488,34320,32880,31608
    .long 159488,34400,32928,31616
    .long 159488,34480,32976,31624
    .long 159488,48640,47616,31680
    .long 159488,48720,47664,31688
    .long 159488,48800,47712,31696
    .long 159488,48880,47760,31704
    .long 159488,48960,47808,31760
    .long 159488,49040,47856,31768
    .long 159488,49120,47904,31776
    .long 159488,49200,47952,31784
    .long 159488,49280,48000,31840
    .long 159488,49360,48048,31848
    .long 159488,49440,48096,31856
    .long 159488,49520,48144,31864
    .long 158528,49600,48192,31920
    .long 158576,49680,48240,31928
    .long 158624,49760,48288,31936
    .long 158672,49840,48336,31944
    .long 155648,3840,2304,46080
    .long 155696,3920,2352,46088
    .long 155744,4000,2400,46096
    .long 155792,4080,2448,46104
    .long 159488,4160,2496,46160
    .long 159488,4240,2544,46168
    .long 159488,4320,2592,46176
    .long 159488,4400,2640,46184
    .long 159488,4480,2688,46240
    .long 159488,4560,2736,46248
    .long 159488,4640,2784,46256
    .long 159488,4720,2832,46264
    .long 159488,4800,2880,46320
    .long 159488,4880,2928,46328
    .long 159488,4960,2976,46336
    .long 159488,5040,3024,46344
    .long 159488,19200,17664,46400
    .long 159488,19280,17712,46408
    .long 159488,19360,17760,46416
    .long 159488,19440,17808,46424
    .long 156608,19520,17856,46480
    .long 156656,19600,17904,46488
    .long 156704,19680,17952,46496
    .long 156752,19760,18000,46504
    .long 159488,19840,18048,46560
    .long 159488,19920,18096,46568
    .long 159488,20000,18144,46576
    .long 159488,20080,18192,46584
    .long 159488,20160,18240,46640
    .long 159488,20240,18288,46648
    .long 159488,20320,18336,46656
    .long 159488,20400,18384,46664
    .long 159488,34560,33024,46720
    .long 159488,34640,33072,46728
    .long 159488,34720,33120,46736
    .long 159488,34800,33168,46744
    .long 159488,34880,33216,46800
    .long 159488,34960,33264,46808
    .long 159488,35040,33312,46816
    .long 159488,35120,33360,46824
    .long 157568,35200,33408,46880
    .long 157616,35280,33456,46888
    .long 157664,35360,33504,46896
    .long 157712,35440,33552,46904
    .long 159488,35520,33600,46960
    .long 159488,35600,33648,46968
    .long 159488,35680,33696,46976
    .long 159488,35760,33744,46984
    .long 159488,49920,48384,47040
    .long 159488,50000,48432,47048
    .long 159488,50080,48480,47056
    .long 159488,50160,48528,47064
    .long 159488,50240,48576,47120
    .long 159488,50320,48624,47128
    .long 159488,50400,48672,47136
    .long 159488,50480,48720,47144
    .long 159488,50560,48768,47200
    .long 159488,50640,48816,47208
    .long 159488,50720,48864,47216
    .long 159488,50800,48912,47224
    .long 158528,50880,48960,47280
    .long 158576,50960,49008,47288
    .long 158624,51040,49056,47296
    .long 158672,51120,49104,47304
    .long 0,0,81920,32768
    .long 8,16,81936,32784
    .long 16,32,81952,32800
    .long 24,48,81968,32816
    .long 48,64,81984,32832
    .long 56,80,1073741824,32848
    .long 64,96,1073741824,32864
    .long 72,112,1073741824,32880
    .long 96,128,1073741824,32896
    .long 104,144,1073741824,32912
    .long 112,160,1073741824,32928
    .long 120,176,1073741824,32944
    .long 144,192,1073741824,32960
    .long 152,208,1073741824,32976
    .long 160,224,1073741824,32992
    .long 168,240,1073741824,33008
    .long 192,256,82000,33024
    .long 200,272,82016,33040
    .long 208,288,82032,33056
    .long 216,304,82048,33072
    .long 240,320,82064,33088
    .long 248,336,1073741824,33104
    .long 256,352,1073741824,33120
    .long 264,368,1073741824,33136
    .long 288,384,1073741824,33152
    .long 296,400,1073741824,33168
    .long 304,416,1073741824,33184
    .long 312,432,1073741824,33200
    .long 336,448,1073741824,33216
    .long 344,464,1073741824,33232
    .long 352,480,1073741824,33248
    .long 360,496,1073741824,33264
    .long 384,16384,82080,49152
    .long 392,16400,82096,49168
    .long 400,16416,82112,49184
    .long 408,16432,82128,49200
    .long 432,16448,82144,49216
    .long 440,16464,1073741824,49232
    .long 448,16480,1073741824,49248
    .long 456,16496,1073741824,49264
    .long 480,16512,1073741824,49280
    .long 488,16528,1073741824,49296
    .long 496,16544,1073741824,49312
    .long 504,16560,1073741824,49328
    .long 528,16576,1073741824,49344
    .long 536,16592,1073741824,49360
    .long 544,16608,1073741824,49376
    .long 552,16624,1073741824,49392
    .long 576,16640,82160,49408
    .long 584,16656,82176,49424
    .long 592,16672,82192,49440
    .long 600,16688,82208,49456
    .long 624,16704,82224,49472
    .long 632,16720,1073741824,49488
    .long 640,16736,1073741824,49504
    .long 648,16752,1073741824,49520
    .long 672,16768,1073741824,49536
    .long 680,16784,1073741824,49552
    .long 688,16800,1073741824,49568
    .long 696,16816,1073741824,49584
    .long 720,16832,1073741824,49600
    .long 728,16848,1073741824,49616
    .long 736,16864,1073741824,49632
    .long 744,16880,1073741824,49648
    .long 15360,114688,196608,147456
    .long 15368,114704,196624,147472
    .long 15376,114720,196640,147488
    .long 15384,114736,196656,147504
    .long 15408,114752,196672,147520
    .long 15416,114768,1073741824,147536
    .long 15424,114784,1073741824,147552
    .long 15432,114800,1073741824,147568
    .long 15456,114816,1073741824,147584
    .long 15464,114832,1073741824,147600
    .long 15472,114848,1073741824,147616
    .long 15480,114864,1073741824,147632
    .long 15504,114880,1073741824,147648
    .long 15512,114896,1073741824,147664
    .long 15520,114912,1073741824,147680
    .long 15528,114928,1073741824,147696
    .long 15552,114944,196688,147712
    .long 15560,114960,196704,147728
    .long 15568,114976,196720,147744
    .long 15576,114992,196736,147760
    .long 15600,115008,196752,147776
    .long 15608,115024,1073741824,147792
    .long 15616,115040,1073741824,147808
    .long 15624,115056,1073741824,147824
    .long 15648,115072,1073741824,147840
    .long 15656,115088,1073741824,147856
    .long 15664,115104,1073741824,147872
    .long 15672,115120,1073741824,147888
    .long 15696,115136,1073741824,147904
    .long 15704,115152,1073741824,147920
    .long 15712,115168,1073741824,147936
    .long 15720,115184,1073741824,147952
    .long 15744,131072,196768,163840
    .long 15752,131088,196784,163856
    .long 15760,131104,196800,163872
    .long 15768,131120,196816,163888
    .long 15792,131136,196832,163904
    .long 15800,131152,1073741824,163920
    .long 15808,131168,1073741824,163936
    .long 15816,131184,1073741824,163952
    .long 15840,131200,1073741824,163968
    .long 15848,131216,1073741824,163984
    .long 15856,131232,1073741824,164000
    .long 15864,131248,1073741824,164016
    .long 15888,131264,1073741824,164032
    .long 15896,131280,1073741824,164048
    .long 15904,131296,1073741824,164064
    .long 15912,131312,1073741824,164080
    .long 15936,131328,196848,164096
    .long 15944,131344,196864,164112
    .long 15952,131360,196880,164128
    .long 15960,131376,196896,164144
    .long 15984,131392,196912,164160
    .long 15992,131408,1073741824,164176
    .long 16000,131424,1073741824,164192
    .long 16008,131440,1073741824,164208
    .long 16032,131456,1073741824,164224
    .long 16040,131472,1073741824,164240
    .long 16048,131488,1073741824,164256
    .long 16056,131504,1073741824,164272
    .long 16080,131520,1073741824,164288
    .long 16088,131536,1073741824,164304
    .long 16096,131552,1073741824,164320
    .long 16104,131568,1073741824,164336
    .long 30720,229376,311296,262144
    .long 30728,229392,311312,262160
    .long 30736,229408,311328,262176
    .long 30744,229424,311344,262192
    .long 30768,229440,311360,262208
    .long 30776,229456,1073741824,262224
    .long 30784,229472,1073741824,262240
    .long 30792,229488,1073741824,262256
    .long 30816,229504,1073741824,262272
    .long 30824,229520,1073741824,262288
    .long 30832,229536,1073741824,262304
    .long 30840,229552,1073741824,262320
    .long 30864,229568,1073741824,262336
    .long 30872,229584,1073741824,262352
    .long 30880,229600,1073741824,262368
    .long 30888,229616,1073741824,262384
    .long 30912,229632,311376,262400
    .long 30920,229648,311392,262416
    .long 30928,229664,311408,262432
    .long 30936,229680,311424,262448
    .long 30960,229696,311440,262464
    .long 30968,229712,1073741824,262480
    .long 30976,229728,1073741824,262496
    .long 30984,229744,1073741824,262512
    .long 31008,229760,1073741824,262528
    .long 31016,229776,1073741824,262544
    .long 31024,229792,1073741824,262560
    .long 31032,229808,1073741824,262576
    .long 31056,229824,1073741824,262592
    .long 31064,229840,1073741824,262608
    .long 31072,229856,1073741824,262624
    .long 31080,229872,1073741824,262640
    .long 31104,245760,311456,278528
    .long 31112,245776,311472,278544
    .long 31120,245792,311488,278560
    .long 31128,245808,311504,278576
    .long 31152,245824,311520,278592
    .long 31160,245840,1073741824,278608
    .long 31168,245856,1073741824,278624
    .long 31176,245872,1073741824,278640
    .long 31200,245888,1073741824,278656
    .long 31208,245904,1073741824,278672
    .long 31216,245920,1073741824,278688
    .long 31224,245936,1073741824,278704
    .long 31248,245952,1073741824,278720
    .long 31256,245968,1073741824,278736
    .long 31264,245984,1073741824,278752
    .long 31272,246000,1073741824,278768
    .long 31296,246016,311536,278784
    .long 31304,246032,311552,278800
    .long 31312,246048,311568,278816
    .long 31320,246064,311584,278832
    .long 31344,246080,311600,278848
    .long 31352,246096,1073741824,278864
    .long 31360,246112,1073741824,278880
    .long 31368,246128,1073741824,278896
    .long 31392,246144,1073741824,278912
    .long 31400,246160,1073741824,278928
    .long 31408,246176,1073741824,278944
    .long 31416,246192,1073741824,278960
    .long 31440,246208,1073741824,278976
    .long 31448,246224,1073741824,278992
    .long 31456,246240,1073741824,279008
    .long 31464,246256,1073741824,279024
    .long 46080,344064,425984,376832
    .long 46088,344080,426000,376848
    .long 46096,344096,426016,376864
    .long 46104,344112,426032,376880
    .long 46128,344128,426048,376896
    .long 46136,344144,1073741824,376912
    .long 46144,344160,1073741824,376928
    .long 46152,344176,1073741824,376944
    .long 46176,344192,1073741824,376960
    .long 46184,344208,1073741824,376976
    .long 46192,344224,1073741824,376992
    .long 46200,344240,1073741824,377008
    .long 46224,344256,1073741824,377024
    .long 46232,344272,1073741824,377040
    .long 46240,344288,1073741824,377056
    .long 46248,344304,1073741824,377072
    .long 46272,344320,426064,377088
    .long 46280,344336,426080,377104
    .long 46288,344352,426096,377120
    .long 46296,344368,426112,377136
    .long 46320,344384,426128,377152
    .long 46328,344400,1073741824,377168
    .long 46336,344416,1073741824,377184
    .long 46344,344432,1073741824,377200
    .long 46368,344448,1073741824,377216
    .long 46376,344464,1073741824,377232
    .long 46384,344480,1073741824,377248
    .long 46392,344496,1073741824,377264
    .long 46416,344512,1073741824,377280
    .long 46424,344528,1073741824,377296
    .long 46432,344544,1073741824,377312
    .long 46440,344560,1073741824,377328
    .long 46464,360448,426144,393216
    .long 46472,360464,426160,393232
    .long 46480,360480,426176,393248
    .long 46488,360496,426192,393264
    .long 46512,360512,426208,393280
    .long 46520,360528,1073741824,393296
    .long 46528,360544,1073741824,393312
    .long 46536,360560,1073741824,393328
    .long 46560,360576,1073741824,393344
    .long 46568,360592,1073741824,393360
    .long 46576,360608,1073741824,393376
    .long 46584,360624,1073741824,393392
    .long 46608,360640,1073741824,393408
    .long 46616,360656,1073741824,393424
    .long 46624,360672,1073741824,393440
    .long 46632,360688,1073741824,393456
    .long 46656,360704,426224,393472
    .long 46664,360720,426240,393488
    .long 46672,360736,426256,393504
    .long 46680,360752,426272,393520
    .long 46704,360768,426288,393536
    .long 46712,360784,1073741824,393552
    .long 46720,360800,1073741824,393568
    .long 46728,360816,1073741824,393584
    .long 46752,360832,1073741824,393600
    .long 46760,360848,1073741824,393616
    .long 46768,360864,1073741824,393632
    .long 46776,360880,1073741824,393648
    .long 46800,360896,1073741824,393664
    .long 46808,360912,1073741824,393680
    .long 46816,360928,1073741824,393696
    .long 46824,360944,1073741824,393712
    .long 82240,65536,98432,0
    .long 82256,65552,98448,0
    .long 82272,65568,98464,0
    .long 82288,65584,98480,0
    .long 82304,65600,98496,0
    .long 1073741824,65616,1073741824,0
    .long 1073741824,65632,1073741824,0
    .long 1073741824,65648,1073741824,0
    .long 1073741824,65664,1073741824,0
    .long 1073741824,65680,1073741824,0
    .long 1073741824,65696,1073741824,0
    .long 1073741824,65712,1073741824,0
    .long 1073741824,65728,1073741824,0
    .long 1073741824,65744,1073741824,0
    .long 1073741824,65760,1073741824,0
    .long 1073741824,65776,1073741824,0
    .long 82320,65792,98512,0
    .long 82336,65808,98528,0
    .long 82352,65824,98544,0
    .long 82368,65840,98560,0
    .long 82384,65856,98576,0
    .long 1073741824,65872,1073741824,0
    .long 1073741824,65888,1073741824,0
    .long 1073741824,65904,1073741824,0
    .long 1073741824,65920,1073741824,0
    .long 1073741824,65936,1073741824,0
    .long 1073741824,65952,1073741824,0
    .long 1073741824,65968,1073741824,0
    .long 1073741824,65984,1073741824,0
    .long 1073741824,66000,1073741824,0
    .long 1073741824,66016,1073741824,0
    .long 1073741824,66032,1073741824,0
    .long 82400,1073741824,1073741824,0
    .long 82416,1073741824,1073741824,0
    .long 98304,1073741824,1073741824,0
    .long 98320,1073741824,1073741824,0
    .long 98336,1073741824,1073741824,0
    .long 1073741824,1073741824,1073741824,0
    .long 1073741824,1073741824,1073741824,0
    .long 1073741824,1073741824,1073741824,0
    .long 1073741824,1073741824,1073741824,0
    .long 1073741824,1073741824,1073741824,0
    .long 1073741824,1073741824,1073741824,0
    .long 1073741824,1073741824,1073741824,0
    .long 1073741824,1073741824,1073741824,0
    .long 1073741824,1073741824,1073741824,0
    .long 1073741824,1073741824,1073741824,0
    .long 1073741824,1073741824,1073741824,0
    .long 98352,1073741824,1073741824,0
    .long 98368,1073741824,1073741824,0
    .long 98384,1073741824,1073741824,0
    .long 98400,1073741824,1073741824,0
    .long 98416,1073741824,1073741824,0
    .long 1073741824,1073741824,1073741824,0
    .long 1073741824,1073741824,1073741824,0
    .long 1073741824,1073741824,1073741824,0
    .long 1073741824,1073741824,1073741824,0
    .long 1073741824,1073741824,1073741824,0
    .long 1073741824,1073741824,1073741824,0
    .long 1073741824,1073741824,1073741824,0
    .long 1073741824,1073741824,1073741824,0
    .long 1073741824,1073741824,1073741824,0
    .long 1073741824,1073741824,1073741824,0
    .long 1073741824,1073741824,1073741824,0
    .long 196928,180224,213120,0
    .long 196944,180240,213136,0
    .long 196960,180256,213152,0
    .long 196976,180272,213168,0
    .long 196992,180288,213184,0
    .long 1073741824,180304,1073741824,0
    .long 1073741824,180320,1073741824,0
    .long 1073741824,180336,1073741824,0
    .long 1073741824,180352,1073741824,0
    .long 1073741824,180368,1073741824,0
    .long 1073741824,180384,1073741824,0
    .long 1073741824,180400,1073741824,0
    .long 1073741824,180416,1073741824,0
    .long 1073741824,180432,1073741824,0
    .long 1073741824,180448,1073741824,0
    .long 1073741824,180464,1073741824,0
    .long 197008,180480,213200,0
    .long 197024,180496,213216,0
    .long 197040,180512,213232,0
    .long 197056,180528,213248,0
    .long 197072,180544,213264,0
    .long 1073741824,180560,1073741824,0
    .long 1073741824,180576,1073741824,0
    .long 1073741824,180592,1073741824,0
    .long 1073741824,180608,1073741824,0
    .long 1073741824,180624,1073741824,0
    .long 1073741824,180640,1073741824,0
    .long 1073741824,180656,1073741824,0
    .long 1073741824,180672,1073741824,0
    .long 1073741824,180688,1073741824,0
    .long 1073741824,180704,1073741824,0
    .long 1073741824,180720,1073741824,0
    .long 197088,1073741824,1073741824,0
    .long 197104,1073741824,1073741824,0
    .long 212992,1073741824,1073741824,0
    .long 213008,1073741824,1073741824,0
    .long 213024,1073741824,1073741824,0
    .long 1073741824,1073741824,1073741824,0
    .long 1073741824,1073741824,1073741824,0
    .long 1073741824,1073741824,1073741824,0
    .long 1073741824,1073741824,1073741824,0
    .long 1073741824,1073741824,1073741824,0
    .long 1073741824,1073741824,1073741824,0
    .long 1073741824,1073741824,1073741824,0
    .long 1073741824,1073741824,1073741824,0
    .long 1073741824,1073741824,1073741824,0
    .long 1073741824,1073741824,1073741824,0
    .long 1073741824,1073741824,1073741824,0
    .long 213040,1073741824,1073741824,0
    .long 213056,1073741824,1073741824,0
    .long 213072,1073741824,1073741824,0
    .long 213088,1073741824,1073741824,0
    .long 213104,1073741824,1073741824,0
    .long 1073741824,1073741824,1073741824,0
    .long 1073741824,1073741824,1073741824,0
    .long 1073741824,1073741824,1073741824,0
    .long 1073741824,1073741824,1073741824,0
    .long 1073741824,1073741824,1073741824,0
    .long 1073741824,1073741824,1073741824,0
    .long 1073741824,1073741824,1073741824,0
    .long 1073741824,1073741824,1073741824,0
    .long 1073741824,1073741824,1073741824,0
    .long 1073741824,1073741824,1073741824,0
    .long 1073741824,1073741824,1073741824,0
    .long 311616,294912,327808,0
    .long 311632,294928,327824,0
    .long 311648,294944,327840,0
    .long 311664,294960,327856,0
    .long 311680,294976,327872,0
    .long 1073741824,294992,1073741824,0
    .long 1073741824,295008,1073741824,0
    .long 1073741824,295024,1073741824,0
    .long 1073741824,295040,1073741824,0
    .long 1073741824,295056,1073741824,0
    .long 1073741824,295072,1073741824,0
    .long 1073741824,295088,1073741824,0
    .long 1073741824,295104,1073741824,0
    .long 1073741824,295120,1073741824,0
    .long 1073741824,295136,1073741824,0
    .long 1073741824,295152,1073741824,0
    .long 311696,295168,327888,0
    .long 311712,295184,327904,0
    .long 311728,295200,327920,0
    .long 311744,295216,327936,0
    .long 311760,295232,327952,0
    .long 1073741824,295248,1073741824,0
    .long 1073741824,295264,1073741824,0
    .long 1073741824,295280,1073741824,0
    .long 1073741824,295296,1073741824,0
    .long 1073741824,295312,1073741824,0
    .long 1073741824,295328,1073741824,0
    .long 1073741824,295344,1073741824,0
    .long 1073741824,295360,1073741824,0
    .long 1073741824,295376,1073741824,0
    .long 1073741824,295392,1073741824,0
    .long 1073741824,295408,1073741824,0
    .long 311776,1073741824,1073741824,0
    .long 311792,1073741824,1073741824,0
    .long 327680,1073741824,1073741824,0
    .long 327696,1073741824,1073741824,0
    .long 327712,1073741824,1073741824,0
    .long 1073741824,1073741824,1073741824,0
    .long 1073741824,1073741824,1073741824,0
    .long 1073741824,1073741824,1073741824,0
    .long 1073741824,1073741824,1073741824,0
    .long 1073741824,1073741824,1073741824,0
    .long 1073741824,1073741824,1073741824,0
    .long 1073741824,1073741824,1073741824,0
    .long 1073741824,1073741824,1073741824,0
    .long 1073741824,1073741824,1073741824,0
    .long 1073741824,1073741824,1073741824,0
    .long 1073741824,1073741824,1073741824,0
    .long 327728,1073741824,1073741824,0
    .long 327744,1073741824,1073741824,0
    .long 327760,1073741824,1073741824,0
    .long 327776,1073741824,1073741824,0
    .long 327792,1073741824,1073741824,0
    .long 1073741824,1073741824,1073741824,0
    .long 1073741824,1073741824,1073741824,0
    .long 1073741824,1073741824,1073741824,0
    .long 1073741824,1073741824,1073741824,0
    .long 1073741824,1073741824,1073741824,0
    .long 1073741824,1073741824,1073741824,0
    .long 1073741824,1073741824,1073741824,0
    .long 1073741824,1073741824,1073741824,0
    .long 1073741824,1073741824,1073741824,0
    .long 1073741824,1073741824,1073741824,0
    .long 1073741824,1073741824,1073741824,0
    .long 426304,409600,442496,0
    .long 426320,409616,442512,0
    .long 426336,409632,442528,0
    .long 426352,409648,442544,0
    .long 426368,409664,442560,0
    .long 1073741824,409680,1073741824,0
    .long 1073741824,409696,1073741824,0
    .long 1073741824,409712,1073741824,0
    .long 1073741824,409728,1073741824,0
    .long 1073741824,409744,1073741824,0
    .long 1073741824,409760,1073741824,0
    .long 1073741824,409776,1073741824,0
    .long 1073741824,409792,1073741824,0
    .long 1073741824,409808,1073741824,0
    .long 1073741824,409824,1073741824,0
    .long 1073741824,409840,1073741824,0
    .long 426384,409856,442576,0
    .long 426400,409872,442592,0
    .long 426416,409888,442608,0
    .long 426432,409904,442624,0
    .long 426448,409920,442640,0
    .long 1073741824,409936,1073741824,0
    .long 1073741824,409952,1073741824,0
    .long 1073741824,409968,1073741824,0
    .long 1073741824,409984,1073741824,0
    .long 1073741824,410000,1073741824,0
    .long 1073741824,410016,1073741824,0
    .long 1073741824,410032,1073741824,0
    .long 1073741824,410048,1073741824,0
    .long 1073741824,410064,1073741824,0
    .long 1073741824,410080,1073741824,0
    .long 1073741824,410096,1073741824,0
    .long 426464,1073741824,1073741824,0
    .long 426480,1073741824,1073741824,0
    .long 442368,1073741824,1073741824,0
    .long 442384,1073741824,1073741824,0
    .long 442400,1073741824,1073741824,0
    .long 1073741824,1073741824,1073741824,0
    .long 1073741824,1073741824,1073741824,0
    .long 1073741824,1073741824,1073741824,0
    .long 1073741824,1073741824,1073741824,0
    .long 1073741824,1073741824,1073741824,0
    .long 1073741824,1073741824,1073741824,0
    .long 1073741824,1073741824,1073741824,0
    .long 1073741824,1073741824,1073741824,0
    .long 1073741824,1073741824,1073741824,0
    .long 1073741824,1073741824,1073741824,0
    .long 1073741824,1073741824,1073741824,0
    .long 442416,1073741824,1073741824,0
    .long 442432,1073741824,1073741824,0
    .long 442448,1073741824,1073741824,0
    .long 442464,1073741824,1073741824,0
    .long 442480,1073741824,1073741824,0
    .long 1073741824,1073741824,1073741824,0
    .long 1073741824,1073741824,1073741824,0
    .long 1073741824,1073741824,1073741824,0
    .long 1073741824,1073741824,1073741824,0
    .long 1073741824,1073741824,1073741824,0
    .long 1073741824,1073741824,1073741824,0
    .long 1073741824,1073741824,1073741824,0
    .long 1073741824,1073741824,1073741824,0
    .long 1073741824,1073741824,1073741824,0
    .long 1073741824,1073741824,1073741824,0
    .long 1073741824,1073741824,1073741824,0
    .long 0,0,0,0
    .long 0,16,0,0
    .long 0,32,0,0
    .long 0,48,0,0
    .long 2048,0,1073741824,0
    .long 2048,16,1073741824,0
    .long 2048,32,1073741824,0
    .long 2048,48,1073741824,0
    .long 4096,0,1073741824,0
    .long 4096,16,1073741824,0
    .long 4096,32,1073741824,0
    .long 4096,48,1073741824,0
    .long 6144,0,1073741824,0
    .long 6144,16,1073741824,0
    .long 6144,32,1073741824,0
    .long 6144,48,1073741824,0
    .long 0,64,0,0
    .long 0,80,0,0
    .long 0,96,0,0
    .long 0,112,0,0
    .long 2048,64,1073741824,0
    .long 2048,80,1073741824,0
    .long 2048,96,1073741824,0
    .long 2048,112,1073741824,0
    .long 4096,64,1073741824,0
    .long 4096,80,1073741824,0
    .long 4096,96,1073741824,0
    .long 4096,112,1073741824,0
    .long 6144,64,1073741824,0
    .long 6144,80,1073741824,0
    .long 6144,96,1073741824,0
    .long 6144,112,1073741824,0
    .long 8192,0,4,0
    .long 8192,16,4,0
    .long 8192,32,4,0
    .long 8192,48,4,0
    .long 10240,0,1073741824,0
    .long 10240,16,1073741824,0
    .long 10240,32,1073741824,0
    .long 10240,48,1073741824,0
    .long 12288,0,1073741824,0
    .long 12288,16,1073741824,0
    .long 12288,32,1073741824,0
    .long 12288,48,1073741824,0
    .long 14336,0,1073741824,0
    .long 14336,16,1073741824,0
    .long 14336,32,1073741824,0
    .long 14336,48,1073741824,0
    .long 8192,64,4,0
    .long 8192,80,4,0
    .long 8192,96,4,0
    .long 8192,112,4,0
    .long 10240,64,1073741824,0
    .long 10240,80,1073741824,0
    .long 10240,96,1073741824,0
    .long 10240,112,1073741824,0
    .long 12288,64,1073741824,0
    .long 12288,80,1073741824,0
    .long 12288,96,1073741824,0
    .long 12288,112,1073741824,0
    .long 14336,64,1073741824,0
    .long 14336,80,1073741824,0
    .long 14336,96,1073741824,0
    .long 14336,112,1073741824,0
    .long 0,128,0,0
    .long 0,144,0,0
    .long 0,160,0,0
    .long 0,176,0,0
    .long 2048,128,1073741824,0
    .long 2048,144,1073741824,0
    .long 2048,160,1073741824,0
    .long 2048,176,1073741824,0
    .long 4096,128,1073741824,0
    .long 4096,144,1073741824,0
    .long 4096,160,1073741824,0
    .long 4096,176,1073741824,0
    .long 6144,128,1073741824,0
    .long 6144,144,1073741824,0
    .long 6144,160,1073741824,0
    .long 6144,176,1073741824,0
    .long 0,192,0,0
    .long 0,208,0,0
    .long 0,224,0,0
    .long 0,240,0,0
    .long 2048,192,1073741824,0
    .long 2048,208,1073741824,0
    .long 2048,224,1073741824,0
    .long 2048,240,1073741824,0
    .long 4096,192,1073741824,0
    .long 4096,208,1073741824,0
    .long 4096,224,1073741824,0
    .long 4096,240,1073741824,0
    .long 6144,192,1073741824,0
    .long 6144,208,1073741824,0
    .long 6144,224,1073741824,0
    .long 6144,240,1073741824,0
    .long 8192,128,4,0
    .long 8192,144,4,0
    .long 8192,160,4,0
    .long 8192,176,4,0
    .long 10240,128,1073741824,0
    .long 10240,144,1073741824,0
    .long 10240,160,1073741824,0
    .long 10240,176,1073741824,0
    .long 12288,128,1073741824,0
    .long 12288,144,1073741824,0
    .long 12288,160,1073741824,0
    .long 12288,176,1073741824,0
    .long 14336,128,1073741824,0
    .long 14336,144,1073741824,0
    .long 14336,160,1073741824,0
    .long 14336,176,1073741824,0
    .long 8192,192,4,0
    .long 8192,208,4,0
    .long 8192,224,4,0
    .long 8192,240,4,0
    .long 10240,192,1073741824,0
    .long 10240,208,1073741824,0
    .long 10240,224,1073741824,0
    .long 10240,240,1073741824,0
    .long 12288,192,1073741824,0
    .long 12288,208,1073741824,0
    .long 12288,224,1073741824,0
    .long 12288,240,1073741824,0
    .long 14336,192,1073741824,0
    .long 14336,208,1073741824,0
    .long 14336,224,1073741824,0
    .long 14336,240,1073741824,0
    .long 0,256,0,0
    .long 0,272,0,0
    .long 0,288,0,0
    .long 0,304,0,0
    .long 2048,256,1073741824,0
    .long 2048,272,1073741824,0
    .long 2048,288,1073741824,0
    .long 2048,304,1073741824,0
    .long 4096,256,1073741824,0
    .long 4096,272,1073741824,0
    .long 4096,288,1073741824,0
    .long 4096,304,1073741824,0
    .long 6144,256,1073741824,0
    .long 6144,272,1073741824,0
    .long 6144,288,1073741824,0
    .long 6144,304,1073741824,0
    .long 0,320,0,0
    .long 0,336,0,0
    .long 0,352,0,0
    .long 0,368,0,0
    .long 2048,320,1073741824,0
    .long 2048,336,1073741824,0
    .long 2048,352,1073741824,0
    .long 2048,368,1073741824,0
    .long 4096,320,1073741824,0
    .long 4096,336,1073741824,0
    .long 4096,352,1073741824,0
    .long 4096,368,1073741824,0
    .long 6144,320,1073741824,0
    .long 6144,336,1073741824,0
    .long 6144,352,1073741824,0
    .long 6144,368,1073741824,0
    .long 8192,256,4,0
    .long 8192,272,4,0
    .long 8192,288,4,0
    .long 8192,304,4,0
    .long 10240,256,1073741824,0
    .long 10240,272,1073741824,0
    .long 10240,288,1073741824,0
    .long 10240,304,1073741824,0
    .long 12288,256,1073741824,0
    .long 12288,272,1073741824,0
    .long 12288,288,1073741824,0
    .long 12288,304,1073741824,0
    .long 14336,256,1073741824,0
    .long 14336,272,1073741824,0
    .long 14336,288,1073741824,0
    .long 14336,304,1073741824,0
    .long 8192,320,4,0
    .long 8192,336,4,0
    .long 8192,352,4,0
    .long 8192,368,4,0
    .long 10240,320,1073741824,0
    .long 10240,336,1073741824,0
    .long 10240,352,1073741824,0
    .long 10240,368,1073741824,0
    .long 12288,320,1073741824,0
    .long 12288,336,1073741824,0
    .long 12288,352,1073741824,0
    .long 12288,368,1073741824,0
    .long 14336,320,1073741824,0
    .long 14336,336,1073741824,0
    .long 14336,352,1073741824,0
    .long 14336,368,1073741824,0
    .long 0,384,0,0
    .long 0,400,0,0
    .long 0,416,0,0
    .long 0,432,0,0
    .long 2048,384,1073741824,0
    .long 2048,400,1073741824,0
    .long 2048,416,1073741824,0
    .long 2048,432,1073741824,0
    .long 4096,384,1073741824,0
    .long 4096,400,1073741824,0
    .long 4096,416,1073741824,0
    .long 4096,432,1073741824,0
    .long 6144,384,1073741824,0
    .long 6144,400,1073741824,0
    .long 6144,416,1073741824,0
    .long 6144,432,1073741824,0
    .long 0,448,0,0
    .long 0,464,0,0
    .long 0,480,0,0
    .long 0,496,0,0
    .long 2048,448,1073741824,0
    .long 2048,464,1073741824,0
    .long 2048,480,1073741824,0
    .long 2048,496,1073741824,0
    .long 4096,448,1073741824,0
    .long 4096,464,1073741824,0
    .long 4096,480,1073741824,0
    .long 4096,496,1073741824,0
    .long 6144,448,1073741824,0
    .long 6144,464,1073741824,0
    .long 6144,480,1073741824,0
    .long 6144,496,1073741824,0
    .long 8192,384,4,0
    .long 8192,400,4,0
    .long 8192,416,4,0
    .long 8192,432,4,0
    .long 10240,384,1073741824,0
    .long 10240,400,1073741824,0
    .long 10240,416,1073741824,0
    .long 10240,432,1073741824,0
    .long 12288,384,1073741824,0
    .long 12288,400,1073741824,0
    .long 12288,416,1073741824,0
    .long 12288,432,1073741824,0
    .long 14336,384,1073741824,0
    .long 14336,400,1073741824,0
    .long 14336,416,1073741824,0
    .long 14336,432,1073741824,0
    .long 8192,448,4,0
    .long 8192,464,4,0
    .long 8192,480,4,0
    .long 8192,496,4,0
    .long 10240,448,1073741824,0
    .long 10240,464,1073741824,0
    .long 10240,480,1073741824,0
    .long 10240,496,1073741824,0
    .long 12288,448,1073741824,0
    .long 12288,464,1073741824,0
    .long 12288,480,1073741824,0
    .long 12288,496,1073741824,0
    .long 14336,448,1073741824,0
    .long 14336,464,1073741824,0
    .long 14336,480,1073741824,0
    .long 14336,496,1073741824,0
    .long 0,16560,31848,47136
    .long 80,16640,31928,47216
    .long 160,15448,32008,47296
    .long 240,15528,32088,47376
    .long 320,15608,30896,47456
    .long 400,15688,30976,47536
    .long 480,15768,31056,46344
    .long 560,15848,31136,46424
    .long 640,15928,31216,46504
    .long 720,16008,31296,46584
    .long 800,16088,31376,46664
    .long 880,16168,31456,46744
    .long 960,16248,31536,46824
    .long 1040,16328,31616,46904
    .long 1120,16408,31696,46984
    .long 1200,16488,31776,47064
    .long 8,16568,31856,47144
    .long 88,16648,31936,47224
    .long 168,15456,32016,47304
    .long 248,15536,32096,47384
    .long 328,15616,30904,47464
    .long 408,15696,30984,47544
    .long 488,15776,31064,47552
    .long 568,15856,31144,47632
    .long 648,15936,31224,47712
    .long 728,16016,31304,47792
    .long 808,16096,31384,47872
    .long 888,16176,31464,47560
    .long 968,16256,31544,47640
    .long 1048,16336,31624,47720
    .long 1128,16416,31704,47800
    .long 1208,16496,31784,47880
    .long 16,16576,31864,47568
    .long 96,16656,31944,47648
    .long 176,15464,32024,47728
    .long 256,15544,32104,47808
    .long 336,15624,30912,47888
    .long 416,15704,30992,47576
    .long 496,15784,31072,47656
    .long 576,15864,31152,47736
    .long 656,15944,31232,47816
    .long 736,16024,31312,47896
    .long 816,16104,31392,47584
    .long 896,16184,31472,47664
    .long 976,16264,31552,47744
    .long 1056,16344,31632,47824
    .long 1136,16424,31712,47904
    .long 1216,16504,31792,47592
    .long 24,16584,31872,47672
    .long 104,16664,31952,47752
    .long 184,15472,32032,47832
    .long 264,15552,32112,47912
    .long 344,15632,30920,47600
    .long 424,15712,31000,47680
    .long 504,15792,31080,47760
    .long 584,15872,31160,47840
    .long 664,15952,31240,47920
    .long 744,16032,31320,47608
    .long 824,16112,31400,47688
    .long 904,16192,31480,47768
    .long 984,16272,31560,47848
    .long 1064,16352,31640,47928
    .long 1144,16432,31720,47616
    .long 1224,16512,31800,47696
    .long 32,16592,31880,47776
    .long 112,16672,31960,47856
    .long 192,15480,32040,47936
    .long 272,15560,32120,47624
    .long 352,15640,32128,47704
    .long 432,15720,32208,47784
    .long 512,15800,32288,47864
    .long 592,15880,32368,47944
    .long 672,15960,32448,47944
    .long 752,16040,32136,47944
    .long 832,16120,32216,47944
    .long 912,16200,32296,47944
    .long 992,16280,32376,47944
    .long 1072,16360,32456,47944
    .long 1152,16440,32144,47944
    .long 1232,16520,32224,47944
    .long 40,16600,32304,47944
    .long 120,16680,32384,47944
    .long 200,15488,32464,47944
    .long 280,15568,32152,47944
    .long 360,15648,32232,47944
    .long 440,15728,32312,47944
    .long 520,15808,32392,47944
    .long 600,15888,32472,47944
    .long 680,15968,32160,47944
    .long 760,16048,32240,47944
    .long 840,16128,32320,47944
    .long 920,16208,32400,47944
    .long 1000,16288,32480,47944
    .long 1080,16368,32168,47944
    .long 1160,16448,32248,47944
    .long 1240,16528,32328,47944
    .long 48,16608,32408,47944
    .long 128,16688,32488,47944
    .long 208,15496,32176,47944
    .long 288,15576,32256,47944
    .long 368,15656,32336,47944
    .long 448,15736,32416,47944
    .long 528,15816,32496,47944
    .long 608,15896,32184,47944
    .long 688,15976,32264,47944
    .long 768,16056,32344,47944
    .long 848,16136,32424,47944
    .long 928,16216,32504,47944
    .long 1008,16296,32192,47944
    .long 1088,16376,32272,47944
    .long 1168,16456,32352,47944
    .long 1248,16536,32432,47944
    .long 56,16616,32512,47944
    .long 136,16696,32200,47944
    .long 216,16704,32280,47944
    .long 296,16784,32360,47944
    .long 376,16864,32440,47944
    .long 456,16944,32520,47944
    .long 536,17024,46272,47944
    .long 616,16712,46352,47944
    .long 696,16792,46432,47944
    .long 776,16872,46512,47944
    .long 856,16952,46592,47944
    .long 936,17032,46672,47944
    .long 1016,16720,46752,47944
    .long 1096,16800,46832,47944
    .long 1176,16880,46912,47944
    .long 1256,16960,46992,47944
    .long 64,17040,47072,47944
    .long 144,16728,47152,47944
    .long 224,16808,47232,47944
    .long 304,16888,47312,47944
    .long 384,16968,47392,47944
    .long 464,17048,47472,47944
    .long 544,16736,46280,47944
    .long 624,16816,46360,47944
    .long 704,16896,46440,47944
    .long 784,16976,46520,47944
    .long 864,17056,46600,47944
    .long 944,16744,46680,47944
    .long 1024,16824,46760,47944
    .long 1104,16904,46840,47944
    .long 1184,16984,46920,47944
    .long 1264,17064,47000,47944
    .long 72,16752,47080,47944
    .long 152,16832,47160,47944
    .long 232,16912,47240,47944
    .long 312,16992,47320,47944
    .long 392,17072,47400,47944
    .long 472,16760,47480,47944
    .long 552,16840,46288,47944
    .long 632,16920,46368,47944
    .long 712,17000,46448,47944
    .long 792,17080,46528,47944
    .long 872,16768,46608,47944
    .long 952,16848,46688,47944
    .long 1032,16928,46768,47944
    .long 1112,17008,46848,47944
    .long 1192,17088,46928,47944
    .long 1272,16776,47008,47944
    .long 1280,16856,47088,47944
    .long 1360,16936,47168,47944
    .long 1440,17016,47248,47944
    .long 1520,17096,47328,47944
    .long 1600,30848,47408,47944
    .long 1288,30928,47488,47944
    .long 1368,31008,46296,47944
    .long 1448,31088,46376,47944
    .long 1528,31168,46456,47944
    .long 1608,31248,46536,47944
    .long 1296,31328,46616,47944
    .long 1376,31408,46696,47944
    .long 1456,31488,46776,47944
    .long 1536,31568,46856,47944
    .long 1616,31648,46936,47944
    .long 1304,31728,47016,47944
    .long 1384,31808,47096,47944
    .long 1464,31888,47176,47944
    .long 1544,31968,47256,47944
    .long 1624,32048,47336,47944
    .long 1312,30856,47416,47944
    .long 1392,30936,47496,47944
    .long 1472,31016,46304,47944
    .long 1552,31096,46384,47944
    .long 1632,31176,46464,47944
    .long 1320,31256,46544,47944
    .long 1400,31336,46624,47944
    .long 1480,31416,46704,47944
    .long 1560,31496,46784,47944
    .long 1640,31576,46864,47944
    .long 1328,31656,46944,47944
    .long 1408,31736,47024,47944
    .long 1488,31816,47104,47944
    .long 1568,31896,47184,47944
    .long 1648,31976,47264,47944
    .long 1336,32056,47344,47944
    .long 1416,30864,47424,47944
    .long 1496,30944,47504,47944
    .long 1576,31024,46312,47944
    .long 1656,31104,46392,47944
    .long 1344,31184,46472,47944
    .long 1424,31264,46552,47944
    .long 1504,31344,46632,47944
    .long 1584,31424,46712,47944
    .long 1664,31504,46792,47944
    .long 1352,31584,46872,47944
    .long 1432,31664,46952,47944
    .long 1512,31744,47032,47944
    .long 1592,31824,47112,47944
    .long 1672,31904,47192,47944
    .long 15424,31984,47272,47944
    .long 15504,32064,47352,47944
    .long 15584,30872,47432,47944
    .long 15664,30952,47512,47944
    .long 15744,31032,46320,47944
    .long 15824,31112,46400,47944
    .long 15904,31192,46480,47944
    .long 15984,31272,46560,47944
    .long 16064,31352,46640,47944
    .long 16144,31432,46720,47944
    .long 16224,31512,46800,47944
    .long 16304,31592,46880,47944
    .long 16384,31672,46960,47944
    .long 16464,31752,47040,47944
    .long 16544,31832,47120,47944
    .long 16624,31912,47200,47944
    .long 15432,31992,47280,47944
    .long 15512,32072,47360,47944
    .long 15592,30880,47440,47944
    .long 15672,30960,47520,47944
    .long 15752,31040,46328,47944
    .long 15832,31120,46408,47944
    .long 15912,31200,46488,47944
    .long 15992,31280,46568,47944
    .long 16072,31360,46648,47944
    .long 16152,31440,46728,47944
    .long 16232,31520,46808,47944
    .long 16312,31600,46888,47944
    .long 16392,31680,46968,47944
    .long 16472,31760,47048,47944
    .long 16552,31840,47128,47944
    .long 16632,31920,47208,47944
    .long 15440,32000,47288,47944
    .long 15520,32080,47368,47944
    .long 15600,30888,47448,47944
    .long 15680,30968,47528,47944
    .long 15760,31048,46336,47944
    .long 15840,31128,46416,47944
    .long 15920,31208,46496,47944
    .long 16000,31288,46576,47944
    .long 16080,31368,46656,47944
    .long 16160,31448,46736,47944
    .long 16240,31528,46816,47944
    .long 16320,31608,46896,47944
    .long 16400,31688,46976,47944
    .long 16480,31768,47056,47944
    .long 0,2160,4320,6480
    .long 8,2168,4328,6488
    .long 16,2176,4336,6496
    .long 24,2184,4344,6504
    .long 32,2192,4352,6512
    .long 40,2200,4360,6520
    .long 48,2208,4368,6528
    .long 56,2216,4376,6536
    .long 64,2224,4384,6544
    .long 72,2232,4392,6552
    .long 80,2240,4400,6560
    .long 88,2248,4408,6568
    .long 96,2256,4416,6576
    .long 104,2264,4424,6584
    .long 112,2272,4432,6592
    .long 120,2280,4440,6600
    .long 128,2288,4448,6608
    .long 136,2296,4456,6616
    .long 144,2304,4464,6624
    .long 152,2312,4472,6632
    .long 160,2320,4480,6640
    .long 168,2328,4488,6648
    .long 176,2336,4496,6656
    .long 184,2344,4504,6664
    .long 192,2352,4512,6672
    .long 200,2360,4520,6680
    .long 208,2368,4528,6688
    .long 216,2376,4536,6696
    .long 224,2384,4544,6704
    .long 232,2392,4552,6712
    .long 240,2400,4560,6720
    .long 248,2408,4568,6728
    .long 256,2416,4576,6736
    .long 264,2424,4584,6744
    .long 272,2432,4592,6752
    .long 280,2440,4600,6760
    .long 288,2448,4608,6768
    .long 296,2456,4616,6776
    .long 304,2464,4624,6784
    .long 312,2472,4632,6792
    .long 320,2480,4640,6800
    .long 328,2488,4648,6808
    .long 336,2496,4656,6816
    .long 344,2504,4664,6824
    .long 352,2512,4672,6832
    .long 360,2520,4680,6840
    .long 368,2528,4688,6848
    .long 376,2536,4696,6856
    .long 384,2544,4704,6864
    .long 392,2552,4712,6872
    .long 400,2560,4720,6880
    .long 408,2568,4728,6888
    .long 416,2576,4736,6896
    .long 424,2584,4744,6904
    .long 432,2592,4752,6912
    .long 440,2600,4760,6920
    .long 448,2608,4768,6928
    .long 456,2616,4776,6936
    .long 464,2624,4784,6944
    .long 472,2632,4792,6952
    .long 480,2640,4800,6960
    .long 488,2648,4808,6968
    .long 496,2656,4816,6976
    .long 504,2664,4824,6984
    .long 512,2672,4832,6992
    .long 520,2680,4840,7000
    .long 528,2688,4848,7008
    .long 536,2696,4856,7016
    .long 544,2704,4864,7024
    .long 552,2712,4872,7032
    .long 560,2720,4880,7040
    .long 568,2728,4888,7048
    .long 576,2736,4896,7048
    .long 584,2744,4904,7048
    .long 592,2752,4912,7048
    .long 600,2760,4920,7048
    .long 608,2768,4928,7048
    .long 616,2776,4936,7048
    .long 624,2784,4944,7048
    .long 632,2792,4952,7048
    .long 640,2800,4960,7048
    .long 648,2808,4968,7048
    .long 656,2816,4976,7048
    .long 664,2824,4984,7048
    .long 672,2832,4992,7048
    .long 680,2840,5000,7048
    .long 688,2848,5008,7048
    .long 696,2856,5016,7048
    .long 704,2864,5024,7048
    .long 712,2872,5032,7048
    .long 720,2880,5040,7048
    .long 728,2888,5048,7048
    .long 736,2896,5056,7048
    .long 744,2904,5064,7048
    .long 752,2912,5072,7048
    .long 760,2920,5080,7048
    .long 768,2928,5088,7048
    .long 776,2936,5096,7048
    .long 784,2944,5104,7048
    .long 792,2952,5112,7048
    .long 800,2960,5120,7048
    .long 808,2968,5128,7048
    .long 816,2976,5136,7048
    .long 824,2984,5144,7048
    .long 832,2992,5152,7048
    .long 840,3000,5160,7048
    .long 848,3008,5168,7048
    .long 856,3016,5176,7048
    .long 864,3024,5184,7048
    .long 872,3032,5192,7048
    .long 880,3040,5200,7048
    .long 888,3048,5208,7048
    .long 896,3056,5216,7048
    .long 904,3064,5224,7048
    .long 912,3072,5232,7048
    .long 920,3080,5240,7048
    .long 928,3088,5248,7048
    .long 936,3096,5256,7048
    .long 944,3104,5376,7048
    .long 952,3112,5384,7048
    .long 960,3120,5392,7048
    .long 968,3128,5400,7048
    .long 976,3136,5408,7048
    .long 984,3144,5416,7048
    .long 992,3152,5424,7048
    .long 1000,3160,5432,7048
    .long 1008,3168,5440,7048
    .long 1016,3176,5448,7048
    .long 1024,3184,5456,7048
    .long 1032,3192,5464,7048
    .long 1040,3200,5472,7048
    .long 1048,3208,5480,7048
    .long 1056,3216,5488,7048
    .long 1064,3224,5496,7048
    .long 1072,3232,5504,7048
    .long 1080,3240,5512,7048
    .long 1088,3248,5520,7048
    .long 1096,3256,5528,7048
    .long 1104,3264,5536,7048
    .long 1112,3272,5544,7048
    .long 1120,3280,5552,7048
    .long 1128,3288,5560,7048
    .long 1136,3296,5568,7048
    .long 1144,3304,5576,7048
    .long 1152,3312,5584,7048
    .long 1160,3320,5592,7048
    .long 1168,3328,5600,7048
    .long 1176,3336,5608,7048
    .long 1184,3344,5616,7048
    .long 1192,3352,5624,7048
    .long 1200,3360,5632,7048
    .long 1208,3368,5640,7048
    .long 1216,3376,5648,7048
    .long 1224,3384,5656,7048
    .long 1232,3392,5664,7048
    .long 1240,3400,5672,7048
    .long 1248,3408,5680,7048
    .long 1256,3416,5688,7048
    .long 1264,3424,5696,7048
    .long 1272,3432,5704,7048
    .long 1280,3440,5712,7048
    .long 1288,3448,5720,7048
    .long 1296,3456,5728,7048
    .long 1304,3464,5736,7048
    .long 1312,3584,5744,7048
    .long 1320,3592,5752,7048
    .long 1328,3600,5760,7048
    .long 1336,3608,5768,7048
    .long 1344,3616,5776,7048
    .long 1352,3624,5784,7048
    .long 1360,3632,5792,7048
    .long 1368,3640,5800,7048
    .long 1376,3648,5808,7048
    .long 1384,3656,5816,7048
    .long 1392,3664,5824,7048
    .long 1400,3672,5832,7048
    .long 1408,3680,5840,7048
    .long 1416,3688,5848,7048
    .long 1424,3696,5856,7048
    .long 1432,3704,5864,7048
    .long 1440,3712,5872,7048
    .long 1448,3720,5880,7048
    .long 1456,3728,5888,7048
    .long 1464,3736,5896,7048
    .long 1472,3744,5904,7048
    .long 1480,3752,5912,7048
    .long 1488,3760,5920,7048
    .long 1496,3768,5928,7048
    .long 1504,3776,5936,7048
    .long 1512,3784,5944,7048
    .long 1520,3792,5952,7048
    .long 1528,3800,5960,7048
    .long 1536,3808,5968,7048
    .long 1544,3816,5976,7048
    .long 1552,3824,5984,7048
    .long 1560,3832,5992,7048
    .long 1568,3840,6000,7048
    .long 1576,3848,6008,7048
    .long 1584,3856,6016,7048
    .long 1592,3864,6024,7048
    .long 1600,3872,6032,7048
    .long 1608,3880,6040,7048
    .long 1616,3888,6048,7048
    .long 1624,3896,6056,7048
    .long 1632,3904,6064,7048
    .long 1640,3912,6072,7048
    .long 1648,3920,6080,7048
    .long 1656,3928,6088,7048
    .long 1664,3936,6096,7048
    .long 1672,3944,6104,7048
    .long 1792,3952,6112,7048
    .long 1800,3960,6120,7048
    .long 1808,3968,6128,7048
    .long 1816,3976,6136,7048
    .long 1824,3984,6144,7048
    .long 1832,3992,6152,7048
    .long 1840,4000,6160,7048
    .long 1848,4008,6168,7048
    .long 1856,4016,6176,7048
    .long 1864,4024,6184,7048
    .long 1872,4032,6192,7048
    .long 1880,4040,6200,7048
    .long 1888,4048,6208,7048
    .long 1896,4056,6216,7048
    .long 1904,4064,6224,7048
    .long 1912,4072,6232,7048
    .long 1920,4080,6240,7048
    .long 1928,4088,6248,7048
    .long 1936,4096,6256,7048
    .long 1944,4104,6264,7048
    .long 1952,4112,6272,7048
    .long 1960,4120,6280,7048
    .long 1968,4128,6288,7048
    .long 1976,4136,6296,7048
    .long 1984,4144,6304,7048
    .long 1992,4152,6312,7048
    .long 2000,4160,6320,7048
    .long 2008,4168,6328,7048
    .long 2016,4176,6336,7048
    .long 2024,4184,6344,7048
    .long 2032,4192,6352,7048
    .long 2040,4200,6360,7048
    .long 2048,4208,6368,7048
    .long 2056,4216,6376,7048
    .long 2064,4224,6384,7048
    .long 2072,4232,6392,7048
    .long 2080,4240,6400,7048
    .long 2088,4248,6408,7048
    .long 2096,4256,6416,7048
    .long 2104,4264,6424,7048
    .long 2112,4272,6432,7048
    .long 2120,4280,6440,7048
    .long 2128,4288,6448,7048
    .long 2136,4296,6456,7048
    .long 2144,4304,6464,7048
    .long 2152,4312,6472,7048
    .long 0,31808,122880,122944
    .long 16,31824,123008,123072
    .long 32,31840,123152,123216
    .long 48,31856,123280,123344
    .long 64,31744,123424,123488
    .long 80,31760,123552,123616
    .long 96,31776,123696,123760
    .long 112,31792,123824,123888
    .long 4096,35904,123968,123904
    .long 4112,35920,124096,124032
    .long 4128,35936,124240,124176
    .long 4144,35952,124368,124304
    .long 4160,35840,124512,124448
    .long 4176,35856,124640,124576
    .long 4192,35872,124784,124720
    .long 4208,35888,124912,124848
    .long 8208,40016,122896,122960
    .long 8192,40000,123024,123088
    .long 8240,40048,123136,123200
    .long 8224,40032,123264,123328
    .long 8272,39952,123440,123504
    .long 8256,39936,123568,123632
    .long 8304,39984,123680,123744
    .long 8288,39968,123808,123872
    .long 12304,44112,123984,123920
    .long 12288,44096,124112,124048
    .long 12336,44144,124224,124160
    .long 12320,44128,124352,124288
    .long 12368,44048,124528,124464
    .long 12352,44032,124656,124592
    .long 12400,44080,124768,124704
    .long 12384,44064,124896,124832
    .long 16416,48224,122912,122976
    .long 16432,48240,123040,123104
    .long 16384,48192,123184,123248
    .long 16400,48208,123312,123376
    .long 16480,48160,123392,123456
    .long 16496,48176,123520,123584
    .long 16448,48128,123664,123728
    .long 16464,48144,123792,123856
    .long 20512,52320,124000,123936
    .long 20528,52336,124128,124064
    .long 20480,52288,124272,124208
    .long 20496,52304,124400,124336
    .long 20576,52256,124480,124416
    .long 20592,52272,124608,124544
    .long 20544,52224,124752,124688
    .long 20560,52240,124880,124816
    .long 24624,56432,122928,122992
    .long 24608,56416,123056,123120
    .long 24592,56400,123168,123232
    .long 24576,56384,123296,123360
    .long 24688,56368,123408,123472
    .long 24672,56352,123536,123600
    .long 24656,56336,123648,123712
    .long 24640,56320,123776,123840
    .long 28720,60528,124016,123952
    .long 28704,60512,124144,124080
    .long 28688,60496,124256,124192
    .long 28672,60480,124384,124320
    .long 28784,60464,124496,124432
    .long 28768,60448,124624,124560
    .long 28752,60432,124736,124672
    .long 28736,60416,124864,124800
    .long 1024,32832,131072,131136
    .long 1040,32848,131200,131264
    .long 1056,32864,131344,131408
    .long 1072,32880,131472,131536
    .long 1088,32768,131616,131680
    .long 1104,32784,131744,131808
    .long 1120,32800,131888,131952
    .long 1136,32816,132016,132080
    .long 5120,36928,132160,132096
    .long 5136,36944,132288,132224
    .long 5152,36960,132432,132368
    .long 5168,36976,132560,132496
    .long 5184,36864,132704,132640
    .long 5200,36880,132832,132768
    .long 5216,36896,132976,132912
    .long 5232,36912,133104,133040
    .long 9232,41040,131088,131152
    .long 9216,41024,131216,131280
    .long 9264,41072,131328,131392
    .long 9248,41056,131456,131520
    .long 9296,40976,131632,131696
    .long 9280,40960,131760,131824
    .long 9328,41008,131872,131936
    .long 9312,40992,132000,132064
    .long 13328,45136,132176,132112
    .long 13312,45120,132304,132240
    .long 13360,45168,132416,132352
    .long 13344,45152,132544,132480
    .long 13392,45072,132720,132656
    .long 13376,45056,132848,132784
    .long 13424,45104,132960,132896
    .long 13408,45088,133088,133024
    .long 17440,49248,131104,131168
    .long 17456,49264,131232,131296
    .long 17408,49216,131376,131440
    .long 17424,49232,131504,131568
    .long 17504,49184,131584,131648
    .long 17520,49200,131712,131776
    .long 17472,49152,131856,131920
    .long 17488,49168,131984,132048
    .long 21536,53344,132192,132128
    .long 21552,53360,132320,132256
    .long 21504,53312,132464,132400
    .long 21520,53328,132592,132528
    .long 21600,53280,132672,132608
    .long 21616,53296,132800,132736
    .long 21568,53248,132944,132880
    .long 21584,53264,133072,133008
    .long 25648,57456,131120,131184
    .long 25632,57440,131248,131312
    .long 25616,57424,131360,131424
    .long 25600,57408,131488,131552
    .long 25712,57392,131600,131664
    .long 25696,57376,131728,131792
    .long 25680,57360,131840,131904
    .long 25664,57344,131968,132032
    .long 29744,61552,132208,132144
    .long 29728,61536,132336,132272
    .long 29712,61520,132448,132384
    .long 29696,61504,132576,132512
    .long 29808,61488,132688,132624
    .long 29792,61472,132816,132752
    .long 29776,61456,132928,132864
    .long 29760,61440,133056,132992
    .long 2048,33856,139264,139328
    .long 2064,33872,139392,139456
    .long 2080,33888,139536,139600
    .long 2096,33904,139664,139728
    .long 2112,33792,139808,139872
    .long 2128,33808,139936,140000
    .long 2144,33824,140080,140144
    .long 2160,33840,140208,140272
    .long 6144,37952,140352,140288
    .long 6160,37968,140480,140416
    .long 6176,37984,140624,140560
    .long 6192,38000,140752,140688
    .long 6208,37888,140896,140832
    .long 6224,37904,141024,140960
    .long 6240,37920,141168,141104
    .long 6256,37936,141296,141232
    .long 10256,42064,139280,139344
    .long 10240,42048,139408,139472
    .long 10288,42096,139520,139584
    .long 10272,42080,139648,139712
    .long 10320,42000,139824,139888
    .long 10304,41984,139952,140016
    .long 10352,42032,140064,140128
    .long 10336,42016,140192,140256
    .long 14352,46160,140368,140304
    .long 14336,46144,140496,140432
    .long 14384,46192,140608,140544
    .long 14368,46176,140736,140672
    .long 14416,46096,140912,140848
    .long 14400,46080,141040,140976
    .long 14448,46128,141152,141088
    .long 14432,46112,141280,141216
    .long 18464,50272,139296,139360
    .long 18480,50288,139424,139488
    .long 18432,50240,139568,139632
    .long 18448,50256,139696,139760
    .long 18528,50208,139776,139840
    .long 18544,50224,139904,139968
    .long 18496,50176,140048,140112
    .long 18512,50192,140176,140240
    .long 22560,54368,140384,140320
    .long 22576,54384,140512,140448
    .long 22528,54336,140656,140592
    .long 22544,54352,140784,140720
    .long 22624,54304,140864,140800
    .long 22640,54320,140992,140928
    .long 22592,54272,141136,141072
    .long 22608,54288,141264,141200
    .long 26672,58480,139312,139376
    .long 26656,58464,139440,139504
    .long 26640,58448,139552,139616
    .long 26624,58432,139680,139744
    .long 26736,58416,139792,139856
    .long 26720,58400,139920,139984
    .long 26704,58384,140032,140096
    .long 26688,58368,140160,140224
    .long 30768,62576,140400,140336
    .long 30752,62560,140528,140464
    .long 30736,62544,140640,140576
    .long 30720,62528,140768,140704
    .long 30832,62512,140880,140816
    .long 30816,62496,141008,140944
    .long 30800,62480,141120,141056
    .long 30784,62464,141248,141184
    .long 3072,34880,147456,147520
    .long 3088,34896,147584,147648
    .long 3104,34912,147728,147792
    .long 3120,34928,147856,147920
    .long 3136,34816,148000,148064
    .long 3152,34832,148128,148192
    .long 3168,34848,148272,148336
    .long 3184,34864,148400,148464
    .long 7168,38976,148544,148480
    .long 7184,38992,148672,148608
    .long 7200,39008,148816,148752
    .long 7216,39024,148944,148880
    .long 7232,38912,149088,149024
    .long 7248,38928,149216,149152
    .long 7264,38944,149360,149296
    .long 7280,38960,149488,149424
    .long 11280,43088,147472,147536
    .long 11264,43072,147600,147664
    .long 11312,43120,147712,147776
    .long 11296,43104,147840,147904
    .long 11344,43024,148016,148080
    .long 11328,43008,148144,148208
    .long 11376,43056,148256,148320
    .long 11360,43040,148384,148448
    .long 15376,47184,148560,148496
    .long 15360,47168,148688,148624
    .long 15408,47216,148800,148736
    .long 15392,47200,148928,148864
    .long 15440,47120,149104,149040
    .long 15424,47104,149232,149168
    .long 15472,47152,149344,149280
    .long 15456,47136,149472,149408
    .long 19488,51296,147488,147552
    .long 19504,51312,147616,147680
    .long 19456,51264,147760,147824
    .long 19472,51280,147888,147952
    .long 19552,51232,147968,148032
    .long 19568,51248,148096,148160
    .long 19520,51200,148240,148304
    .long 19536,51216,148368,148432
    .long 23584,55392,148576,148512
    .long 23600,55408,148704,148640
    .long 23552,55360,148848,148784
    .long 23568,55376,148976,148912
    .long 23648,55328,149056,148992
    .long 23664,55344,149184,149120
    .long 23616,55296,149328,149264
    .long 23632,55312,149456,149392
    .long 27696,59504,147504,147568
    .long 27680,59488,147632,147696
    .long 27664,59472,147744,147808
    .long 27648,59456,147872,147936
    .long 27760,59440,147984,148048
    .long 27744,59424,148112,148176
    .long 27728,59408,148224,148288
    .long 27712,59392,148352,148416
    .long 31792,63600,148592,148528
    .long 31776,63584,148720,148656
    .long 31760,63568,148832,148768
    .long 31744,63552,148960,148896
    .long 31856,63536,149072,149008
    .long 31840,63520,149200,149136
    .long 31824,63504,149312,149248
    .long 31808,63488,149440,149376
    .long 0,162560,0,1600
    .long 4,162560,80,159488
    .long 8,162560,160,159488
    .long 12,162560,240,159488
    .long 16,162560,159488,159488
    .long 20,162560,159488,159488
    .long 24,162560,159488,159488
    .long 28,162560,159488,159488
    .long 0,162560,159488,159488
    .long 4,162560,159488,159488
    .long 8,162560,159488,159488
    .long 12,162560,159488,159488
    .long 16,162560,159488,159488
    .long 20,162560,159488,159488
    .long 24,162560,159488,159488
    .long 28,162560,159488,159488
    .long 0,162576,159488,159488
    .long 4,162576,159488,159488
    .long 8,162576,159488,159488
    .long 12,162576,159488,159488
    .long 16,162576,15424,17024
    .long 20,162576,15504,159488
    .long 24,162576,15584,159488
    .long 28,162576,15664,159488
    .long 0,162576,159488,159488
    .long 4,162576,159488,159488
    .long 8,162576,159488,159488
    .long 12,162576,159488,159488
    .long 16,162576,159488,159488
    .long 20,162576,159488,159488
    .long 24,162576,159488,159488
    .long 28,162576,159488,159488
    .long 0,162592,159488,159488
    .long 4,162592,159488,159488
    .long 8,162592,159488,159488
    .long 12,162592,159488,159488
    .long 16,162592,159488,159488
    .long 20,162592,159488,159488
    .long 24,162592,159488,159488
    .long 28,162592,159488,159488
    .long 0,162592,30848,32448
    .long 4,162592,30928,159488
    .long 8,162592,31008,159488
    .long 12,162592,31088,159488
    .long 16,162592,159488,159488
    .long 20,162592,159488,159488
    .long 24,162592,159488,159488
    .long 28,162592,159488,159488
    .long 0,162608,159488,159488
    .long 4,162608,159488,159488
    .long 8,162608,159488,159488
    .long 12,162608,159488,159488
    .long 16,162608,159488,159488
    .long 20,162608,159488,159488
    .long 24,162608,159488,159488
    .long 28,162608,159488,159488
    .long 0,162608,159488,159488
    .long 4,162608,159488,159488
    .long 8,162608,159488,159488
    .long 12,162608,159488,159488
    .long 16,162608,46272,47872
    .long 20,162608,46352,159488
    .long 24,162608,46432,159488
    .long 28,162608,46512,159488
    .long 0,162560,0,1600
    .long 4,162560,80,159488
    .long 8,162560,160,159488
    .long 12,162560,240,159488
    .long 16,162560,159488,159488
    .long 20,162560,159488,159488
    .long 24,162560,159488,159488
    .long 28,162560,159488,159488
    .long 0,162560,159488,159488
    .long 4,162560,159488,159488
    .long 8,162560,159488,159488
    .long 12,162560,159488,159488
    .long 16,162560,159488,159488
    .long 20,162560,159488,159488
    .long 24,162560,159488,159488
    .long 28,162560,159488,159488
    .long 0,162576,159488,159488
    .long 4,162576,159488,159488
    .long 8,162576,159488,159488
    .long 12,162576,159488,159488
    .long 16,162576,15424,17024
    .long 20,162576,15504,159488
    .long 24,162576,15584,159488
    .long 28,162576,15664,159488
    .long 0,162576,159488,159488
    .long 4,162576,159488,159488
    .long 8,162576,159488,159488
    .long 12,162576,159488,159488
    .long 16,162576,159488,159488
    .long 20,162576,159488,159488
    .long 24,162576,159488,159488
    .long 28,162576,159488,159488
    .long 0,162592,159488,159488
    .long 4,162592,159488,159488
    .long 8,162592,159488,159488
    .long 12,162592,159488,159488
    .long 16,162592,159488,159488
    .long 20,162592,159488,159488
    .long 24,162592,159488,159488
    .long 28,162592,159488,159488
    .long 0,162592,30848,32448
    .long 4,162592,30928,159488
    .long 8,162592,31008,159488
    .long 12,162592,31088,159488
    .long 16,162592,159488,159488
    .long 20,162592,159488,159488
    .long 24,162592,159488,159488
    .long 28,162592,159488,159488
    .long 0,162608,159488,159488
    .long 4,162608,159488,159488
    .long 8,162608,159488,159488
    .long 12,162608,159488,159488
    .long 16,162608,159488,159488
    .long 20,162608,159488,159488
    .long 24,162608,159488,159488
    .long 28,162608,159488,159488
    .long 0,162608,159488,159488
    .long 4,162608,159488,159488
    .long 8,162608,159488,159488
    .long 12,162608,159488,159488
    .long 16,162608,46272,47872
    .long 20,162608,46352,159488
    .long 24,162608,46432,159488
    .long 28,162608,46512,159488
    .long 0,162560,0,1600
    .long 4,162560,80,159488
    .long 8,162560,160,159488
    .long 12,162560,240,159488
    .long 16,162560,159488,159488
    .long 20,162560,159488,159488
    .long 24,162560,159488,159488
    .long 28,162560,159488,159488
    .long 0,162560,159488,159488
    .long 4,162560,159488,159488
    .long 8,162560,159488,159488
    .long 12,162560,159488,159488
    .long 16,162560,159488,159488
    .long 20,162560,159488,159488
    .long 24,162560,159488,159488
    .long 28,162560,159488,159488
    .long 0,162576,159488,159488
    .long 4,162576,159488,159488
    .long 8,162576,159488,159488
    .long 12,162576,159488,159488
    .long 16,162576,15424,17024
    .long 20,162576,15504,159488
    .long 24,162576,15584,159488
    .long 28,162576,15664,159488
    .long 0,162576,159488,159488
    .long 4,162576,159488,159488
    .long 8,162576,159488,159488
    .long 12,162576,159488,159488
    .long 16,162576,159488,159488
    .long 20,162576,159488,159488
    .long 24,162576,159488,159488
    .long 28,162576,159488,159488
    .long 0,162592,159488,159488
    .long 4,162592,159488,159488
    .long 8,162592,159488,159488
    .long 12,162592,159488,159488
    .long 16,162592,159488,159488
    .long 20,162592,159488,159488
    .long 24,162592,159488,159488
    .long 28,162592,159488,159488
    .long 0,162592,30848,32448
    .long 4,162592,30928,159488
    .long 8,162592,31008,159488
    .long 12,162592,31088,159488
    .long 16,162592,159488,159488
    .long 20,162592,159488,159488
    .long 24,162592,159488,159488
    .long 28,162592,159488,159488
    .long 0,162608,159488,159488
    .long 4,162608,159488,159488
    .long 8,162608,159488,159488
    .long 12,162608,159488,159488
    .long 16,162608,159488,159488
    .long 20,162608,159488,159488
    .long 24,162608,159488,159488
    .long 28,162608,159488,159488
    .long 0,162608,159488,159488
    .long 4,162608,159488,159488
    .long 8,162608,159488,159488
    .long 12,162608,159488,159488
    .long 16,162608,46272,47872
    .long 20,162608,46352,159488
    .long 24,162608,46432,159488
    .long 28,162608,46512,159488
    .long 0,162560,0,1600
    .long 4,162560,80,159488
    .long 8,162560,160,159488
    .long 12,162560,240,159488
    .long 16,162560,159488,159488
    .long 20,162560,159488,159488
    .long 24,162560,159488,159488
    .long 28,162560,159488,159488
    .long 0,162560,159488,159488
    .long 4,162560,159488,159488
    .long 8,162560,159488,159488
    .long 12,162560,159488,159488
    .long 16,162560,159488,159488
    .long 20,162560,159488,159488
    .long 24,162560,159488,159488
    .long 28,162560,159488,159488
    .long 0,162576,159488,159488
    .long 4,162576,159488,159488
    .long 8,162576,159488,159488
    .long 12,162576,159488,159488
    .long 16,162576,15424,17024
    .long 20,162576,15504,159488
    .long 24,162576,15584,159488
    .long 28,162576,15664,159488
    .long 0,162576,159488,159488
    .long 4,162576,159488,159488
    .long 8,162576,159488,159488
    .long 12,162576,159488,159488
    .long 16,162576,159488,159488
    .long 20,162576,159488,159488
    .long 24,162576,159488,159488
    .long 28,162576,159488,159488
    .long 0,162592,159488,159488
    .long 4,162592,159488,159488
    .long 8,162592,159488,159488
    .long 12,162592,159488,159488
    .long 16,162592,159488,159488
    .long 20,162592,159488,159488
    .long 24,162592,159488,159488
    .long 28,162592,159488,159488
    .long 0,162592,30848,32448
    .long 4,162592,30928,159488
    .long 8,162592,31008,159488
    .long 12,162592,31088,159488
    .long 16,162592,159488,159488
    .long 20,162592,159488,159488
    .long 24,162592,159488,159488
    .long 28,162592,159488,159488
    .long 0,162608,159488,159488
    .long 4,162608,159488,159488
    .long 8,162608,159488,159488
    .long 12,162608,159488,159488
    .long 16,162608,159488,159488
    .long 20,162608,159488,159488
    .long 24,162608,159488,159488
    .long 28,162608,159488,159488
    .long 0,162608,159488,159488
    .long 4,162608,159488,159488
    .long 8,162608,159488,159488
    .long 12,162608,159488,159488
    .long 16,162608,46272,47872
    .long 20,162608,46352,159488
    .long 24,162608,46432,159488
    .long 28,162608,46512,159488
    .long 0,162560,0,0
    .long 16,162568,0,0
    .long 32,162576,0,0
    .long 48,162584,0,0
    .long 64,162592,0,0
    .long 80,162600,0,0
    .long 96,162608,0,0
    .long 112,162616,0,0
    .long 128,162624,0,0
    .long 144,162632,0,0
    .long 160,162640,0,0
    .long 176,162648,0,0
    .long 192,162656,0,0
    .long 208,162664,0,0
    .long 224,162672,0,0
    .long 240,162680,0,0
    .long 256,162688,0,0
    .long 272,162696,0,0
    .long 288,162704,0,0
    .long 304,162712,0,0
    .long 320,162720,0,0
    .long 336,162728,0,0
    .long 352,162736,0,0
    .long 368,162744,0,0
    .long 384,162752,0,0
    .long 400,162760,0,0
    .long 416,162768,0,0
    .long 432,162776,0,0
    .long 448,162784,0,0
    .long 464,162792,0,0
    .long 480,162800,0,0
    .long 496,162808,0,0
    .long 512,162816,0,0
    .long 528,162824,0,0
    .long 544,162832,0,0
    .long 560,162840,0,0
    .long 576,162848,0,0
    .long 592,162856,0,0
    .long 608,162864,0,0
    .long 624,162872,0,0
    .long 5120,162880,0,0
    .long 5136,162888,0,0
    .long 5152,162896,0,0
    .long 5168,162904,0,0
    .long 5184,162912,0,0
    .long 5200,162920,0,0
    .long 5216,162928,0,0
    .long 5232,162936,0,0
    .long 5248,162944,0,0
    .long 5264,162952,0,0
    .long 5280,162960,0,0
    .long 5296,162968,0,0
    .long 5312,162976,0,0
    .long 5328,162984,0,0
    .long 5344,162992,0,0
    .long 5360,163000,0,0
    .long 5376,163008,0,0
    .long 5392,163016,0,0
    .long 5408,163024,0,0
    .long 5424,163032,0,0
    .long 5440,163040,0,0
    .long 5456,163048,0,0
    .long 5472,163056,0,0
    .long 5488,163064,0,0
    .long 5504,163072,0,0
    .long 5520,163080,0,0
    .long 5536,163088,0,0
    .long 5552,163096,0,0
    .long 5568,163104,0,0
    .long 5584,163112,0,0
    .long 5600,163120,0,0
    .long 5616,163128,0,0
    .long 5632,163136,0,0
    .long 5648,163144,0,0
    .long 5664,163152,0,0
    .long 5680,163160,0,0
    .long 5696,163168,0,0
    .long 5712,163176,0,0
    .long 5728,163184,0,0
    .long 5744,163192,0,0
    .long 10240,163200,0,0
    .long 10256,163208,0,0
    .long 10272,163216,0,0
    .long 10288,163224,0,0
    .long 10304,163232,0,0
    .long 10320,163240,0,0
    .long 10336,163248,0,0
    .long 10352,163256,0,0
    .long 10368,163264,0,0
    .long 10384,163272,0,0
    .long 10400,163280,0,0
    .long 10416,163288,0,0
    .long 10432,163296,0,0
    .long 10448,163304,0,0
    .long 10464,163312,0,0
    .long 10480,163320,0,0
    .long 10496,163328,0,0
    .long 10512,163336,0,0
    .long 10528,163344,0,0
    .long 10544,163352,0,0
    .long 10560,163360,0,0
    .long 10576,163368,0,0
    .long 10592,163376,0,0
    .long 10608,163384,0,0
    .long 10624,163392,0,0
    .long 10640,163400,0,0
    .long 10656,163408,0,0
    .long 10672,163416,0,0
    .long 10688,163424,0,0
    .long 10704,163432,0,0
    .long 10720,163440,0,0
    .long 10736,163448,0,0
    .long 10752,163456,0,0
    .long 10768,163464,0,0
    .long 10784,163472,0,0
    .long 10800,163480,0,0
    .long 10816,163488,0,0
    .long 10832,163496,0,0
    .long 10848,163504,0,0
    .long 10864,163512,0,0
    .long 15360,163520,0,0
    .long 15376,163528,0,0
    .long 15392,163536,0,0
    .long 15408,163544,0,0
    .long 15424,163552,0,0
    .long 15440,163560,0,0
    .long 15456,163568,0,0
    .long 15472,163576,0,0
    .long 15488,163584,0,0
    .long 15504,163592,0,0
    .long 15520,163600,0,0
    .long 15536,163608,0,0
    .long 15552,163616,0,0
    .long 15568,163624,0,0
    .long 15584,163632,0,0
    .long 15600,163640,0,0
    .long 15616,163648,0,0
    .long 15632,163656,0,0
    .long 15648,163664,0,0
    .long 15664,163672,0,0
    .long 15680,163680,0,0
    .long 15696,163688,0,0
    .long 15712,163696,0,0
    .long 15728,163704,0,0
    .long 15744,163712,0,0
    .long 15760,163720,0,0
    .long 15776,163728,0,0
    .long 15792,163736,0,0
    .long 15808,163744,0,0
    .long 15824,163752,0,0
    .long 15840,163760,0,0
    .long 15856,163768,0,0
    .long 15872,163776,0,0
    .long 15888,163784,0,0
    .long 15904,163792,0,0
    .long 15920,163800,0,0
    .long 15936,163808,0,0
    .long 15952,163816,0,0
    .long 15968,163824,0,0
    .long 15984,163832,0,0
    .long 15984,163832,0,0
    .long 15984,163832,0,0
    .long 15984,163832,0,0
    .long 15984,163832,0,0
    .long 15984,163832,0,0
    .long 15984,163832,0,0
    .long 15984,163832,0,0
    .long 15984,163832,0,0
    .long 15984,163832,0,0
    .long 15984,163832,0,0
    .long 15984,163832,0,0
    .long 15984,163832,0,0
    .long 15984,163832,0,0
    .long 15984,163832,0,0
    .long 15984,163832,0,0
    .long 15984,163832,0,0
    .long 15984,163832,0,0
    .long 15984,163832,0,0
    .long 15984,163832,0,0
    .long 15984,163832,0,0
    .long 15984,163832,0,0
    .long 15984,163832,0,0
    .long 15984,163832,0,0
    .long 15984,163832,0,0
    .long 15984,163832,0,0
    .long 15984,163832,0,0
    .long 15984,163832,0,0
    .long 15984,163832,0,0
    .long 15984,163832,0,0
    .long 15984,163832,0,0
    .long 15984,163832,0,0
    .long 15984,163832,0,0
    .long 15984,163832,0,0
    .long 15984,163832,0,0
    .long 15984,163832,0,0
    .long 15984,163832,0,0
    .long 15984,163832,0,0
    .long 15984,163832,0,0
    .long 15984,163832,0,0
    .long 15984,163832,0,0
    .long 15984,163832,0,0
    .long 15984,163832,0,0
    .long 15984,163832,0,0
    .long 15984,163832,0,0
    .long 15984,163832,0,0
    .long 15984,163832,0,0
    .long 15984,163832,0,0
    .long 15984,163832,0,0
    .long 15984,163832,0,0
    .long 15984,163832,0,0
    .long 15984,163832,0,0
    .long 15984,163832,0,0
    .long 15984,163832,0,0
    .long 15984,163832,0,0
    .long 15984,163832,0,0
    .long 15984,163832,0,0
    .long 15984,163832,0,0
    .long 15984,163832,0,0
    .long 15984,163832,0,0
    .long 15984,163832,0,0
    .long 15984,163832,0,0
    .long 15984,163832,0,0
    .long 15984,163832,0,0
    .long 15984,163832,0,0
    .long 15984,163832,0,0
    .long 15984,163832,0,0
    .long 15984,163832,0,0
    .long 15984,163832,0,0
    .long 15984,163832,0,0
    .long 15984,163832,0,0
    .long 15984,163832,0,0
    .long 15984,163832,0,0
    .long 15984,163832,0,0
    .long 15984,163832,0,0
    .long 15984,163832,0,0
    .long 15984,163832,0,0
    .long 15984,163832,0,0
    .long 15984,163832,0,0
    .long 15984,163832,0,0
    .long 15984,163832,0,0
    .long 15984,163832,0,0
    .long 15984,163832,0,0
    .long 15984,163832,0,0
    .long 15984,163832,0,0
    .long 15984,163832,0,0
    .long 15984,163832,0,0
    .long 15984,163832,0,0
    .long 15984,163832,0,0
    .long 15984,163832,0,0
    .long 15984,163832,0,0
    .long 15984,163832,0,0
    .long 15984,163832,0,0
    .long 15984,163832,0,0
    .long 15984,163832,0,0
    .long 15984,163832,0,0
    .long 15984,163832,0,0
    .long 0,0,0,0
    .long 0,4,4,0
    .long 0,8,8,0
    .long 0,12,12,0
    .long 0,16,16,0
    .long 0,20,20,0
    .long 0,24,24,0
    .long 0,28,28,0
    .long 0,32,32,0
    .long 0,36,36,0
    .long 0,40,40,0
    .long 0,44,44,0
    .long 0,48,48,0
    .long 0,52,52,0
    .long 0,56,56,0
    .long 0,60,60,0
    .long 0,1073741824,256,0
    .long 0,1073741824,260,0
    .long 0,1073741824,264,0
    .long 0,1073741824,268,0
    .long 0,1073741824,272,0
    .long 0,1073741824,276,0
    .long 0,1073741824,280,0
    .long 0,1073741824,284,0
    .long 0,1073741824,288,0
    .long 0,1073741824,292,0
    .long 0,1073741824,296,0
    .long 0,1073741824,300,0
    .long 0,1073741824,304,0
    .long 0,1073741824,308,0
    .long 0,1073741824,312,0
    .long 0,1073741824,316,0
    .long 0,64,512,0
    .long 0,68,516,0
    .long 0,72,520,0
    .long 0,76,524,0
    .long 0,80,528,0
    .long 0,84,532,0
    .long 0,88,536,0
    .long 0,92,540,0
    .long 0,96,544,0
    .long 0,100,548,0
    .long 0,104,552,0
    .long 0,108,556,0
    .long 0,112,560,0
    .long 0,116,564,0
    .long 0,120,568,0
    .long 0,124,572,0
    .long 0,1073741824,768,0
    .long 0,1073741824,772,0
    .long 0,1073741824,776,0
    .long 0,1073741824,780,0
    .long 0,1073741824,784,0
    .long 0,1073741824,788,0
    .long 0,1073741824,792,0
    .long 0,1073741824,796,0
    .long 0,1073741824,800,0
    .long 0,1073741824,804,0
    .long 0,1073741824,808,0
    .long 0,1073741824,812,0
    .long 0,1073741824,816,0
    .long 0,1073741824,820,0
    .long 0,1073741824,824,0
    .long 0,1073741824,828,0
    .long 0,0,0,0
    .long 0,4,4,0
    .long 0,8,8,0
    .long 0,12,12,0
    .long 0,16,16,0
    .long 0,20,20,0
    .long 0,24,24,0
    .long 0,28,28,0
    .long 0,32,32,0
    .long 0,36,36,0
    .long 0,40,40,0
    .long 0,44,44,0
    .long 0,48,48,0
    .long 0,52,52,0
    .long 0,56,56,0
    .long 0,60,60,0
    .long 1065353216,1073741824,256,0
    .long 1065353216,1073741824,260,0
    .long 1065353216,1073741824,264,0
    .long 1065353216,1073741824,268,0
    .long 1065353216,1073741824,272,0
    .long 1065353216,1073741824,276,0
    .long 1065353216,1073741824,280,0
    .long 1065353216,1073741824,284,0
    .long 1065353216,1073741824,288,0
    .long 1065353216,1073741824,292,0
    .long 1065353216,1073741824,296,0
    .long 1065353216,1073741824,300,0
    .long 1065353216,1073741824,304,0
    .long 1065353216,1073741824,308,0
    .long 1065353216,1073741824,312,0
    .long 1065353216,1073741824,316,0
    .long 1065353216,64,512,0
    .long 1065353216,68,516,0
    .long 1065353216,72,520,0
    .long 1065353216,76,524,0
    .long 1065353216,80,528,0
    .long 1065353216,84,532,0
    .long 1065353216,88,536,0
    .long 1065353216,92,540,0
    .long 1065353216,96,544,0
    .long 1065353216,100,548,0
    .long 1065353216,104,552,0
    .long 1065353216,108,556,0
    .long 1065353216,112,560,0
    .long 1065353216,116,564,0
    .long 1065353216,120,568,0
    .long 1065353216,124,572,0
    .long 1065353216,1073741824,768,0
    .long 1065353216,1073741824,772,0
    .long 1065353216,1073741824,776,0
    .long 1065353216,1073741824,780,0
    .long 1065353216,1073741824,784,0
    .long 1065353216,1073741824,788,0
    .long 1065353216,1073741824,792,0
    .long 1065353216,1073741824,796,0
    .long 0,1073741824,800,0
    .long 0,1073741824,804,0
    .long 0,1073741824,808,0
    .long 0,1073741824,812,0
    .long 0,1073741824,816,0
    .long 0,1073741824,820,0
    .long 0,1073741824,824,0
    .long 0,1073741824,828,0
    .long 0,0,0,0
    .long 0,4,4,0
    .long 0,8,8,0
    .long 0,12,12,0
    .long 0,16,16,0
    .long 0,20,20,0
    .long 0,24,24,0
    .long 0,28,28,0
    .long 0,32,32,0
    .long 0,36,36,0
    .long 0,40,40,0
    .long 0,44,44,0
    .long 0,48,48,0
    .long 0,52,52,0
    .long 0,56,56,0
    .long 0,60,60,0
    .long 0,1073741824,256,0
    .long 0,1073741824,260,0
    .long 0,1073741824,264,0
    .long 0,1073741824,268,0
    .long 0,1073741824,272,0
    .long 0,1073741824,276,0
    .long 0,1073741824,280,0
    .long 0,1073741824,284,0
    .long 0,1073741824,288,0
    .long 0,1073741824,292,0
    .long 0,1073741824,296,0
    .long 0,1073741824,300,0
    .long 0,1073741824,304,0
    .long 0,1073741824,308,0
    .long 0,1073741824,312,0
    .long 0,1073741824,316,0
    .long 0,64,512,0
    .long 0,68,516,0
    .long 0,72,520,0
    .long 0,76,524,0
    .long 0,80,528,0
    .long 0,84,532,0
    .long 0,88,536,0
    .long 0,92,540,0
    .long 0,96,544,0
    .long 0,100,548,0
    .long 0,104,552,0
    .long 0,108,556,0
    .long 0,112,560,0
    .long 0,116,564,0
    .long 0,120,568,0
    .long 0,124,572,0
    .long 0,1073741824,768,0
    .long 0,1073741824,772,0
    .long 0,1073741824,776,0
    .long 0,1073741824,780,0
    .long 0,1073741824,784,0
    .long 0,1073741824,788,0
    .long 0,1073741824,792,0
    .long 0,1073741824,796,0
    .long 0,1073741824,800,0
    .long 0,1073741824,804,0
    .long 0,1073741824,808,0
    .long 0,1073741824,812,0
    .long 0,1073741824,816,0
    .long 0,1073741824,820,0
    .long 0,1073741824,824,0
    .long 0,1073741824,828,0
    .long 0,0,0,0
    .long 0,4,4,0
    .long 0,8,8,0
    .long 0,12,12,0
    .long 0,16,16,0
    .long 0,20,20,0
    .long 0,24,24,0
    .long 0,28,28,0
    .long 0,32,32,0
    .long 0,36,36,0
    .long 0,40,40,0
    .long 0,44,44,0
    .long 0,48,48,0
    .long 0,52,52,0
    .long 0,56,56,0
    .long 0,60,60,0
    .long 0,1073741824,256,0
    .long 0,1073741824,260,0
    .long 0,1073741824,264,0
    .long 0,1073741824,268,0
    .long 0,1073741824,272,0
    .long 0,1073741824,276,0
    .long 0,1073741824,280,0
    .long 0,1073741824,284,0
    .long 0,1073741824,288,0
    .long 0,1073741824,292,0
    .long 0,1073741824,296,0
    .long 0,1073741824,300,0
    .long 0,1073741824,304,0
    .long 0,1073741824,308,0
    .long 0,1073741824,312,0
    .long 0,1073741824,316,0
    .long 0,64,512,0
    .long 0,68,516,0
    .long 0,72,520,0
    .long 0,76,524,0
    .long 0,80,528,0
    .long 0,84,532,0
    .long 0,88,536,0
    .long 0,92,540,0
    .long 0,96,544,0
    .long 0,100,548,0
    .long 0,104,552,0
    .long 0,108,556,0
    .long 0,112,560,0
    .long 0,116,564,0
    .long 0,120,568,0
    .long 0,124,572,0
    .long 0,1073741824,768,0
    .long 0,1073741824,772,0
    .long 0,1073741824,776,0
    .long 0,1073741824,780,0
    .long 0,1073741824,784,0
    .long 0,1073741824,788,0
    .long 0,1073741824,792,0
    .long 0,1073741824,796,0
    .long 0,1073741824,800,0
    .long 0,1073741824,804,0
    .long 0,1073741824,808,0
    .long 0,1073741824,812,0
    .long 0,1073741824,816,0
    .long 0,1073741824,820,0
    .long 0,1073741824,824,0
    .long 0,1073741824,828,0
    .long 0,0,0,0
    .long 1073741824,128,16,4
    .long 1073741824,256,32,8
    .long 1073741824,384,48,12
    .long 1073741824,512,64,16
    .long 1073741824,640,80,20
    .long 1073741824,768,96,24
    .long 1073741824,896,112,28
    .long 1073741824,64,128,32
    .long 1073741824,192,144,36
    .long 1073741824,320,160,40
    .long 1073741824,448,176,44
    .long 1073741824,576,192,48
    .long 1073741824,704,208,52
    .long 1073741824,832,224,56
    .long 1073741824,960,240,60
    .long 16,16,1024,64
    .long 1073741824,144,1040,68
    .long 1073741824,272,1056,72
    .long 1073741824,400,1072,76
    .long 1073741824,528,1088,80
    .long 1073741824,656,1104,84
    .long 1073741824,784,1120,88
    .long 1073741824,912,1136,92
    .long 1073741824,80,1152,96
    .long 1073741824,208,1168,100
    .long 1073741824,336,1184,104
    .long 1073741824,464,1200,108
    .long 1073741824,592,1216,112
    .long 1073741824,720,1232,116
    .long 1073741824,848,1248,120
    .long 1073741824,976,1264,124
    .long 32,32,256,0
    .long 1073741824,160,272,4
    .long 1073741824,288,288,8
    .long 1073741824,416,304,12
    .long 1073741824,544,320,16
    .long 1073741824,672,336,20
    .long 1073741824,800,352,24
    .long 1073741824,928,368,28
    .long 1073741824,96,384,32
    .long 1073741824,224,400,36
    .long 1073741824,352,416,40
    .long 1073741824,480,432,44
    .long 1073741824,608,448,48
    .long 1073741824,736,464,52
    .long 1073741824,864,480,56
    .long 1073741824,992,496,60
    .long 48,48,1280,64
    .long 1073741824,176,1296,68
    .long 1073741824,304,1312,72
    .long 1073741824,432,1328,76
    .long 1073741824,560,1344,80
    .long 1073741824,688,1360,84
    .long 1073741824,816,1376,88
    .long 1073741824,944,1392,92
    .long 1073741824,112,1408,96
    .long 1073741824,240,1424,100
    .long 1073741824,368,1440,104
    .long 1073741824,496,1456,108
    .long 1073741824,624,1472,112
    .long 1073741824,752,1488,116
    .long 1073741824,880,1504,120
    .long 1073741824,1008,1520,124
    .long 0,0,0,0
    .long 1073741824,128,16,4
    .long 1073741824,256,32,8
    .long 1073741824,384,48,12
    .long 1073741824,512,64,16
    .long 1073741824,640,80,20
    .long 1073741824,768,96,24
    .long 1073741824,896,112,28
    .long 1073741824,64,128,32
    .long 1073741824,192,144,36
    .long 1073741824,320,160,40
    .long 1073741824,448,176,44
    .long 1073741824,576,192,48
    .long 1073741824,704,208,52
    .long 1073741824,832,224,56
    .long 1073741824,960,240,60
    .long 16,16,1024,64
    .long 1073741824,144,1040,68
    .long 1073741824,272,1056,72
    .long 1073741824,400,1072,76
    .long 1073741824,528,1088,80
    .long 1073741824,656,1104,84
    .long 1073741824,784,1120,88
    .long 1073741824,912,1136,92
    .long 1073741824,80,1152,96
    .long 1073741824,208,1168,100
    .long 1073741824,336,1184,104
    .long 1073741824,464,1200,108
    .long 1073741824,592,1216,112
    .long 1073741824,720,1232,116
    .long 1073741824,848,1248,120
    .long 1073741824,976,1264,124
    .long 32,32,256,0
    .long 1073741824,160,272,4
    .long 1073741824,288,288,8
    .long 1073741824,416,304,12
    .long 1073741824,544,320,16
    .long 1073741824,672,336,20
    .long 1073741824,800,352,24
    .long 1073741824,928,368,28
    .long 1073741824,96,384,32
    .long 1073741824,224,400,36
    .long 1073741824,352,416,40
    .long 1073741824,480,432,44
    .long 1073741824,608,448,48
    .long 1073741824,736,464,52
    .long 1073741824,864,480,56
    .long 1073741824,992,496,60
    .long 48,48,1280,64
    .long 1073741824,176,1296,68
    .long 1073741824,304,1312,72
    .long 1073741824,432,1328,76
    .long 1073741824,560,1344,80
    .long 1073741824,688,1360,84
    .long 1073741824,816,1376,88
    .long 1073741824,944,1392,92
    .long 1073741824,112,1408,96
    .long 1073741824,240,1424,100
    .long 1073741824,368,1440,104
    .long 1073741824,496,1456,108
    .long 1073741824,624,1472,112
    .long 1073741824,752,1488,116
    .long 1073741824,880,1504,120
    .long 1073741824,1008,1520,124
    .long 0,0,0,0
    .long 1073741824,128,16,4
    .long 1073741824,256,32,8
    .long 1073741824,384,48,12
    .long 1073741824,512,64,16
    .long 1073741824,640,80,20
    .long 1073741824,768,96,24
    .long 1073741824,896,112,28
    .long 1073741824,64,128,32
    .long 1073741824,192,144,36
    .long 1073741824,320,160,40
    .long 1073741824,448,176,44
    .long 1073741824,576,192,48
    .long 1073741824,704,208,52
    .long 1073741824,832,224,56
    .long 1073741824,960,240,60
    .long 16,16,1024,64
    .long 1073741824,144,1040,68
    .long 1073741824,272,1056,72
    .long 1073741824,400,1072,76
    .long 1073741824,528,1088,80
    .long 1073741824,656,1104,84
    .long 1073741824,784,1120,88
    .long 1073741824,912,1136,92
    .long 1073741824,80,1152,96
    .long 1073741824,208,1168,100
    .long 1073741824,336,1184,104
    .long 1073741824,464,1200,108
    .long 1073741824,592,1216,112
    .long 1073741824,720,1232,116
    .long 1073741824,848,1248,120
    .long 1073741824,976,1264,124
    .long 32,32,256,0
    .long 1073741824,160,272,4
    .long 1073741824,288,288,8
    .long 1073741824,416,304,12
    .long 1073741824,544,320,16
    .long 1073741824,672,336,20
    .long 1073741824,800,352,24
    .long 1073741824,928,368,28
    .long 1073741824,96,384,32
    .long 1073741824,224,400,36
    .long 1073741824,352,416,40
    .long 1073741824,480,432,44
    .long 1073741824,608,448,48
    .long 1073741824,736,464,52
    .long 1073741824,864,480,56
    .long 1073741824,992,496,60
    .long 48,48,1280,64
    .long 1073741824,176,1296,68
    .long 1073741824,304,1312,72
    .long 1073741824,432,1328,76
    .long 1073741824,560,1344,80
    .long 1073741824,688,1360,84
    .long 1073741824,816,1376,88
    .long 1073741824,944,1392,92
    .long 1073741824,112,1408,96
    .long 1073741824,240,1424,100
    .long 1073741824,368,1440,104
    .long 1073741824,496,1456,108
    .long 1073741824,624,1472,112
    .long 1073741824,752,1488,116
    .long 1073741824,880,1504,120
    .long 1073741824,1008,1520,124
    .long 0,0,0,0
    .long 1073741824,128,16,4
    .long 1073741824,256,32,8
    .long 1073741824,384,48,12
    .long 1073741824,512,64,16
    .long 1073741824,640,80,20
    .long 1073741824,768,96,24
    .long 1073741824,896,112,28
    .long 1073741824,64,128,32
    .long 1073741824,192,144,36
    .long 1073741824,320,160,40
    .long 1073741824,448,176,44
    .long 1073741824,576,192,48
    .long 1073741824,704,208,52
    .long 1073741824,832,224,56
    .long 1073741824,960,240,60
    .long 16,16,1024,64
    .long 1073741824,144,1040,68
    .long 1073741824,272,1056,72
    .long 1073741824,400,1072,76
    .long 1073741824,528,1088,80
    .long 1073741824,656,1104,84
    .long 1073741824,784,1120,88
    .long 1073741824,912,1136,92
    .long 1073741824,80,1152,96
    .long 1073741824,208,1168,100
    .long 1073741824,336,1184,104
    .long 1073741824,464,1200,108
    .long 1073741824,592,1216,112
    .long 1073741824,720,1232,116
    .long 1073741824,848,1248,120
    .long 1073741824,976,1264,124
    .long 32,32,256,0
    .long 1073741824,160,272,4
    .long 1073741824,288,288,8
    .long 1073741824,416,304,12
    .long 1073741824,544,320,16
    .long 1073741824,672,336,20
    .long 1073741824,800,352,24
    .long 1073741824,928,368,28
    .long 1073741824,96,384,32
    .long 1073741824,224,400,36
    .long 1073741824,352,416,40
    .long 1073741824,480,432,44
    .long 1073741824,608,448,48
    .long 1073741824,736,464,52
    .long 1073741824,864,480,56
    .long 1073741824,992,496,60
    .long 48,48,1280,64
    .long 1073741824,176,1296,68
    .long 1073741824,304,1312,72
    .long 1073741824,432,1328,76
    .long 1073741824,560,1344,80
    .long 1073741824,688,1360,84
    .long 1073741824,816,1376,88
    .long 1073741824,944,1392,92
    .long 1073741824,112,1408,96
    .long 1073741824,240,1424,100
    .long 1073741824,368,1440,104
    .long 1073741824,496,1456,108
    .long 1073741824,624,1472,112
    .long 1073741824,752,1488,116
    .long 1073741824,880,1504,120
    .long 1073741824,1008,1520,124
    .long 88832,107264,131840,156416
    .long 88848,107280,131856,156432
    .long 88864,107296,131872,156448
    .long 88880,107312,131888,156464
    .long 88896,107328,131904,156480
    .long 88912,107344,131920,156496
    .long 88928,107360,131936,156512
    .long 88944,107376,131952,156528
    .long 88960,107392,131968,156544
    .long 88976,107408,131984,156560
    .long 88992,107424,132000,156576
    .long 89008,107440,132016,156592
    .long 89024,107456,132032,156608
    .long 89040,107472,132048,156624
    .long 89056,107488,132064,156640
    .long 89072,107504,132080,156656
    .long 89088,107520,132096,156672
    .long 89104,107536,132112,156688
    .long 89120,107552,132128,156704
    .long 89136,107568,132144,156720
    .long 89152,107584,132160,156736
    .long 89168,107600,132176,156752
    .long 89184,107616,132192,156768
    .long 89200,107632,132208,156784
    .long 89216,107648,132224,156800
    .long 89232,107664,132240,156816
    .long 89248,107680,132256,156832
    .long 89264,107696,132272,156848
    .long 89280,107712,132288,156864
    .long 89296,107728,132304,156880
    .long 89312,107744,132320,156896
    .long 89328,107760,132336,156912
    .long 89344,107776,132352,156928
    .long 89360,107792,132368,156944
    .long 89376,107808,132384,156960
    .long 89392,107824,132400,156976
    .long 89408,107840,132416,156992
    .long 89424,107856,132432,157008
    .long 89440,107872,132448,157024
    .long 89456,107888,132464,157040
    .long 89472,107904,132480,157056
    .long 89488,107920,132496,157072
    .long 89504,107936,132512,157088
    .long 89520,107952,132528,157104
    .long 89536,107968,132544,157120
    .long 89552,107984,132560,157136
    .long 89568,108000,132576,157152
    .long 89584,108016,132592,157168
    .long 89600,108032,132608,157184
    .long 89616,108048,132624,157200
    .long 89632,108064,132640,157216
    .long 89648,108080,132656,157232
    .long 89664,108096,132672,157248
    .long 89680,108112,132688,157264
    .long 89696,108128,132704,157280
    .long 89712,108144,132720,157296
    .long 89728,108160,132736,157312
    .long 89744,108176,132752,157328
    .long 89760,108192,132768,157344
    .long 89776,108208,132784,157360
    .long 89792,108224,132800,157376
    .long 89808,108240,132816,157392
    .long 89824,108256,132832,157408
    .long 89840,108272,132848,157424
    .long 107264,125696,150272,101120
    .long 107280,125712,150288,101136
    .long 107296,125728,150304,101152
    .long 107312,125744,150320,101168
    .long 107328,125760,150336,101184
    .long 107344,125776,150352,101200
    .long 107360,125792,150368,101216
    .long 107376,125808,150384,101232
    .long 107392,125824,150400,101248
    .long 107408,125840,150416,101264
    .long 107424,125856,150432,101280
    .long 107440,125872,150448,101296
    .long 107456,125888,150464,101312
    .long 107472,125904,150480,101328
    .long 107488,125920,150496,101344
    .long 107504,125936,150512,101360
    .long 107520,125952,150528,101376
    .long 107536,125968,150544,101392
    .long 107552,125984,150560,101408
    .long 107568,126000,150576,101424
    .long 107584,126016,150592,101440
    .long 107600,126032,150608,101456
    .long 107616,126048,150624,101472
    .long 107632,126064,150640,101488
    .long 107648,126080,150656,101504
    .long 107664,126096,150672,101520
    .long 107680,126112,150688,101536
    .long 107696,126128,150704,101552
    .long 107712,126144,150720,101568
    .long 107728,126160,150736,101584
    .long 107744,126176,150752,101600
    .long 107760,126192,150768,101616
    .long 107776,126208,150784,101632
    .long 107792,126224,150800,101648
    .long 107808,126240,150816,101664
    .long 107824,126256,150832,101680
    .long 107840,126272,150848,101696
    .long 107856,126288,150864,101712
    .long 107872,126304,150880,101728
    .long 107888,126320,150896,101744
    .long 107904,126336,150912,101760
    .long 107920,126352,150928,101776
    .long 107936,126368,150944,101792
    .long 107952,126384,150960,101808
    .long 107968,126400,150976,101824
    .long 107984,126416,150992,101840
    .long 108000,126432,151008,101856
    .long 108016,126448,151024,101872
    .long 108032,126464,151040,101888
    .long 108048,126480,151056,101904
    .long 108064,126496,151072,101920
    .long 108080,126512,151088,101936
    .long 108096,126528,151104,101952
    .long 108112,126544,151120,101968
    .long 108128,126560,151136,101984
    .long 108144,126576,151152,102000
    .long 108160,126592,151168,102016
    .long 108176,126608,151184,102032
    .long 108192,126624,151200,102048
    .long 108208,126640,151216,102064
    .long 108224,126656,151232,102080
    .long 108240,126672,151248,102096
    .long 108256,126688,151264,102112
    .long 108272,126704,151280,102128
    .long 125696,144128,94976,119552
    .long 125712,144144,94992,119568
    .long 125728,144160,95008,119584
    .long 125744,144176,95024,119600
    .long 125760,144192,95040,119616
    .long 125776,144208,95056,119632
    .long 125792,144224,95072,119648
    .long 125808,144240,95088,119664
    .long 125824,144256,95104,119680
    .long 125840,144272,95120,119696
    .long 125856,144288,95136,119712
    .long 125872,144304,95152,119728
    .long 125888,144320,95168,119744
    .long 125904,144336,95184,119760
    .long 125920,144352,95200,119776
    .long 125936,144368,95216,119792
    .long 125952,144384,95232,119808
    .long 125968,144400,95248,119824
    .long 125984,144416,95264,119840
    .long 126000,144432,95280,119856
    .long 126016,144448,95296,119872
    .long 126032,144464,95312,119888
    .long 126048,144480,95328,119904
    .long 126064,144496,95344,119920
    .long 126080,144512,95360,119936
    .long 126096,144528,95376,119952
    .long 126112,144544,95392,119968
    .long 126128,144560,95408,119984
    .long 126144,144576,95424,120000
    .long 126160,144592,95440,120016
    .long 126176,144608,95456,120032
    .long 126192,144624,95472,120048
    .long 126208,144640,95488,120064
    .long 126224,144656,95504,120080
    .long 126240,144672,95520,120096
    .long 126256,144688,95536,120112
    .long 126272,144704,95552,120128
    .long 126288,144720,95568,120144
    .long 126304,144736,95584,120160
    .long 126320,144752,95600,120176
    .long 126336,144768,95616,120192
    .long 126352,144784,95632,120208
    .long 126368,144800,95648,120224
    .long 126384,144816,95664,120240
    .long 126400,144832,95680,120256
    .long 126416,144848,95696,120272
    .long 126432,144864,95712,120288
    .long 126448,144880,95728,120304
    .long 126464,144896,95744,120320
    .long 126480,144912,95760,120336
    .long 126496,144928,95776,120352
    .long 126512,144944,95792,120368
    .long 126528,144960,95808,120384
    .long 126544,144976,95824,120400
    .long 126560,144992,95840,120416
    .long 126576,145008,95856,120432
    .long 126592,145024,95872,120448
    .long 126608,145040,95888,120464
    .long 126624,145056,95904,120480
    .long 126640,145072,95920,120496
    .long 126656,145088,95936,120512
    .long 126672,145104,95952,120528
    .long 126688,145120,95968,120544
    .long 126704,145136,95984,120560
    .long 144128,88832,113408,137984
    .long 144144,88848,113424,138000
    .long 144160,88864,113440,138016
    .long 144176,88880,113456,138032
    .long 144192,88896,113472,138048
    .long 144208,88912,113488,138064
    .long 144224,88928,113504,138080
    .long 144240,88944,113520,138096
    .long 144256,88960,113536,138112
    .long 144272,88976,113552,138128
    .long 144288,88992,113568,138144
    .long 144304,89008,113584,138160
    .long 144320,89024,113600,138176
    .long 144336,89040,113616,138192
    .long 144352,89056,113632,138208
    .long 144368,89072,113648,138224
    .long 144384,89088,113664,138240
    .long 144400,89104,113680,138256
    .long 144416,89120,113696,138272
    .long 144432,89136,113712,138288
    .long 144448,89152,113728,138304
    .long 144464,89168,113744,138320
    .long 144480,89184,113760,138336
    .long 144496,89200,113776,138352
    .long 144512,89216,113792,138368
    .long 144528,89232,113808,138384
    .long 144544,89248,113824,138400
    .long 144560,89264,113840,138416
    .long 144576,89280,113856,138432
    .long 144592,89296,113872,138448
    .long 144608,89312,113888,138464
    .long 144624,89328,113904,138480
    .long 144640,89344,113920,138496
    .long 144656,89360,113936,138512
    .long 144672,89376,113952,138528
    .long 144688,89392,113968,138544
    .long 144704,89408,113984,138560
    .long 144720,89424,114000,138576
    .long 144736,89440,114016,138592
    .long 144752,89456,114032,138608
    .long 144768,89472,114048,138624
    .long 144784,89488,114064,138640
    .long 144800,89504,114080,138656
    .long 144816,89520,114096,138672
    .long 144832,89536,114112,138688
    .long 144848,89552,114128,138704
    .long 144864,89568,114144,138720
    .long 144880,89584,114160,138736
    .long 144896,89600,114176,138752
    .long 144912,89616,114192,138768
    .long 144928,89632,114208,138784
    .long 144944,89648,114224,138800
    .long 144960,89664,114240,138816
    .long 144976,89680,114256,138832
    .long 144992,89696,114272,138848
    .long 145008,89712,114288,138864
    .long 145024,89728,114304,138880
    .long 145040,89744,114320,138896
    .long 145056,89760,114336,138912
    .long 145072,89776,114352,138928
    .long 145088,89792,114368,138944
    .long 145104,89808,114384,138960
    .long 145120,89824,114400,138976
    .long 145136,89840,114416,138992
    .long 131072,0,7744,15488
    .long 131248,16,7760,15504
    .long 131424,32,7776,16640
    .long 131600,48,7792,16656
    .long 131776,64,7808,16672
    .long 131952,80,7824,16688
    .long 132128,96,8960,16704
    .long 132304,112,8976,16720
    .long 132480,128,8992,16736
    .long 132656,144,9008,16752
    .long 132832,1280,9024,16768
    .long 133008,1296,9040,16784
    .long 133184,1312,9056,17920
    .long 133360,1328,9072,17936
    .long 133536,1344,9088,17952
    .long 133712,1360,9104,17968
    .long 131080,1376,10240,17984
    .long 131256,1392,10256,18000
    .long 131432,1408,10272,18016
    .long 131608,1424,10288,18032
    .long 131784,2560,10304,18048
    .long 131960,2576,10320,18064
    .long 132136,2592,10336,19200
    .long 132312,2608,10352,19216
    .long 132488,2624,10368,19232
    .long 132664,2640,10384,19248
    .long 132840,2656,11520,19264
    .long 133016,2672,11536,19280
    .long 133192,2688,11552,19296
    .long 133368,2704,11568,19312
    .long 133544,3840,11584,19328
    .long 133720,3856,11600,19344
    .long 131088,3872,11616,1073741824
    .long 131264,3888,11632,1073741824
    .long 131440,3904,11648,1073741824
    .long 131616,3920,11664,1073741824
    .long 131792,3936,12800,1073741824
    .long 131968,3952,12816,1073741824
    .long 132144,3968,12832,1073741824
    .long 132320,3984,12848,1073741824
    .long 132496,5120,12864,1073741824
    .long 132672,5136,12880,1073741824
    .long 132848,5152,12896,1073741824
    .long 133024,5168,12912,1073741824
    .long 133200,5184,12928,1073741824
    .long 133376,5200,12944,1073741824
    .long 133552,5216,14080,1073741824
    .long 133728,5232,14096,1073741824
    .long 131096,5248,14112,1073741824
    .long 131272,5264,14128,1073741824
    .long 131448,6400,14144,1073741824
    .long 131624,6416,14160,1073741824
    .long 131800,6432,14176,1073741824
    .long 131976,6448,14192,1073741824
    .long 132152,6464,14208,1073741824
    .long 132328,6480,14224,1073741824
    .long 132504,6496,15360,1073741824
    .long 132680,6512,15376,1073741824
    .long 132856,6528,15392,1073741824
    .long 133032,6544,15408,1073741824
    .long 133208,7680,15424,1073741824
    .long 133384,7696,15440,1073741824
    .long 133560,7712,15456,1073741824
    .long 133736,7728,15472,1073741824
    .long 133888,0,7744,15488
    .long 134064,16,7760,15504
    .long 134240,32,7776,16640
    .long 134416,48,7792,16656
    .long 134592,64,7808,16672
    .long 134768,80,7824,16688
    .long 134944,96,8960,16704
    .long 135120,112,8976,16720
    .long 135296,128,8992,16736
    .long 135472,144,9008,16752
    .long 135648,1280,9024,16768
    .long 135824,1296,9040,16784
    .long 136000,1312,9056,17920
    .long 136176,1328,9072,17936
    .long 136352,1344,9088,17952
    .long 136528,1360,9104,17968
    .long 133896,1376,10240,17984
    .long 134072,1392,10256,18000
    .long 134248,1408,10272,18016
    .long 134424,1424,10288,18032
    .long 134600,2560,10304,18048
    .long 134776,2576,10320,18064
    .long 134952,2592,10336,19200
    .long 135128,2608,10352,19216
    .long 135304,2624,10368,19232
    .long 135480,2640,10384,19248
    .long 135656,2656,11520,19264
    .long 135832,2672,11536,19280
    .long 136008,2688,11552,19296
    .long 136184,2704,11568,19312
    .long 136360,3840,11584,19328
    .long 136536,3856,11600,19344
    .long 133904,3872,11616,1073741824
    .long 134080,3888,11632,1073741824
    .long 134256,3904,11648,1073741824
    .long 134432,3920,11664,1073741824
    .long 134608,3936,12800,1073741824
    .long 134784,3952,12816,1073741824
    .long 134960,3968,12832,1073741824
    .long 135136,3984,12848,1073741824
    .long 135312,5120,12864,1073741824
    .long 135488,5136,12880,1073741824
    .long 135664,5152,12896,1073741824
    .long 135840,5168,12912,1073741824
    .long 136016,5184,12928,1073741824
    .long 136192,5200,12944,1073741824
    .long 136368,5216,14080,1073741824
    .long 136544,5232,14096,1073741824
    .long 133912,5248,14112,1073741824
    .long 134088,5264,14128,1073741824
    .long 134264,6400,14144,1073741824
    .long 134440,6416,14160,1073741824
    .long 134616,6432,14176,1073741824
    .long 134792,6448,14192,1073741824
    .long 134968,6464,14208,1073741824
    .long 135144,6480,14224,1073741824
    .long 135320,6496,15360,1073741824
    .long 135496,6512,15376,1073741824
    .long 135672,6528,15392,1073741824
    .long 135848,6544,15408,1073741824
    .long 136024,7680,15424,1073741824
    .long 136200,7696,15440,1073741824
    .long 136376,7712,15456,1073741824
    .long 136552,7728,15472,1073741824
    .long 136704,0,7744,15488
    .long 136880,16,7760,15504
    .long 137056,32,7776,16640
    .long 137232,48,7792,16656
    .long 137408,64,7808,16672
    .long 137584,80,7824,16688
    .long 137760,96,8960,16704
    .long 137936,112,8976,16720
    .long 138112,128,8992,16736
    .long 138288,144,9008,16752
    .long 138464,1280,9024,16768
    .long 138640,1296,9040,16784
    .long 138816,1312,9056,17920
    .long 138992,1328,9072,17936
    .long 139168,1344,9088,17952
    .long 139344,1360,9104,17968
    .long 136712,1376,10240,17984
    .long 136888,1392,10256,18000
    .long 137064,1408,10272,18016
    .long 137240,1424,10288,18032
    .long 137416,2560,10304,18048
    .long 137592,2576,10320,18064
    .long 137768,2592,10336,19200
    .long 137944,2608,10352,19216
    .long 138120,2624,10368,19232
    .long 138296,2640,10384,19248
    .long 138472,2656,11520,19264
    .long 138648,2672,11536,19280
    .long 138824,2688,11552,19296
    .long 139000,2704,11568,19312
    .long 139176,3840,11584,19328
    .long 139352,3856,11600,19344
    .long 136720,3872,11616,1073741824
    .long 136896,3888,11632,1073741824
    .long 137072,3904,11648,1073741824
    .long 137248,3920,11664,1073741824
    .long 137424,3936,12800,1073741824
    .long 137600,3952,12816,1073741824
    .long 137776,3968,12832,1073741824
    .long 137952,3984,12848,1073741824
    .long 138128,5120,12864,1073741824
    .long 138304,5136,12880,1073741824
    .long 138480,5152,12896,1073741824
    .long 138656,5168,12912,1073741824
    .long 138832,5184,12928,1073741824
    .long 139008,5200,12944,1073741824
    .long 139184,5216,14080,1073741824
    .long 139360,5232,14096,1073741824
    .long 136728,5248,14112,1073741824
    .long 136904,5264,14128,1073741824
    .long 137080,6400,14144,1073741824
    .long 137256,6416,14160,1073741824
    .long 137432,6432,14176,1073741824
    .long 137608,6448,14192,1073741824
    .long 137784,6464,14208,1073741824
    .long 137960,6480,14224,1073741824
    .long 138136,6496,15360,1073741824
    .long 138312,6512,15376,1073741824
    .long 138488,6528,15392,1073741824
    .long 138664,6544,15408,1073741824
    .long 138840,7680,15424,1073741824
    .long 139016,7696,15440,1073741824
    .long 139192,7712,15456,1073741824
    .long 139368,7728,15472,1073741824
    .long 139520,0,7744,15488
    .long 139696,16,7760,15504
    .long 139872,32,7776,16640
    .long 140048,48,7792,16656
    .long 140224,64,7808,16672
    .long 140400,80,7824,16688
    .long 140576,96,8960,16704
    .long 140752,112,8976,16720
    .long 140928,128,8992,16736
    .long 141104,144,9008,16752
    .long 141280,1280,9024,16768
    .long 141456,1296,9040,16784
    .long 141632,1312,9056,17920
    .long 141808,1328,9072,17936
    .long 141984,1344,9088,17952
    .long 142160,1360,9104,17968
    .long 139528,1376,10240,17984
    .long 139704,1392,10256,18000
    .long 139880,1408,10272,18016
    .long 140056,1424,10288,18032
    .long 140232,2560,10304,18048
    .long 140408,2576,10320,18064
    .long 140584,2592,10336,19200
    .long 140760,2608,10352,19216
    .long 140936,2624,10368,19232
    .long 141112,2640,10384,19248
    .long 141288,2656,11520,19264
    .long 141464,2672,11536,19280
    .long 141640,2688,11552,19296
    .long 141816,2704,11568,19312
    .long 141992,3840,11584,19328
    .long 142168,3856,11600,19344
    .long 139536,3872,11616,1073741824
    .long 139712,3888,11632,1073741824
    .long 139888,3904,11648,1073741824
    .long 140064,3920,11664,1073741824
    .long 140240,3936,12800,1073741824
    .long 140416,3952,12816,1073741824
    .long 140592,3968,12832,1073741824
    .long 140768,3984,12848,1073741824
    .long 140944,5120,12864,1073741824
    .long 141120,5136,12880,1073741824
    .long 141296,5152,12896,1073741824
    .long 141472,5168,12912,1073741824
    .long 141648,5184,12928,1073741824
    .long 141824,5200,12944,1073741824
    .long 142000,5216,14080,1073741824
    .long 142176,5232,14096,1073741824
    .long 139544,5248,14112,1073741824
    .long 139720,5264,14128,1073741824
    .long 139896,6400,14144,1073741824
    .long 140072,6416,14160,1073741824
    .long 140248,6432,14176,1073741824
    .long 140424,6448,14192,1073741824
    .long 140600,6464,14208,1073741824
    .long 140776,6480,14224,1073741824
    .long 140952,6496,15360,1073741824
    .long 141128,6512,15376,1073741824
    .long 141304,6528,15392,1073741824
    .long 141480,6544,15408,1073741824
    .long 141656,7680,15424,1073741824
    .long 141832,7696,15440,1073741824
    .long 142008,7712,15456,1073741824
    .long 142184,7728,15472,1073741824
    .long 131072,132192,133312,0
    .long 131088,132208,133328,0
    .long 131104,132224,133360,0
    .long 131120,132240,133376,0
    .long 131136,132256,133392,0
    .long 131152,132272,133408,0
    .long 131168,132304,133424,0
    .long 131184,132320,133440,0
    .long 131200,132336,133456,0
    .long 131216,132352,133472,0
    .long 131248,132368,133488,0
    .long 131264,132384,133504,0
    .long 131280,132400,133536,0
    .long 131296,132416,133552,0
    .long 131312,132432,133568,0
    .long 131328,132448,133584,0
    .long 131344,132480,133600,0
    .long 131360,132496,133616,0
    .long 131376,132512,133632,0
    .long 131392,132528,133648,0
    .long 131424,132544,133664,0
    .long 131440,132560,133680,0
    .long 131456,132576,133712,0
    .long 131472,132592,133728,0
    .long 131488,132608,133744,0
    .long 131504,132624,133760,0
    .long 131520,132656,133776,0
    .long 131536,132672,133792,0
    .long 131552,132688,133808,0
    .long 131568,132704,133824,0
    .long 131600,132720,133840,0
    .long 131616,132736,133856,0
    .long 131632,132752,133856,0
    .long 131648,132768,133856,0
    .long 131664,132784,133856,0
    .long 131680,132800,133856,0
    .long 131696,132832,133856,0
    .long 131712,132848,133856,0
    .long 131728,132864,133856,0
    .long 131744,132880,133856,0
    .long 131776,132896,133856,0
    .long 131792,132912,133856,0
    .long 131808,132928,133856,0
    .long 131824,132944,133856,0
    .long 131840,132960,133856,0
    .long 131856,132976,133856,0
    .long 131872,133008,133856,0
    .long 131888,133024,133856,0
    .long 131904,133040,133856,0
    .long 131920,133056,133856,0
    .long 131952,133072,133856,0
    .long 131968,133088,133856,0
    .long 131984,133104,133856,0
    .long 132000,133120,133856,0
    .long 132016,133136,133856,0
    .long 132032,133152,133856,0
    .long 132048,133184,133856,0
    .long 132064,133200,133856,0
    .long 132080,133216,133856,0
    .long 132096,133232,133856,0
    .long 132128,133248,133856,0
    .long 132144,133264,133856,0
    .long 132160,133280,133856,0
    .long 132176,133296,133856,0
    .long 133888,135008,136128,0
    .long 133904,135024,136144,0
    .long 133920,135040,136176,0
    .long 133936,135056,136192,0
    .long 133952,135072,136208,0
    .long 133968,135088,136224,0
    .long 133984,135120,136240,0
    .long 134000,135136,136256,0
    .long 134016,135152,136272,0
    .long 134032,135168,136288,0
    .long 134064,135184,136304,0
    .long 134080,135200,136320,0
    .long 134096,135216,136352,0
    .long 134112,135232,136368,0
    .long 134128,135248,136384,0
    .long 134144,135264,136400,0
    .long 134160,135296,136416,0
    .long 134176,135312,136432,0
    .long 134192,135328,136448,0
    .long 134208,135344,136464,0
    .long 134240,135360,136480,0
    .long 134256,135376,136496,0
    .long 134272,135392,136528,0
    .long 134288,135408,136544,0
    .long 134304,135424,136560,0
    .long 134320,135440,136576,0
    .long 134336,135472,136592,0
    .long 134352,135488,136608,0
    .long 134368,135504,136624,0
    .long 134384,135520,136640,0
    .long 134416,135536,136656,0
    .long 134432,135552,136672,0
    .long 134448,135568,136672,0
    .long 134464,135584,136672,0
    .long 134480,135600,136672,0
    .long 134496,135616,136672,0
    .long 134512,135648,136672,0
    .long 134528,135664,136672,0
    .long 134544,135680,136672,0
    .long 134560,135696,136672,0
    .long 134592,135712,136672,0
    .long 134608,135728,136672,0
    .long 134624,135744,136672,0
    .long 134640,135760,136672,0
    .long 134656,135776,136672,0
    .long 134672,135792,136672,0
    .long 134688,135824,136672,0
    .long 134704,135840,136672,0
    .long 134720,135856,136672,0
    .long 134736,135872,136672,0
    .long 134768,135888,136672,0
    .long 134784,135904,136672,0
    .long 134800,135920,136672,0
    .long 134816,135936,136672,0
    .long 134832,135952,136672,0
    .long 134848,135968,136672,0
    .long 134864,136000,136672,0
    .long 134880,136016,136672,0
    .long 134896,136032,136672,0
    .long 134912,136048,136672,0
    .long 134944,136064,136672,0
    .long 134960,136080,136672,0
    .long 134976,136096,136672,0
    .long 134992,136112,136672,0
    .long 136704,137824,138944,0
    .long 136720,137840,138960,0
    .long 136736,137856,138992,0
    .long 136752,137872,139008,0
    .long 136768,137888,139024,0
    .long 136784,137904,139040,0
    .long 136800,137936,139056,0
    .long 136816,137952,139072,0
    .long 136832,137968,139088,0
    .long 136848,137984,139104,0
    .long 136880,138000,139120,0
    .long 136896,138016,139136,0
    .long 136912,138032,139168,0
    .long 136928,138048,139184,0
    .long 136944,138064,139200,0
    .long 136960,138080,139216,0
    .long 136976,138112,139232,0
    .long 136992,138128,139248,0
    .long 137008,138144,139264,0
    .long 137024,138160,139280,0
    .long 137056,138176,139296,0
    .long 137072,138192,139312,0
    .long 137088,138208,139344,0
    .long 137104,138224,139360,0
    .long 137120,138240,139376,0
    .long 137136,138256,139392,0
    .long 137152,138288,139408,0
    .long 137168,138304,139424,0
    .long 137184,138320,139440,0
    .long 137200,138336,139456,0
    .long 137232,138352,139472,0
    .long 137248,138368,139488,0
    .long 137264,138384,139488,0
    .long 137280,138400,139488,0
    .long 137296,138416,139488,0
    .long 137312,138432,139488,0
    .long 137328,138464,139488,0
    .long 137344,138480,139488,0
    .long 137360,138496,139488,0
    .long 137376,138512,139488,0
    .long 137408,138528,139488,0
    .long 137424,138544,139488,0
    .long 137440,138560,139488,0
    .long 137456,138576,139488,0
    .long 137472,138592,139488,0
    .long 137488,138608,139488,0
    .long 137504,138640,139488,0
    .long 137520,138656,139488,0
    .long 137536,138672,139488,0
    .long 137552,138688,139488,0
    .long 137584,138704,139488,0
    .long 137600,138720,139488,0
    .long 137616,138736,139488,0
    .long 137632,138752,139488,0
    .long 137648,138768,139488,0
    .long 137664,138784,139488,0
    .long 137680,138816,139488,0
    .long 137696,138832,139488,0
    .long 137712,138848,139488,0
    .long 137728,138864,139488,0
    .long 137760,138880,139488,0
    .long 137776,138896,139488,0
    .long 137792,138912,139488,0
    .long 137808,138928,139488,0
    .long 139520,140640,141760,0
    .long 139536,140656,141776,0
    .long 139552,140672,141808,0
    .long 139568,140688,141824,0
    .long 139584,140704,141840,0
    .long 139600,140720,141856,0
    .long 139616,140752,141872,0
    .long 139632,140768,141888,0
    .long 139648,140784,141904,0
    .long 139664,140800,141920,0
    .long 139696,140816,141936,0
    .long 139712,140832,141952,0
    .long 139728,140848,141984,0
    .long 139744,140864,142000,0
    .long 139760,140880,142016,0
    .long 139776,140896,142032,0
    .long 139792,140928,142048,0
    .long 139808,140944,142064,0
    .long 139824,140960,142080,0
    .long 139840,140976,142096,0
    .long 139872,140992,142112,0
    .long 139888,141008,142128,0
    .long 139904,141024,142160,0
    .long 139920,141040,142176,0
    .long 139936,141056,142192,0
    .long 139952,141072,142208,0
    .long 139968,141104,142224,0
    .long 139984,141120,142240,0
    .long 140000,141136,142256,0
    .long 140016,141152,142272,0
    .long 140048,141168,142288,0
    .long 140064,141184,142304,0
    .long 140080,141200,142304,0
    .long 140096,141216,142304,0
    .long 140112,141232,142304,0
    .long 140128,141248,142304,0
    .long 140144,141280,142304,0
    .long 140160,141296,142304,0
    .long 140176,141312,142304,0
    .long 140192,141328,142304,0
    .long 140224,141344,142304,0
    .long 140240,141360,142304,0
    .long 140256,141376,142304,0
    .long 140272,141392,142304,0
    .long 140288,141408,142304,0
    .long 140304,141424,142304,0
    .long 140320,141456,142304,0
    .long 140336,141472,142304,0
    .long 140352,141488,142304,0
    .long 140368,141504,142304,0
    .long 140400,141520,142304,0
    .long 140416,141536,142304,0
    .long 140432,141552,142304,0
    .long 140448,141568,142304,0
    .long 140464,141584,142304,0
    .long 140480,141600,142304,0
    .long 140496,141632,142304,0
    .long 140512,141648,142304,0
    .long 140528,141664,142304,0
    .long 140544,141680,142304,0
    .long 140576,141696,142304,0
    .long 140592,141712,142304,0
    .long 140608,141728,142304,0
    .long 140624,141744,142304,0
    .size L_ctab, 61440
L_last:
.section .rodata,"a"
.p2align 6
.amdhsa_kernel adaLN_cond__linear_kernel_hedgehog__mixer_gmlp__prompt_kernel
  .amdhsa_next_free_vgpr 512
  .amdhsa_next_free_sgpr 102
  .amdhsa_accum_offset 256
  .amdhsa_group_segment_fixed_size 0
  .amdhsa_kernarg_size 112
  .amdhsa_user_sgpr_count 2
  .amdhsa_user_sgpr_kernarg_segment_ptr 1
  .amdhsa_system_sgpr_workgroup_id_x 1
.end_amdhsa_kernel
```
